```python
import torch

def _softmax(x, axis=-1):
    return torch.softmax(x, dim=axis)
def _gelu(x):
    return torch.nn.functional.gelu(x, approximate="tanh")
def _silu(x):
    return torch.nn.functional.silu(x)
def _sigmoid(x):
    return torch.sigmoid(x)
def _layernorm(x, axis=-1, eps=1e-5):
    m = x.mean(dim=axis, keepdim=True)
    v = x.var(dim=axis, keepdim=True, unbiased=False)
    return (x - m) / torch.sqrt(v + eps)
def _scatter_add(tgt, idx, src, axis=0):
    return tgt.clone().index_add_(axis, idx, src)
def _segment_sum(src, seg, n):
    out = torch.zeros((n,) + src.shape[1:], dtype=src.dtype)
    return out.index_add_(0, seg, src)
def _pad(x, pw):
    flat = tuple(v for pair in reversed(pw) for v in pair)
    return torch.nn.functional.pad(x, flat)

kernel_name = 'recurrent_scan__sliding_local_dilated__swiglu_ffn__prompt'

def setup_inputs():

    _w = (lambda a: (lambda t: t.to(torch.bfloat16) if t.is_floating_point() else t)(torch.as_tensor(a)))
    def _A_setup():
        B, S, D = 1, 2048, 640
        return {
            "x": _w((lambda *s: torch.randn(*s, dtype=torch.bfloat16) * 0.05)(B, S, D)),
            "wqkv": _w((lambda *s: torch.randn(*s, dtype=torch.bfloat16) * 0.05)(D, 3 * D)),
            "wo": _w((lambda *s: torch.randn(*s, dtype=torch.bfloat16) * 0.05)(D, D)),
        }
    _A_in = _A_setup()

    def _B_setup():
        B, S, D, F = 1, 2048, 640, 1728
        return {
            "x": _w((lambda *s: torch.randn(*s, dtype=torch.bfloat16) * 0.05)(B, S, D)),
            "w_gate": _w((lambda *s: torch.randn(*s, dtype=torch.bfloat16) * 0.05)(D, F)),
            "w_up": _w((lambda *s: torch.randn(*s, dtype=torch.bfloat16) * 0.05)(D, F)),
            "w_down": _w((lambda *s: torch.randn(*s, dtype=torch.bfloat16) * 0.05)(F, D)),
        }
    _B_in = _B_setup()

    return {
        "A_x": _A_in["x"],
        "A_wqkv": _A_in["wqkv"],
        "A_wo": _A_in["wo"],
        "B_x": _B_in["x"],
        "B_w_gate": _B_in["w_gate"],
        "B_w_up": _B_in["w_up"],
        "B_w_down": _B_in["w_down"],
    }

def reference(A_x, A_wqkv, A_wo, B_x, B_w_gate, B_w_up, B_w_down):
    def _A_ref(x, wqkv, wo):
        B, S, D = x.shape
        H = 32; Dh = D // H
        W, dil = 8, 2
        qkv = (lambda x, *d: x.permute(*d))((x @ wqkv).reshape(B, S, 3, H, Dh), 2, 0, 3, 1, 4)
        q, k, v = qkv[0], qkv[1], qkv[2]
        scale = Dh ** -0.5
        pos = torch.arange(S)
        off = torch.arange(W) * dil
        idx = pos[:, None] - off[None, :]
        mask = idx >= 0
        idx_c = torch.where(mask, idx, 0).reshape(-1)
        kg = k[:, :, idx_c, :].reshape(B, H, S, W, Dh)
        vg = v[:, :, idx_c, :].reshape(B, H, S, W, Dh)
        logits = torch.einsum("bhsd,bhswd->bhsw", q, kg) * scale
        logits = torch.where(mask[None, None, :, :], logits, -1e9)
        attn = _softmax(logits, axis=-1)
        o = torch.einsum("bhsw,bhswd->bhsd", attn, vg)
        return (lambda x, *d: x.permute(*d))(o, 0, 2, 1, 3).reshape(B, S, D) @ wo

    def _B_ref(x, w_gate, w_up, w_down):
        g = _silu(x @ w_gate)
        u = x @ w_up
        return (g * u) @ w_down

    x = A_x
    xn = _layernorm(x, axis=-1)
    s = _A_ref(xn, A_wqkv, A_wo)
    g = _silu(_B_ref(xn, B_w_gate, B_w_up, B_w_down))
    return x + s * g
```

```asm
; @launch grid=(256,1,1) block=(256,1,1) lds=163840
.amdgcn_target "amdgcn-amd-amdhsa--gfx950"
.text
.globl recurrent_scan__sliding_local_dilated__swiglu_ffn__prompt_kernel
.p2align 8
.type recurrent_scan__sliding_local_dilated__swiglu_ffn__prompt_kernel,@function
recurrent_scan__sliding_local_dilated__swiglu_ffn__prompt_kernel:
    s_cmp_ge_u32 s2, 256
    s_cbranch_scc1 recurrent_scan__sliding_local_dilated__swiglu_ffn__prompt_kernel_end
    s_load_dwordx2 s[4:5], s[0:1], 0
    s_load_dwordx2 s[76:77], s[0:1], 8
    s_load_dwordx2 s[80:81], s[0:1], 16
    s_load_dwordx4 s[84:87], s[0:1], 32
    s_load_dwordx2 s[82:83], s[0:1], 48
    s_load_dwordx2 s[6:7], s[0:1], 56
    s_load_dwordx2 s[78:79], s[0:1], 72
    s_getpc_b64 s[92:93]
    s_lshr_b32 s94, s2, 3
    s_mul_i32 s94, s94, 1408
    v_lshlrev_b32 v27, 7, v0
    v_add_u32 v27, s94, v27
    v_min_u32 v27, recurrent_scan__sliding_local_dilated__swiglu_ffn__prompt_kernel_end-recurrent_scan__sliding_local_dilated__swiglu_ffn__prompt_kernel-128, v27
    v_cmp_gt_u32 vcc, 11, v0
    s_and_saveexec_b64 s[94:95], vcc
    s_cbranch_execz recurrent_scan__sliding_local_dilated__swiglu_ffn__prompt_kernel_nt
    global_load_dword v95, v27, s[92:93]
    recurrent_scan__sliding_local_dilated__swiglu_ffn__prompt_kernel_nt:
    s_mov_b64 exec, -1
    v_lshrrev_b32 v27, 6, v0
    v_and_b32 v0, 63, v0
    s_and_b32 s92, s2, 7
    v_readfirstlane_b32 s8, v27
    s_lshr_b32 s93, s2, 3
    s_and_b32 s10, s92, 1
    s_lshr_b32 s92, s92, 1
    s_lshl_b32 s92, s92, 2
    s_lshr_b32 s94, s93, 3
    s_add_u32 s88, s92, s94
    s_and_b32 s89, s93, 7
    s_lshl_b32 s90, s94, 2
    s_lshr_b32 s90, 4112, s90
    s_and_b32 s90, s90, 15
    s_add_u32 s90, s90, s89
    s_lshr_b32 s95, 29984, s92
    s_and_b32 s95, s95, 15
    s_add_u32 s90, s90, s95
    s_mul_i32 s95, s10, 0
    s_add_u32 s90, s90, s95
    s_lshl_b32 s11, s8, 12
    s_sub_u32 s95, s90, 10
    s_min_u32 s90, s90, s95
    s_lshl_b32 s101, s90, 7
    s_lshl_b32 s92, s88, 7
    s_lshl_b32 s93, s8, 5
    s_add_u32 s92, s92, s93
    s_mul_i32 s92, s92, 1280
    v_lshrrev_b32 v27, 3, v0
    v_mul_u32_u24 v27, 1280, v27
    v_add_u32 v27, s92, v27
    v_lshrrev_b32 v28, 4, v0
    v_and_b32 v29, 7, v0
    v_xor_b32 v28, v28, v29
    v_xor_b32 v29, 4, v28
    v_lshl_add_u32 v36, v28, 4, v27
    v_lshl_add_u32 v37, v29, 4, v27
    v_add_u32 v37, 9216, v37
    v_add_u32 v38, 18432, v36
    v_add_u32 v39, 18432, v37
    s_mov_b32 s22, 2621440
    s_mov_b32 s23, 0x20000
    s_mov_b32 m0, s11
    s_mov_b32 s3, 67108864
    s_lshl_b32 s99, s10, 3
    s_add_u32 s99, s99, s89
    v_lshrrev_b32 v25, 3, v0
    s_and_b32 s92, s8, 1
    s_lshl_b32 s92, s92, 5
    v_add_u32 v25, s92, v25
    v_bfe_u32 v27, v0, 1, 2
    v_bfe_u32 v28, v0, 4, 1
    v_xor_b32 v27, v27, v28
    v_and_b32 v28, 1, v0
    v_lshlrev_b32 v28, 4, v28
    v_lshl_add_u32 v26, v27, 5, v28
    s_add_u32 s100, s99, 15
    s_and_b32 s100, s100, 15
    s_mov_b32 s27, 0x20000
    s_movk_i32 s28, 3840
    s_lshr_b32 s92, s8, 1
    s_lshl_b32 s29, s100, 1
    s_add_u32 s29, s29, s92
    s_lshl_b32 s29, s29, 7
    s_mul_i32 s30, s90, 245760
    s_lshl_b32 s92, s88, 2
    s_add_u32 s92, s92, s8
    s_mul_i32 s92, s92, 122880
    s_lshl_b32 s93, s100, 13
    s_add_u32 s92, s92, s93
    s_add_u32 s92, s92, 16777216
    s_cmp_lt_u32 s100, 15
    s_cselect_b32 s26, 2457600, 0
    s_cselect_b32 s31, s92, s3
    v_mad_u32_u24 v1, v25, s28, v26
    s_lshl_b32 s13, s28, 6
    s_lshl_b32 s92, s28, 3
    s_sub_u32 s92, s92, 1024
    v_add_u32 v1, s29, v1
    s_mul_i32 s14, s13, 9
    s_mov_b32 s12, s30
    v_xor_b32 v2, 64, v1
    v_add_u32 v2, s92, v2
    s_lshl_b32 s92, s92, 1
    v_add_u32 v3, s92, v1
    v_add_u32 v4, s92, v2
    s_waitcnt lgkmcnt(0)
    s_mov_b32 s20, s4
    s_mov_b32 s21, s5
    buffer_load_dwordx4 v36, s[20:23], s101 offen offset:0 lds
    s_mov_b32 s24, s76
    s_mov_b32 s25, s77
    s_add_u32 s92, s78, 25165568
    s_addc_u32 s93, s79, 0
    s_load_dwordx2 s[60:61], s[92:93], 0
    s_mov_b32 s57, 0x3f803f80
    s_mov_b32 s58, 0x00003f80
    s_mov_b32 s59, 0x3f800000
    v_and_b32 v27, 15, v0
    v_lshlrev_b32 v28, 7, v27
    v_add_u32 v28, s11, v28
    v_bfe_u32 v27, v0, 1, 3
    v_lshrrev_b32 v29, 4, v0
    v_xor_b32 v27, v27, v29
    v_xor_b32 v29, 0, v27
    v_lshl_add_u32 v40, v29, 4, v28
    v_add_u32 v44, 0x10000, v40
    v_add_u32 v48, 0x20000, v40
    v_xor_b32 v29, 4, v27
    v_lshl_add_u32 v41, v29, 4, v28
    v_add_u32 v45, 0x10000, v41
    buffer_load_dwordx4 v37, s[20:23], s101 offen offset:1024 lds
    v_add_u32 v49, 0x20000, v41
    v_mov_b64 v[56:57], 0
    v_mov_b64 v[58:59], 0
    v_lshlrev_b32 v31, 4, v0
    v_lshlrev_b32 v18, 3, v0
    v_bfe_u32 v27, v0, 4, 1
    v_bfe_u32 v28, v0, 2, 2
    v_lshrrev_b32 v29, 4, v0
    v_lshl_add_u32 v29, v29, 3, v28
    v_lshlrev_b32 v29, 7, v29
    v_and_b32 v32, 3, v0
    v_lshl_add_u32 v29, v32, 3, v29
    v_lshrrev_b32 v28, 1, v28
    v_lshl_add_u32 v27, v27, 1, v28
    v_xor_b32 v28, 0, v27
    v_lshl_add_u32 v5, v28, 5, v29
    v_add_u32 v9, 0x10000, v5
    v_add_u32 v13, 0x20000, v5
    v_xor_b32 v28, 1, v27
    v_lshl_add_u32 v6, v28, 5, v29
    buffer_load_dwordx4 v38, s[20:23], s101 offen offset:2048 lds
    v_add_u32 v10, 0x10000, v6
    v_add_u32 v14, 0x20000, v6
    v_xor_b32 v28, 2, v27
    v_lshl_add_u32 v7, v28, 5, v29
    v_add_u32 v11, 0x10000, v7
    v_add_u32 v15, 0x20000, v7
    v_xor_b32 v28, 3, v27
    v_lshl_add_u32 v8, v28, 5, v29
    v_add_u32 v12, 0x10000, v8
    v_add_u32 v16, 0x20000, v8
    v_lshrrev_b32 v27, 4, v0
    v_lshlrev_b32 v27, 8, v27
    v_and_b32 v28, 15, v0
    v_lshl_add_u32 v17, v28, 3, v27
    s_mov_b32 s16, s78
    s_mov_b32 s17, s79
    s_mov_b32 s18, 33554432
    s_mov_b32 s19, 0x20000
    s_lshl_b32 s9, s88, 1
    s_add_u32 s9, s9, s10
    buffer_load_dwordx4 v39, s[20:23], s101 offen offset:3072 lds
    s_lshl_b32 s62, s88, 4
    s_add_u32 s62, s62, s99
    s_lshl_b32 s62, s62, 2
    s_add_u32 s62, s62, s8
    s_lshl_b32 s62, s62, 3
    s_add_u32 s62, s62, 25165824
    s_mul_i32 s100, s10, 3
    s_add_u32 s100, s100, s89
    s_add_u32 s100, s100, 16
    s_add_u32 s92, s99, 5
    s_and_b32 s92, s92, 15
    s_cmp_lt_u32 s92, 11
    s_cselect_b32 s100, s100, 31
    s_cselect_b32 s15, 1, 0
    s_mov_b32 s35, 0x20000
    s_cmp_lt_u32 s8, 2
    s_cselect_b32 s32, s84, s86
    s_cselect_b32 s33, s85, s87
    s_cmp_lt_u32 s99, 27
    s_cselect_b32 s34, 2211840, 0
    s_movk_i32 s36, 3456
    s_lshl_b32 s37, s99, 7
    s_mul_i32 s38, s90, 221184
    s_lshr_b32 s96, s99, 2
    s_mul_i32 s96, s96, 6
    s_add_u32 m0, s11, 16384
    s_sub_u32 s101, s101, 128
    s_cselect_b32 s101, 1152, s101
    buffer_load_dwordx4 v36, s[20:23], s101 offen offset:0 lds
    s_lshl_b32 s39, s99, 1
    s_add_u32 s96, s96, s39
    s_sub_u32 s97, s99, 16
    s_mul_i32 s97, s97, 21846
    s_lshr_b32 s97, s97, 16
    s_lshl_b32 s97, s97, 3
    s_add_u32 s97, s97, s39
    s_sub_u32 s97, s97, 24
    s_cmp_lt_u32 s99, 16
    s_cselect_b32 s39, s96, s97
    s_lshl_b32 s92, s88, 1
    s_lshr_b32 s93, s8, 1
    s_add_u32 s92, s92, s93
    s_mul_i32 s92, s92, 56
    s_add_u32 s39, s39, s92
    s_lshl_b32 s39, s39, 12
    s_and_b32 s93, s8, 1
    s_lshl_b32 s93, s93, 11
    s_add_u32 s39, s39, s93
    s_mov_b32 s43, 0x20000
    s_cmp_lt_u32 s8, 2
    s_cselect_b32 s40, s84, s86
    s_cselect_b32 s41, s85, s87
    buffer_load_dwordx4 v37, s[20:23], s101 offen offset:1024 lds
    s_cmp_lt_u32 s100, 27
    s_cselect_b32 s42, 2211840, 0
    s_movk_i32 s44, 3456
    s_lshl_b32 s45, s100, 7
    s_mul_i32 s46, s90, 221184
    s_lshr_b32 s96, s100, 2
    s_mul_i32 s96, s96, 6
    s_lshl_b32 s47, s100, 1
    s_add_u32 s96, s96, s47
    s_sub_u32 s97, s100, 16
    s_mul_i32 s97, s97, 21846
    s_lshr_b32 s97, s97, 16
    s_lshl_b32 s97, s97, 3
    s_add_u32 s97, s97, s47
    s_sub_u32 s97, s97, 24
    s_cmp_lt_u32 s100, 16
    s_cselect_b32 s47, s96, s97
    s_lshl_b32 s92, s88, 1
    s_lshr_b32 s93, s8, 1
    s_add_u32 s92, s92, s93
    s_mul_i32 s92, s92, 56
    s_add_u32 s47, s47, s92
    buffer_load_dwordx4 v38, s[20:23], s101 offen offset:2048 lds
    s_lshl_b32 s47, s47, 12
    s_and_b32 s93, s8, 1
    s_lshl_b32 s93, s93, 11
    s_add_u32 s47, s47, s93
    s_mov_b32 s51, 0x20000
    s_mov_b32 s94, 819200
    s_cmp_lt_u32 s2, 135
    s_cselect_b32 s48, s82, s80
    s_cselect_b32 s49, s83, s81
    s_cselect_b32 s50, 2211840, s94
    s_cselect_b32 s92, 0, 135
    s_sub_u32 s92, s2, s92
    s_mul_i32 s94, s92, 13108
    s_lshr_b32 s94, s94, 16
    s_mul_i32 s95, s94, 5
    s_sub_u32 s93, s92, s95
    s_mul_i32 s52, s94, 81920
    s_lshl_b32 s95, s93, 8
    s_add_u32 s52, s52, s95
    s_lshr_b32 s95, s8, 1
    s_lshl_b32 s95, s95, 7
    s_add_u32 s52, s52, s95
    s_lshr_b32 s96, s94, 2
    s_mul_i32 s96, s96, 6
    buffer_load_dwordx4 v39, s[20:23], s101 offen offset:3072 lds
    s_lshl_b32 s95, s94, 1
    s_add_u32 s96, s96, s95
    s_sub_u32 s97, s94, 16
    s_mul_i32 s97, s97, 21846
    s_lshr_b32 s97, s97, 16
    s_lshl_b32 s97, s97, 3
    s_add_u32 s97, s97, s95
    s_sub_u32 s97, s97, 24
    s_cmp_lt_u32 s94, 16
    s_cselect_b32 s95, s96, s97
    s_lshl_b32 s94, s94, 1
    s_mov_b32 s92, 13631488
    s_movk_i32 s98, 100
    s_cmp_lt_u32 s2, 135
    s_cselect_b32 s95, s95, s94
    s_cselect_b32 s92, 10485760, s92
    s_cselect_b32 s98, 280, s98
    s_and_b32 s94, s8, 1
    s_add_u32 s95, s95, s94
    s_mul_i32 s95, s95, 5120
    s_add_u32 s92, s92, s95
    s_cmp_lt_u32 s2, 185
    s_cselect_b32 s50, s50, 0
    s_cselect_b32 s92, s92, s3
    s_lshl_b32 s93, s93, 3
    s_and_b32 s94, s8, 2
    s_add_u32 m0, s11, 32768
    s_sub_u32 s101, s101, 128
    s_cselect_b32 s101, 1152, s101
    buffer_load_dwordx4 v36, s[20:23], s101 offen offset:0 lds
    s_lshl_b32 s94, s94, 1
    s_add_u32 s93, s93, s94
    s_sub_u32 s98, s98, 5
    s_add_u32 s94, s93, 0
    s_mul_i32 s95, s94, 13108
    s_lshr_b32 s95, s95, 16
    s_mul_i32 s95, s95, s98
    s_add_u32 s95, s95, s94
    s_lshl_b32 s95, s95, 10
    s_add_u32 s53, s95, s92
    s_add_u32 s94, s93, 1
    s_mul_i32 s95, s94, 13108
    s_lshr_b32 s95, s95, 16
    s_mul_i32 s95, s95, s98
    s_add_u32 s95, s95, s94
    s_lshl_b32 s95, s95, 10
    s_add_u32 s54, s95, s92
    s_add_u32 s94, s93, 2
    s_mul_i32 s95, s94, 13108
    s_lshr_b32 s95, s95, 16
    buffer_load_dwordx4 v37, s[20:23], s101 offen offset:1024 lds
    s_mul_i32 s95, s95, s98
    s_add_u32 s95, s95, s94
    s_lshl_b32 s95, s95, 10
    s_add_u32 s55, s95, s92
    s_add_u32 s94, s93, 3
    s_mul_i32 s95, s94, 13108
    s_lshr_b32 s95, s95, 16
    s_mul_i32 s95, s95, s98
    s_add_u32 s95, s95, s94
    s_lshl_b32 s95, s95, 10
    s_add_u32 s56, s95, s92
    s_cmp_lt_u32 s2, 135
    s_cselect_b32 s94, 0, 8
    s_cselect_b32 s95, 16, 8
    v_lshrrev_b32 v27, 2, v0
    v_lshrrev_b32 v28, 5, v0
    v_mad_u32_u24 v27, v28, s94, v27
    v_bfe_u32 v28, v27, 1, 1
    v_bfe_u32 v29, v27, 3, 1
    v_lshl_add_u32 v28, v29, 1, v28
    v_and_b32 v29, 3, v0
    v_lshlrev_b32 v29, 3, v29
    buffer_load_dwordx4 v38, s[20:23], s101 offen offset:2048 lds
    v_lshl_add_u32 v29, v27, 7, v29
    v_add_u32 v29, s11, v29
    v_xor_b32 v84, 0, v28
    v_lshl_add_u32 v84, v84, 5, v29
    v_xor_b32 v85, 1, v28
    v_lshl_add_u32 v85, v85, 5, v29
    v_xor_b32 v86, 2, v28
    v_lshl_add_u32 v86, v86, 5, v29
    v_xor_b32 v87, 3, v28
    v_lshl_add_u32 v87, v87, 5, v29
    v_add_u32 v27, s95, v27
    v_bfe_u32 v28, v27, 1, 1
    v_bfe_u32 v29, v27, 3, 1
    v_lshl_add_u32 v28, v29, 1, v28
    v_and_b32 v29, 3, v0
    v_lshlrev_b32 v29, 3, v29
    v_lshl_add_u32 v29, v27, 7, v29
    v_add_u32 v29, s11, v29
    v_xor_b32 v88, 0, v28
    v_lshl_add_u32 v88, v88, 5, v29
    buffer_load_dwordx4 v39, s[20:23], s101 offen offset:3072 lds
    v_xor_b32 v89, 1, v28
    v_lshl_add_u32 v89, v89, 5, v29
    v_xor_b32 v90, 2, v28
    v_lshl_add_u32 v90, v90, 5, v29
    v_xor_b32 v91, 3, v28
    v_lshl_add_u32 v91, v91, 5, v29
    v_mul_u32_u24 v80, 1280, v25
    v_add_u32 v80, v26, v80
    v_xor_b32 v81, 64, v80
    v_add_u32 v81, 9216, v81
    v_add_u32 v82, 18432, v80
    v_add_u32 v83, 18432, v81
    s_lshl_b32 s92, s2, 1
    s_and_b32 s93, s8, 1
    s_add_u32 s92, s92, s93
    s_mul_i32 s93, s92, 14
    v_add_u32 v27, s93, v0
    v_mul_u32_u24 v28, 95326, v27
    v_lshrrev_b32 v28, 20, v28
    v_mul_u32_u24 v28, 2048, v28
    s_add_u32 m0, s11, 49152
    s_sub_u32 s101, s101, 128
    s_cselect_b32 s101, 1152, s101
    buffer_load_dwordx4 v36, s[20:23], s101 offen offset:0 lds
    v_lshl_add_u32 v94, v27, 7, v28
    s_lshr_b32 s96, s2, 3
    s_and_b32 s96, s96, 3
    s_lshr_b32 s92, s89, 1
    s_add_u32 s91, s88, s92
    s_and_b32 s91, s91, 3
    s_lshl_b32 s92, s10, 2
    s_or_b32 s91, s91, s92
    s_and_b32 s92, s89, 1
    s_lshl_b32 s9, s88, 1
    s_add_u32 s9, s9, s92
    s_lshl_b32 s92, s92, 2
    s_lshl_b32 s10, 0x0f0f0f0f, s92
    s_mul_i32 s92, s8, 14
    s_mul_i32 s66, s9, 56
    s_add_u32 s66, s66, s92
    s_lshl_b32 s66, s66, 12
    s_mul_i32 s68, s91, 56
    s_add_u32 s68, s68, s92
    s_mul_i32 s68, s68, 5120
    buffer_load_dwordx4 v37, s[20:23], s101 offen offset:1024 lds
    s_add_u32 s68, s68, 10485760
    s_cmp_lt_u32 s8, 3
    s_cselect_b32 s67, s66, s3
    s_cselect_b32 s69, s68, s3
    s_mul_i32 s92, s9, 81920
    s_add_u32 s92, s92, 7864320
    s_mul_i32 s70, s8, 20480
    s_add_u32 s70, s70, s92
    s_mul_i32 s72, s91, 10
    s_add_u32 s72, s72, s8
    s_lshl_b32 s72, s72, 8
    s_add_u32 s72, s72, s92
    s_cmp_lt_u32 s8, 2
    s_cselect_b32 s73, s72, s3
    s_mul_i32 s71, s91, 102400
    s_add_u32 s71, s71, 13631488
    s_add_u32 s71, s71, s11
    s_lshl_b32 s74, s91, 2
    s_add_u32 s74, s74, s8
    s_mul_i32 s74, s74, 1280
    s_add_u32 s74, s74, 16777216
    s_lshl_b32 s75, s9, 2
    s_add_u32 s75, s75, s8
    buffer_load_dwordx4 v38, s[20:23], s101 offen offset:2048 lds
    s_mul_i32 s75, s75, 20480
    s_mul_i32 s92, s91, 160
    s_add_u32 s75, s75, s92
    s_lshl_b32 s63, s88, 9
    s_add_u32 s63, s63, 25165824
    s_max_u32 s64, s88, 1
    s_lshl_b32 s64, s64, 9
    s_add_u32 s64, s64, 25165312
    s_lshl_b32 s65, s8, 11
    s_add_u32 s65, s65, 25165824
    s_lshl_b32 s92, s9, 1
    v_lshrrev_b32 v28, 5, v0
    v_add_u32 v28, s92, v28
    v_mul_u32_u24 v28, 122880, v28
    v_and_b32 v29, 31, v0
    v_lshl_add_u32 v28, v29, 3, v28
    v_add_u32 v29, 8, v0
    v_lshrrev_b32 v27, 4, v29
    v_add_u32 v27, s92, v27
    v_max_u32 v27, 1, v27
    buffer_load_dwordx4 v39, s[20:23], s101 offen offset:3072 lds
    v_subrev_u32 v27, 1, v27
    v_mul_u32_u24 v27, 122880, v27
    v_and_b32 v29, 15, v29
    v_lshl_add_u32 v29, v29, 4, v27
    s_waitcnt vmcnt(12)
    ds_read_b128 v[96:99], v40 offset:0
    ds_read_b128 v[100:103], v40 offset:2048
    ds_read_b128 v[104:107], v41 offset:0
    ds_read_b128 v[108:111], v41 offset:2048
    s_add_u32 m0, s11, 65536
    s_sub_u32 s101, s101, 128
    s_cselect_b32 s101, 1152, s101
    buffer_load_dwordx4 v36, s[20:23], s101 offen offset:0 lds
    buffer_load_dwordx4 v37, s[20:23], s101 offen offset:1024 lds
    buffer_load_dwordx4 v38, s[20:23], s101 offen offset:2048 lds
    buffer_load_dwordx4 v39, s[20:23], s101 offen offset:3072 lds
    s_waitcnt lgkmcnt(0)
    s_waitcnt vmcnt(12)
    ds_read_b128 v[112:115], v40 offset:16384
    ds_read_b128 v[116:119], v40 offset:18432
    ds_read_b128 v[120:123], v41 offset:16384
    ds_read_b128 v[124:127], v41 offset:18432
    s_add_u32 m0, s11, 0
    s_sub_u32 s101, s101, 128
    s_cselect_b32 s101, 1152, s101
    buffer_load_dwordx4 v36, s[20:23], s101 offen offset:0 lds
    v_dot2c_f32_bf16 v56, s57, v96
    v_dot2c_f32_bf16 v58, v96, v96
    v_dot2c_f32_bf16 v56, s57, v97
    v_dot2c_f32_bf16 v58, v97, v97
    v_dot2c_f32_bf16 v56, s57, v98
    v_dot2c_f32_bf16 v58, v98, v98
    v_dot2c_f32_bf16 v56, s57, v99
    v_dot2c_f32_bf16 v58, v99, v99
    buffer_load_dwordx4 v37, s[20:23], s101 offen offset:1024 lds
    v_dot2c_f32_bf16 v57, s57, v100
    v_dot2c_f32_bf16 v59, v100, v100
    v_dot2c_f32_bf16 v57, s57, v101
    v_dot2c_f32_bf16 v59, v101, v101
    v_dot2c_f32_bf16 v57, s57, v102
    v_dot2c_f32_bf16 v59, v102, v102
    v_dot2c_f32_bf16 v57, s57, v103
    v_dot2c_f32_bf16 v59, v103, v103
    buffer_load_dwordx4 v38, s[20:23], s101 offen offset:2048 lds
    v_dot2c_f32_bf16 v56, s57, v104
    v_dot2c_f32_bf16 v58, v104, v104
    v_dot2c_f32_bf16 v56, s57, v105
    v_dot2c_f32_bf16 v58, v105, v105
    v_dot2c_f32_bf16 v56, s57, v106
    v_dot2c_f32_bf16 v58, v106, v106
    v_dot2c_f32_bf16 v56, s57, v107
    v_dot2c_f32_bf16 v58, v107, v107
    buffer_load_dwordx4 v39, s[20:23], s101 offen offset:3072 lds
    v_dot2c_f32_bf16 v57, s57, v108
    v_dot2c_f32_bf16 v59, v108, v108
    v_dot2c_f32_bf16 v57, s57, v109
    v_dot2c_f32_bf16 v59, v109, v109
    v_dot2c_f32_bf16 v57, s57, v110
    v_dot2c_f32_bf16 v59, v110, v110
    v_dot2c_f32_bf16 v57, s57, v111
    v_dot2c_f32_bf16 v59, v111, v111
    s_waitcnt lgkmcnt(0)
    s_waitcnt vmcnt(12)
    ds_read_b128 v[128:131], v40 offset:32768
    ds_read_b128 v[132:135], v40 offset:34816
    ds_read_b128 v[136:139], v41 offset:32768
    ds_read_b128 v[140:143], v41 offset:34816
    s_add_u32 m0, s11, 16384
    s_sub_u32 s101, s101, 128
    s_cselect_b32 s101, 1152, s101
    buffer_load_dwordx4 v36, s[20:23], s101 offen offset:0 lds
    v_dot2c_f32_bf16 v56, s57, v112
    v_dot2c_f32_bf16 v58, v112, v112
    v_dot2c_f32_bf16 v56, s57, v113
    v_dot2c_f32_bf16 v58, v113, v113
    v_dot2c_f32_bf16 v56, s57, v114
    v_dot2c_f32_bf16 v58, v114, v114
    v_dot2c_f32_bf16 v56, s57, v115
    v_dot2c_f32_bf16 v58, v115, v115
    buffer_load_dwordx4 v37, s[20:23], s101 offen offset:1024 lds
    v_dot2c_f32_bf16 v57, s57, v116
    v_dot2c_f32_bf16 v59, v116, v116
    v_dot2c_f32_bf16 v57, s57, v117
    v_dot2c_f32_bf16 v59, v117, v117
    v_dot2c_f32_bf16 v57, s57, v118
    v_dot2c_f32_bf16 v59, v118, v118
    v_dot2c_f32_bf16 v57, s57, v119
    v_dot2c_f32_bf16 v59, v119, v119
    buffer_load_dwordx4 v38, s[20:23], s101 offen offset:2048 lds
    v_dot2c_f32_bf16 v56, s57, v120
    v_dot2c_f32_bf16 v58, v120, v120
    v_dot2c_f32_bf16 v56, s57, v121
    v_dot2c_f32_bf16 v58, v121, v121
    v_dot2c_f32_bf16 v56, s57, v122
    v_dot2c_f32_bf16 v58, v122, v122
    v_dot2c_f32_bf16 v56, s57, v123
    v_dot2c_f32_bf16 v58, v123, v123
    buffer_load_dwordx4 v39, s[20:23], s101 offen offset:3072 lds
    v_dot2c_f32_bf16 v57, s57, v124
    v_dot2c_f32_bf16 v59, v124, v124
    v_dot2c_f32_bf16 v57, s57, v125
    v_dot2c_f32_bf16 v59, v125, v125
    v_dot2c_f32_bf16 v57, s57, v126
    v_dot2c_f32_bf16 v59, v126, v126
    v_dot2c_f32_bf16 v57, s57, v127
    v_dot2c_f32_bf16 v59, v127, v127
    s_waitcnt lgkmcnt(0)
    s_waitcnt vmcnt(12)
    ds_read_b128 v[144:147], v40 offset:49152
    ds_read_b128 v[148:151], v40 offset:51200
    ds_read_b128 v[152:155], v41 offset:49152
    ds_read_b128 v[156:159], v41 offset:51200
    s_add_u32 m0, s11, 32768
    s_sub_u32 s101, s101, 128
    s_cselect_b32 s101, 1152, s101
    buffer_load_dwordx4 v36, s[20:23], s101 offen offset:0 lds
    v_dot2c_f32_bf16 v56, s57, v128
    v_dot2c_f32_bf16 v58, v128, v128
    v_dot2c_f32_bf16 v56, s57, v129
    v_dot2c_f32_bf16 v58, v129, v129
    v_dot2c_f32_bf16 v56, s57, v130
    v_dot2c_f32_bf16 v58, v130, v130
    v_dot2c_f32_bf16 v56, s57, v131
    v_dot2c_f32_bf16 v58, v131, v131
    buffer_load_dwordx4 v37, s[20:23], s101 offen offset:1024 lds
    v_dot2c_f32_bf16 v57, s57, v132
    v_dot2c_f32_bf16 v59, v132, v132
    v_dot2c_f32_bf16 v57, s57, v133
    v_dot2c_f32_bf16 v59, v133, v133
    v_dot2c_f32_bf16 v57, s57, v134
    v_dot2c_f32_bf16 v59, v134, v134
    v_dot2c_f32_bf16 v57, s57, v135
    v_dot2c_f32_bf16 v59, v135, v135
    buffer_load_dwordx4 v38, s[20:23], s101 offen offset:2048 lds
    v_dot2c_f32_bf16 v56, s57, v136
    v_dot2c_f32_bf16 v58, v136, v136
    v_dot2c_f32_bf16 v56, s57, v137
    v_dot2c_f32_bf16 v58, v137, v137
    v_dot2c_f32_bf16 v56, s57, v138
    v_dot2c_f32_bf16 v58, v138, v138
    v_dot2c_f32_bf16 v56, s57, v139
    v_dot2c_f32_bf16 v58, v139, v139
    buffer_load_dwordx4 v39, s[20:23], s101 offen offset:3072 lds
    v_dot2c_f32_bf16 v57, s57, v140
    v_dot2c_f32_bf16 v59, v140, v140
    v_dot2c_f32_bf16 v57, s57, v141
    v_dot2c_f32_bf16 v59, v141, v141
    v_dot2c_f32_bf16 v57, s57, v142
    v_dot2c_f32_bf16 v59, v142, v142
    v_dot2c_f32_bf16 v57, s57, v143
    v_dot2c_f32_bf16 v59, v143, v143
    s_waitcnt lgkmcnt(0)
    s_waitcnt vmcnt(12)
    ds_read_b128 v[160:163], v44 offset:0
    ds_read_b128 v[164:167], v44 offset:2048
    ds_read_b128 v[168:171], v45 offset:0
    ds_read_b128 v[172:175], v45 offset:2048
    s_add_u32 m0, s11, 49152
    s_sub_u32 s101, s101, 128
    s_cselect_b32 s101, 1152, s101
    buffer_load_dwordx4 v36, s[20:23], s101 offen offset:0 lds
    v_dot2c_f32_bf16 v56, s57, v144
    v_dot2c_f32_bf16 v58, v144, v144
    v_dot2c_f32_bf16 v56, s57, v145
    v_dot2c_f32_bf16 v58, v145, v145
    v_dot2c_f32_bf16 v56, s57, v146
    v_dot2c_f32_bf16 v58, v146, v146
    v_dot2c_f32_bf16 v56, s57, v147
    v_dot2c_f32_bf16 v58, v147, v147
    buffer_load_dwordx4 v37, s[20:23], s101 offen offset:1024 lds
    v_dot2c_f32_bf16 v57, s57, v148
    v_dot2c_f32_bf16 v59, v148, v148
    v_dot2c_f32_bf16 v57, s57, v149
    v_dot2c_f32_bf16 v59, v149, v149
    v_dot2c_f32_bf16 v57, s57, v150
    v_dot2c_f32_bf16 v59, v150, v150
    v_dot2c_f32_bf16 v57, s57, v151
    v_dot2c_f32_bf16 v59, v151, v151
    buffer_load_dwordx4 v38, s[20:23], s101 offen offset:2048 lds
    v_dot2c_f32_bf16 v56, s57, v152
    v_dot2c_f32_bf16 v58, v152, v152
    v_dot2c_f32_bf16 v56, s57, v153
    v_dot2c_f32_bf16 v58, v153, v153
    v_dot2c_f32_bf16 v56, s57, v154
    v_dot2c_f32_bf16 v58, v154, v154
    v_dot2c_f32_bf16 v56, s57, v155
    v_dot2c_f32_bf16 v58, v155, v155
    buffer_load_dwordx4 v39, s[20:23], s101 offen offset:3072 lds
    v_dot2c_f32_bf16 v57, s57, v156
    v_dot2c_f32_bf16 v59, v156, v156
    v_dot2c_f32_bf16 v57, s57, v157
    v_dot2c_f32_bf16 v59, v157, v157
    v_dot2c_f32_bf16 v57, s57, v158
    v_dot2c_f32_bf16 v59, v158, v158
    v_dot2c_f32_bf16 v57, s57, v159
    v_dot2c_f32_bf16 v59, v159, v159
    s_waitcnt lgkmcnt(0)
    s_waitcnt vmcnt(12)
    ds_read_b128 v[176:179], v40 offset:0
    ds_read_b128 v[180:183], v40 offset:2048
    ds_read_b128 v[184:187], v41 offset:0
    ds_read_b128 v[188:191], v41 offset:2048
    s_add_u32 m0, s11, 65536
    s_sub_u32 s101, s101, 128
    s_cselect_b32 s101, 1152, s101
    buffer_load_dwordx4 v36, s[20:23], s101 offen offset:0 lds
    v_dot2c_f32_bf16 v56, s57, v160
    v_dot2c_f32_bf16 v58, v160, v160
    v_dot2c_f32_bf16 v56, s57, v161
    v_dot2c_f32_bf16 v58, v161, v161
    v_dot2c_f32_bf16 v56, s57, v162
    v_dot2c_f32_bf16 v58, v162, v162
    v_dot2c_f32_bf16 v56, s57, v163
    v_dot2c_f32_bf16 v58, v163, v163
    buffer_load_dwordx4 v37, s[20:23], s101 offen offset:1024 lds
    v_dot2c_f32_bf16 v57, s57, v164
    v_dot2c_f32_bf16 v59, v164, v164
    v_dot2c_f32_bf16 v57, s57, v165
    v_dot2c_f32_bf16 v59, v165, v165
    v_dot2c_f32_bf16 v57, s57, v166
    v_dot2c_f32_bf16 v59, v166, v166
    v_dot2c_f32_bf16 v57, s57, v167
    v_dot2c_f32_bf16 v59, v167, v167
    buffer_load_dwordx4 v38, s[20:23], s101 offen offset:2048 lds
    v_dot2c_f32_bf16 v56, s57, v168
    v_dot2c_f32_bf16 v58, v168, v168
    v_dot2c_f32_bf16 v56, s57, v169
    v_dot2c_f32_bf16 v58, v169, v169
    v_dot2c_f32_bf16 v56, s57, v170
    v_dot2c_f32_bf16 v58, v170, v170
    v_dot2c_f32_bf16 v56, s57, v171
    v_dot2c_f32_bf16 v58, v171, v171
    buffer_load_dwordx4 v39, s[20:23], s101 offen offset:3072 lds
    v_dot2c_f32_bf16 v57, s57, v172
    v_dot2c_f32_bf16 v59, v172, v172
    v_dot2c_f32_bf16 v57, s57, v173
    v_dot2c_f32_bf16 v59, v173, v173
    v_dot2c_f32_bf16 v57, s57, v174
    v_dot2c_f32_bf16 v59, v174, v174
    v_dot2c_f32_bf16 v57, s57, v175
    v_dot2c_f32_bf16 v59, v175, v175
    s_waitcnt lgkmcnt(0)
    s_waitcnt vmcnt(12)
    ds_read_b128 v[192:195], v40 offset:16384
    ds_read_b128 v[196:199], v40 offset:18432
    ds_read_b128 v[200:203], v41 offset:16384
    ds_read_b128 v[204:207], v41 offset:18432
    s_add_u32 m0, s11, 0
    s_nop 0
    buffer_load_dwordx4 v1, s[24:27], s12 offen offset:0 lds
    v_dot2c_f32_bf16 v56, s57, v176
    v_dot2c_f32_bf16 v58, v176, v176
    v_dot2c_f32_bf16 v56, s57, v177
    v_dot2c_f32_bf16 v58, v177, v177
    v_dot2c_f32_bf16 v56, s57, v178
    v_dot2c_f32_bf16 v58, v178, v178
    v_dot2c_f32_bf16 v56, s57, v179
    v_dot2c_f32_bf16 v58, v179, v179
    buffer_load_dwordx4 v2, s[24:27], s12 offen offset:1024 lds
    v_dot2c_f32_bf16 v57, s57, v180
    v_dot2c_f32_bf16 v59, v180, v180
    v_dot2c_f32_bf16 v57, s57, v181
    v_dot2c_f32_bf16 v59, v181, v181
    v_dot2c_f32_bf16 v57, s57, v182
    v_dot2c_f32_bf16 v59, v182, v182
    v_dot2c_f32_bf16 v57, s57, v183
    v_dot2c_f32_bf16 v59, v183, v183
    buffer_load_dwordx4 v3, s[24:27], s12 offen offset:2048 lds
    v_dot2c_f32_bf16 v56, s57, v184
    v_dot2c_f32_bf16 v58, v184, v184
    v_dot2c_f32_bf16 v56, s57, v185
    v_dot2c_f32_bf16 v58, v185, v185
    v_dot2c_f32_bf16 v56, s57, v186
    v_dot2c_f32_bf16 v58, v186, v186
    v_dot2c_f32_bf16 v56, s57, v187
    v_dot2c_f32_bf16 v58, v187, v187
    buffer_load_dwordx4 v4, s[24:27], s12 offen offset:3072 lds
    v_dot2c_f32_bf16 v57, s57, v188
    v_dot2c_f32_bf16 v59, v188, v188
    v_dot2c_f32_bf16 v57, s57, v189
    v_dot2c_f32_bf16 v59, v189, v189
    v_dot2c_f32_bf16 v57, s57, v190
    v_dot2c_f32_bf16 v59, v190, v190
    v_dot2c_f32_bf16 v57, s57, v191
    v_dot2c_f32_bf16 v59, v191, v191
    s_waitcnt lgkmcnt(0)
    s_waitcnt vmcnt(12)
    ds_read_b128 v[208:211], v40 offset:32768
    ds_read_b128 v[212:215], v40 offset:34816
    ds_read_b128 v[216:219], v41 offset:32768
    ds_read_b128 v[220:223], v41 offset:34816
    s_add_u32 m0, s11, 16384
    s_sub_u32 s12, s12, s13
    s_cselect_b32 s12, s14, s12
    buffer_load_dwordx4 v1, s[24:27], s12 offen offset:0 lds
    v_dot2c_f32_bf16 v56, s57, v192
    v_dot2c_f32_bf16 v58, v192, v192
    v_dot2c_f32_bf16 v56, s57, v193
    v_dot2c_f32_bf16 v58, v193, v193
    v_dot2c_f32_bf16 v56, s57, v194
    v_dot2c_f32_bf16 v58, v194, v194
    v_dot2c_f32_bf16 v56, s57, v195
    v_dot2c_f32_bf16 v58, v195, v195
    buffer_load_dwordx4 v2, s[24:27], s12 offen offset:1024 lds
    v_dot2c_f32_bf16 v57, s57, v196
    v_dot2c_f32_bf16 v59, v196, v196
    v_dot2c_f32_bf16 v57, s57, v197
    v_dot2c_f32_bf16 v59, v197, v197
    v_dot2c_f32_bf16 v57, s57, v198
    v_dot2c_f32_bf16 v59, v198, v198
    v_dot2c_f32_bf16 v57, s57, v199
    v_dot2c_f32_bf16 v59, v199, v199
    buffer_load_dwordx4 v3, s[24:27], s12 offen offset:2048 lds
    v_dot2c_f32_bf16 v56, s57, v200
    v_dot2c_f32_bf16 v58, v200, v200
    v_dot2c_f32_bf16 v56, s57, v201
    v_dot2c_f32_bf16 v58, v201, v201
    v_dot2c_f32_bf16 v56, s57, v202
    v_dot2c_f32_bf16 v58, v202, v202
    v_dot2c_f32_bf16 v56, s57, v203
    v_dot2c_f32_bf16 v58, v203, v203
    buffer_load_dwordx4 v4, s[24:27], s12 offen offset:3072 lds
    v_dot2c_f32_bf16 v57, s57, v204
    v_dot2c_f32_bf16 v59, v204, v204
    v_dot2c_f32_bf16 v57, s57, v205
    v_dot2c_f32_bf16 v59, v205, v205
    v_dot2c_f32_bf16 v57, s57, v206
    v_dot2c_f32_bf16 v59, v206, v206
    v_dot2c_f32_bf16 v57, s57, v207
    v_dot2c_f32_bf16 v59, v207, v207
    s_waitcnt lgkmcnt(0)
    s_waitcnt vmcnt(12)
    ds_read_b128 v[224:227], v40 offset:49152
    ds_read_b128 v[228:231], v40 offset:51200
    ds_read_b128 v[232:235], v41 offset:49152
    ds_read_b128 v[236:239], v41 offset:51200
    v_dot2c_f32_bf16 v56, s57, v208
    v_dot2c_f32_bf16 v58, v208, v208
    v_dot2c_f32_bf16 v56, s57, v209
    v_dot2c_f32_bf16 v58, v209, v209
    v_dot2c_f32_bf16 v56, s57, v210
    v_dot2c_f32_bf16 v58, v210, v210
    v_dot2c_f32_bf16 v56, s57, v211
    v_dot2c_f32_bf16 v58, v211, v211
    v_dot2c_f32_bf16 v57, s57, v212
    v_dot2c_f32_bf16 v59, v212, v212
    v_dot2c_f32_bf16 v57, s57, v213
    v_dot2c_f32_bf16 v59, v213, v213
    v_dot2c_f32_bf16 v57, s57, v214
    v_dot2c_f32_bf16 v59, v214, v214
    v_dot2c_f32_bf16 v57, s57, v215
    v_dot2c_f32_bf16 v59, v215, v215
    v_dot2c_f32_bf16 v56, s57, v216
    v_dot2c_f32_bf16 v58, v216, v216
    v_dot2c_f32_bf16 v56, s57, v217
    v_dot2c_f32_bf16 v58, v217, v217
    v_dot2c_f32_bf16 v56, s57, v218
    v_dot2c_f32_bf16 v58, v218, v218
    v_dot2c_f32_bf16 v56, s57, v219
    v_dot2c_f32_bf16 v58, v219, v219
    v_dot2c_f32_bf16 v57, s57, v220
    v_dot2c_f32_bf16 v59, v220, v220
    v_dot2c_f32_bf16 v57, s57, v221
    v_dot2c_f32_bf16 v59, v221, v221
    v_dot2c_f32_bf16 v57, s57, v222
    v_dot2c_f32_bf16 v59, v222, v222
    v_dot2c_f32_bf16 v57, s57, v223
    v_dot2c_f32_bf16 v59, v223, v223
    s_waitcnt lgkmcnt(0)
    s_waitcnt vmcnt(8)
    ds_read_b128 v[240:243], v44 offset:0
    ds_read_b128 v[244:247], v44 offset:2048
    ds_read_b128 v[248:251], v45 offset:0
    ds_read_b128 v[252:255], v45 offset:2048
    v_dot2c_f32_bf16 v56, s57, v224
    v_dot2c_f32_bf16 v58, v224, v224
    v_dot2c_f32_bf16 v56, s57, v225
    v_dot2c_f32_bf16 v58, v225, v225
    v_dot2c_f32_bf16 v56, s57, v226
    v_dot2c_f32_bf16 v58, v226, v226
    v_dot2c_f32_bf16 v56, s57, v227
    v_dot2c_f32_bf16 v58, v227, v227
    v_dot2c_f32_bf16 v57, s57, v228
    v_dot2c_f32_bf16 v59, v228, v228
    v_dot2c_f32_bf16 v57, s57, v229
    v_dot2c_f32_bf16 v59, v229, v229
    v_dot2c_f32_bf16 v57, s57, v230
    v_dot2c_f32_bf16 v59, v230, v230
    v_dot2c_f32_bf16 v57, s57, v231
    v_dot2c_f32_bf16 v59, v231, v231
    v_dot2c_f32_bf16 v56, s57, v232
    v_dot2c_f32_bf16 v58, v232, v232
    v_dot2c_f32_bf16 v56, s57, v233
    v_dot2c_f32_bf16 v58, v233, v233
    v_dot2c_f32_bf16 v56, s57, v234
    v_dot2c_f32_bf16 v58, v234, v234
    v_dot2c_f32_bf16 v56, s57, v235
    v_dot2c_f32_bf16 v58, v235, v235
    v_dot2c_f32_bf16 v57, s57, v236
    v_dot2c_f32_bf16 v59, v236, v236
    v_dot2c_f32_bf16 v57, s57, v237
    v_dot2c_f32_bf16 v59, v237, v237
    v_dot2c_f32_bf16 v57, s57, v238
    v_dot2c_f32_bf16 v59, v238, v238
    v_dot2c_f32_bf16 v57, s57, v239
    v_dot2c_f32_bf16 v59, v239, v239
    s_waitcnt lgkmcnt(0)
    s_xor_b32 s61, s61, 0x5bd1e995
    s_add_u32 s60, s60, 1
    v_dot2c_f32_bf16 v56, s57, v240
    v_dot2c_f32_bf16 v58, v240, v240
    v_dot2c_f32_bf16 v56, s57, v241
    v_dot2c_f32_bf16 v58, v241, v241
    v_dot2c_f32_bf16 v56, s57, v242
    v_dot2c_f32_bf16 v58, v242, v242
    v_dot2c_f32_bf16 v56, s57, v243
    v_dot2c_f32_bf16 v58, v243, v243
    v_dot2c_f32_bf16 v57, s57, v244
    v_dot2c_f32_bf16 v59, v244, v244
    v_dot2c_f32_bf16 v57, s57, v245
    v_dot2c_f32_bf16 v59, v245, v245
    v_dot2c_f32_bf16 v57, s57, v246
    v_dot2c_f32_bf16 v59, v246, v246
    v_dot2c_f32_bf16 v57, s57, v247
    v_dot2c_f32_bf16 v59, v247, v247
    v_dot2c_f32_bf16 v56, s57, v248
    v_dot2c_f32_bf16 v58, v248, v248
    v_dot2c_f32_bf16 v56, s57, v249
    v_dot2c_f32_bf16 v58, v249, v249
    v_dot2c_f32_bf16 v56, s57, v250
    v_dot2c_f32_bf16 v58, v250, v250
    v_dot2c_f32_bf16 v56, s57, v251
    v_dot2c_f32_bf16 v58, v251, v251
    v_dot2c_f32_bf16 v57, s57, v252
    v_dot2c_f32_bf16 v59, v252, v252
    v_dot2c_f32_bf16 v57, s57, v253
    v_dot2c_f32_bf16 v59, v253, v253
    v_dot2c_f32_bf16 v57, s57, v254
    v_dot2c_f32_bf16 v59, v254, v254
    v_dot2c_f32_bf16 v57, s57, v255
    v_dot2c_f32_bf16 v59, v255, v255
    s_nop 2
    v_mov_b64 v[60:61], v[56:57]
    v_mov_b64 v[62:63], v[58:59]
    s_nop 0
    v_permlane16_swap_b32 v56, v60
    v_permlane16_swap_b32 v57, v61
    v_permlane16_swap_b32 v58, v62
    v_permlane16_swap_b32 v59, v63
    s_nop 0
    v_pk_add_f32 v[56:57], v[56:57], v[60:61]
    v_pk_add_f32 v[58:59], v[58:59], v[62:63]
    v_mov_b64 v[60:61], v[56:57]
    v_mov_b64 v[62:63], v[58:59]
    s_nop 0
    v_permlane32_swap_b32 v56, v60
    v_permlane32_swap_b32 v57, v61
    v_permlane32_swap_b32 v58, v62
    v_permlane32_swap_b32 v59, v63
    s_nop 0
    v_pk_add_f32 v[56:57], v[56:57], v[60:61]
    v_pk_add_f32 v[58:59], v[58:59], v[62:63]
    v_mul_f32 v56, 0x3acccccd, v56
    v_mul_f32 v57, 0x3acccccd, v57
    v_mul_f32 v58, 0x3acccccd, v58
    v_mul_f32 v59, 0x3acccccd, v59
    v_cvt_pk_bf16_f32 v92, 0, -v56
    v_cvt_pk_bf16_f32 v93, 0, -v57
    v_fma_f32 v19, -v56, v56, v58
    v_fma_f32 v24, -v57, v57, v59
    v_dot2_f32_bf16 v32, v96, s58, v92
    s_add_u32 m0, s11, 32768
    s_sub_u32 s12, s12, s13
    s_cselect_b32 s12, s14, s12
    buffer_load_dwordx4 v1, s[24:27], s12 offen offset:0 lds
    v_dot2_f32_bf16 v33, v96, s59, v92
    v_dot2_f32_bf16 v34, v97, s58, v92
    v_dot2_f32_bf16 v35, v97, s59, v92
    v_dot2_f32_bf16 v36, v98, s58, v92
    v_dot2_f32_bf16 v37, v98, s59, v92
    v_dot2_f32_bf16 v38, v99, s58, v92
    v_dot2_f32_bf16 v39, v99, s59, v92
    v_dot2_f32_bf16 v40, v100, s58, v93
    v_dot2_f32_bf16 v41, v100, s59, v93
    v_dot2_f32_bf16 v42, v101, s58, v93
    v_dot2_f32_bf16 v43, v101, s59, v93
    v_dot2_f32_bf16 v44, v102, s58, v93
    buffer_load_dwordx4 v2, s[24:27], s12 offen offset:1024 lds
    v_dot2_f32_bf16 v45, v102, s59, v93
    v_dot2_f32_bf16 v46, v103, s58, v93
    v_dot2_f32_bf16 v47, v103, s59, v93
    v_dot2_f32_bf16 v48, v104, s58, v92
    v_dot2_f32_bf16 v49, v104, s59, v92
    v_dot2_f32_bf16 v50, v105, s58, v92
    v_dot2_f32_bf16 v51, v105, s59, v92
    v_dot2_f32_bf16 v52, v106, s58, v92
    v_dot2_f32_bf16 v53, v106, s59, v92
    v_dot2_f32_bf16 v54, v107, s58, v92
    v_dot2_f32_bf16 v55, v107, s59, v92
    v_dot2_f32_bf16 v56, v108, s58, v93
    buffer_load_dwordx4 v3, s[24:27], s12 offen offset:2048 lds
    v_dot2_f32_bf16 v57, v108, s59, v93
    v_dot2_f32_bf16 v58, v109, s58, v93
    v_dot2_f32_bf16 v59, v109, s59, v93
    v_dot2_f32_bf16 v60, v110, s58, v93
    v_dot2_f32_bf16 v61, v110, s59, v93
    v_dot2_f32_bf16 v62, v111, s58, v93
    v_dot2_f32_bf16 v63, v111, s59, v93
    v_cvt_pk_bf16_f32 v96, v32, v33
    v_cvt_pk_bf16_f32 v97, v34, v35
    v_cvt_pk_bf16_f32 v98, v36, v37
    v_cvt_pk_bf16_f32 v99, v38, v39
    v_cvt_pk_bf16_f32 v100, v40, v41
    buffer_load_dwordx4 v4, s[24:27], s12 offen offset:3072 lds
    v_cvt_pk_bf16_f32 v101, v42, v43
    v_cvt_pk_bf16_f32 v102, v44, v45
    v_cvt_pk_bf16_f32 v103, v46, v47
    v_cvt_pk_bf16_f32 v104, v48, v49
    v_cvt_pk_bf16_f32 v105, v50, v51
    v_cvt_pk_bf16_f32 v106, v52, v53
    v_cvt_pk_bf16_f32 v107, v54, v55
    v_cvt_pk_bf16_f32 v108, v56, v57
    v_cvt_pk_bf16_f32 v109, v58, v59
    v_cvt_pk_bf16_f32 v110, v60, v61
    v_cvt_pk_bf16_f32 v111, v62, v63
    v_dot2_f32_bf16 v32, v112, s58, v92
    s_add_u32 m0, s11, 49152
    s_sub_u32 s12, s12, s13
    s_cselect_b32 s12, s14, s12
    buffer_load_dwordx4 v1, s[24:27], s12 offen offset:0 lds
    v_dot2_f32_bf16 v33, v112, s59, v92
    v_dot2_f32_bf16 v34, v113, s58, v92
    v_dot2_f32_bf16 v35, v113, s59, v92
    v_dot2_f32_bf16 v36, v114, s58, v92
    v_dot2_f32_bf16 v37, v114, s59, v92
    v_dot2_f32_bf16 v38, v115, s58, v92
    v_dot2_f32_bf16 v39, v115, s59, v92
    v_dot2_f32_bf16 v40, v116, s58, v93
    v_dot2_f32_bf16 v41, v116, s59, v93
    v_dot2_f32_bf16 v42, v117, s58, v93
    v_dot2_f32_bf16 v43, v117, s59, v93
    v_dot2_f32_bf16 v44, v118, s58, v93
    buffer_load_dwordx4 v2, s[24:27], s12 offen offset:1024 lds
    v_dot2_f32_bf16 v45, v118, s59, v93
    v_dot2_f32_bf16 v46, v119, s58, v93
    v_dot2_f32_bf16 v47, v119, s59, v93
    v_dot2_f32_bf16 v48, v120, s58, v92
    v_dot2_f32_bf16 v49, v120, s59, v92
    v_dot2_f32_bf16 v50, v121, s58, v92
    v_dot2_f32_bf16 v51, v121, s59, v92
    v_dot2_f32_bf16 v52, v122, s58, v92
    v_dot2_f32_bf16 v53, v122, s59, v92
    v_dot2_f32_bf16 v54, v123, s58, v92
    v_dot2_f32_bf16 v55, v123, s59, v92
    v_dot2_f32_bf16 v56, v124, s58, v93
    buffer_load_dwordx4 v3, s[24:27], s12 offen offset:2048 lds
    v_dot2_f32_bf16 v57, v124, s59, v93
    v_dot2_f32_bf16 v58, v125, s58, v93
    v_dot2_f32_bf16 v59, v125, s59, v93
    v_dot2_f32_bf16 v60, v126, s58, v93
    v_dot2_f32_bf16 v61, v126, s59, v93
    v_dot2_f32_bf16 v62, v127, s58, v93
    v_dot2_f32_bf16 v63, v127, s59, v93
    v_cvt_pk_bf16_f32 v112, v32, v33
    v_cvt_pk_bf16_f32 v113, v34, v35
    v_cvt_pk_bf16_f32 v114, v36, v37
    v_cvt_pk_bf16_f32 v115, v38, v39
    v_cvt_pk_bf16_f32 v116, v40, v41
    buffer_load_dwordx4 v4, s[24:27], s12 offen offset:3072 lds
    v_cvt_pk_bf16_f32 v117, v42, v43
    v_cvt_pk_bf16_f32 v118, v44, v45
    v_cvt_pk_bf16_f32 v119, v46, v47
    v_cvt_pk_bf16_f32 v120, v48, v49
    v_cvt_pk_bf16_f32 v121, v50, v51
    v_cvt_pk_bf16_f32 v122, v52, v53
    v_cvt_pk_bf16_f32 v123, v54, v55
    v_cvt_pk_bf16_f32 v124, v56, v57
    v_cvt_pk_bf16_f32 v125, v58, v59
    v_cvt_pk_bf16_f32 v126, v60, v61
    v_cvt_pk_bf16_f32 v127, v62, v63
    v_dot2_f32_bf16 v32, v128, s58, v92
    v_dot2_f32_bf16 v33, v128, s59, v92
    v_dot2_f32_bf16 v34, v129, s58, v92
    v_dot2_f32_bf16 v35, v129, s59, v92
    v_dot2_f32_bf16 v36, v130, s58, v92
    v_dot2_f32_bf16 v37, v130, s59, v92
    v_dot2_f32_bf16 v38, v131, s58, v92
    v_dot2_f32_bf16 v39, v131, s59, v92
    v_dot2_f32_bf16 v40, v132, s58, v93
    v_dot2_f32_bf16 v41, v132, s59, v93
    v_dot2_f32_bf16 v42, v133, s58, v93
    v_dot2_f32_bf16 v43, v133, s59, v93
    v_dot2_f32_bf16 v44, v134, s58, v93
    v_dot2_f32_bf16 v45, v134, s59, v93
    v_dot2_f32_bf16 v46, v135, s58, v93
    v_dot2_f32_bf16 v47, v135, s59, v93
    v_dot2_f32_bf16 v48, v136, s58, v92
    v_dot2_f32_bf16 v49, v136, s59, v92
    v_dot2_f32_bf16 v50, v137, s58, v92
    v_dot2_f32_bf16 v51, v137, s59, v92
    v_dot2_f32_bf16 v52, v138, s58, v92
    v_dot2_f32_bf16 v53, v138, s59, v92
    v_dot2_f32_bf16 v54, v139, s58, v92
    v_dot2_f32_bf16 v55, v139, s59, v92
    v_dot2_f32_bf16 v56, v140, s58, v93
    v_dot2_f32_bf16 v57, v140, s59, v93
    v_dot2_f32_bf16 v58, v141, s58, v93
    v_dot2_f32_bf16 v59, v141, s59, v93
    v_dot2_f32_bf16 v60, v142, s58, v93
    v_dot2_f32_bf16 v61, v142, s59, v93
    v_dot2_f32_bf16 v62, v143, s58, v93
    v_dot2_f32_bf16 v63, v143, s59, v93
    s_waitcnt vmcnt(8)
    s_barrier
    ds_read_b64_tr_b16 a[128:129], v5 offset:0
    ds_read_b64_tr_b16 a[130:131], v5 offset:512
    ds_read_b64_tr_b16 a[132:133], v6 offset:0
    ds_read_b64_tr_b16 a[134:135], v6 offset:512
    ds_read_b64_tr_b16 a[136:137], v7 offset:0
    ds_read_b64_tr_b16 a[138:139], v7 offset:512
    ds_read_b64_tr_b16 a[140:141], v8 offset:0
    ds_read_b64_tr_b16 a[142:143], v8 offset:512
    ds_read_b64_tr_b16 a[144:145], v5 offset:8192
    ds_read_b64_tr_b16 a[146:147], v5 offset:8704
    ds_read_b64_tr_b16 a[148:149], v6 offset:8192
    ds_read_b64_tr_b16 a[150:151], v6 offset:8704
    ds_read_b64_tr_b16 a[152:153], v7 offset:8192
    ds_read_b64_tr_b16 a[154:155], v7 offset:8704
    ds_read_b64_tr_b16 a[156:157], v8 offset:8192
    ds_read_b64_tr_b16 a[158:159], v8 offset:8704
    v_cvt_pk_bf16_f32 v128, v32, v33
    v_cvt_pk_bf16_f32 v129, v34, v35
    v_cvt_pk_bf16_f32 v130, v36, v37
    v_cvt_pk_bf16_f32 v131, v38, v39
    v_cvt_pk_bf16_f32 v132, v40, v41
    v_cvt_pk_bf16_f32 v133, v42, v43
    v_cvt_pk_bf16_f32 v134, v44, v45
    v_cvt_pk_bf16_f32 v135, v46, v47
    v_cvt_pk_bf16_f32 v136, v48, v49
    v_cvt_pk_bf16_f32 v137, v50, v51
    v_cvt_pk_bf16_f32 v138, v52, v53
    v_cvt_pk_bf16_f32 v139, v54, v55
    v_cvt_pk_bf16_f32 v140, v56, v57
    v_cvt_pk_bf16_f32 v141, v58, v59
    v_cvt_pk_bf16_f32 v142, v60, v61
    v_cvt_pk_bf16_f32 v143, v62, v63
    s_waitcnt lgkmcnt(8)
    v_mfma_f32_16x16x32_bf16 a[0:3], a[128:131], v[96:99], 0
    ds_read_b64_tr_b16 a[160:161], v5 offset:4096
    v_mfma_f32_16x16x32_bf16 a[16:19], a[128:131], v[100:103], 0
    ds_read_b64_tr_b16 a[162:163], v5 offset:4608
    v_mfma_f32_16x16x32_bf16 a[4:7], a[132:135], v[96:99], 0
    ds_read_b64_tr_b16 a[164:165], v6 offset:4096
    v_mfma_f32_16x16x32_bf16 a[20:23], a[132:135], v[100:103], 0
    ds_read_b64_tr_b16 a[166:167], v6 offset:4608
    v_mfma_f32_16x16x32_bf16 a[32:35], a[136:139], v[96:99], 0
    ds_read_b64_tr_b16 a[168:169], v7 offset:4096
    v_mfma_f32_16x16x32_bf16 a[48:51], a[136:139], v[100:103], 0
    ds_read_b64_tr_b16 a[170:171], v7 offset:4608
    v_mfma_f32_16x16x32_bf16 a[36:39], a[140:143], v[96:99], 0
    ds_read_b64_tr_b16 a[172:173], v8 offset:4096
    ds_read_b64_tr_b16 a[174:175], v8 offset:4608
    v_mfma_f32_16x16x32_bf16 a[52:55], a[140:143], v[100:103], 0
    v_max_f32 v19, 0, v19
    v_max_f32 v24, 0, v24
    s_waitcnt lgkmcnt(8)
    v_mfma_f32_16x16x32_bf16 a[8:11], a[144:147], v[96:99], 0
    ds_read_b64_tr_b16 a[128:129], v5 offset:12288
    ds_read_b64_tr_b16 a[130:131], v5 offset:12800
    v_mfma_f32_16x16x32_bf16 a[24:27], a[144:147], v[100:103], 0
    v_cvt_pk_bf16_f32 v19, 0, v19
    v_cvt_pk_bf16_f32 v24, 0, v24
    v_add_f32 v19, 0x3727c5ac, v19
    v_mfma_f32_16x16x32_bf16 a[12:15], a[148:151], v[96:99], 0
    ds_read_b64_tr_b16 a[132:133], v6 offset:12288
    ds_read_b64_tr_b16 a[134:135], v6 offset:12800
    v_mfma_f32_16x16x32_bf16 a[28:31], a[148:151], v[100:103], 0
    v_add_f32 v24, 0x3727c5ac, v24
    v_cvt_pk_bf16_f32 v19, 0, v19
    v_cvt_pk_bf16_f32 v24, 0, v24
    v_mfma_f32_16x16x32_bf16 a[40:43], a[152:155], v[96:99], 0
    ds_read_b64_tr_b16 a[136:137], v7 offset:12288
    v_mfma_f32_16x16x32_bf16 a[56:59], a[152:155], v[100:103], 0
    ds_read_b64_tr_b16 a[138:139], v7 offset:12800
    v_sqrt_f32 v19, v19
    v_mfma_f32_16x16x32_bf16 a[44:47], a[156:159], v[96:99], 0
    ds_read_b64_tr_b16 a[140:141], v8 offset:12288
    ds_read_b64_tr_b16 a[142:143], v8 offset:12800
    v_mfma_f32_16x16x32_bf16 a[60:63], a[156:159], v[100:103], 0
    v_sqrt_f32 v24, v24
    v_cvt_pk_bf16_f32 v20, 0, v19
    s_waitcnt lgkmcnt(8)
    v_mfma_f32_16x16x32_bf16 a[0:3], a[160:163], v[104:107], a[0:3]
    ds_read_b64_tr_b16 a[144:145], v5 offset:16384
    ds_read_b64_tr_b16 a[146:147], v5 offset:16896
    s_add_u32 m0, s11, 65536
    s_sub_u32 s12, s12, s13
    s_cselect_b32 s12, s14, s12
    v_mfma_f32_16x16x32_bf16 a[16:19], a[160:163], v[108:111], a[16:19]
    buffer_load_dwordx4 v1, s[24:27], s12 offen offset:0 lds
    v_cvt_pk_bf16_f32 v21, 0, v24
    v_rcp_f32 v19, v20
    v_mfma_f32_16x16x32_bf16 a[4:7], a[164:167], v[104:107], a[4:7]
    ds_read_b64_tr_b16 a[148:149], v6 offset:16384
    ds_read_b64_tr_b16 a[150:151], v6 offset:16896
    v_mfma_f32_16x16x32_bf16 a[20:23], a[164:167], v[108:111], a[20:23]
    v_rcp_f32 v24, v21
    v_mul_f32 v20, v20, v20
    v_mfma_f32_16x16x32_bf16 a[32:35], a[168:171], v[104:107], a[32:35]
    ds_read_b64_tr_b16 a[152:153], v7 offset:16384
    ds_read_b64_tr_b16 a[154:155], v7 offset:16896
    v_mfma_f32_16x16x32_bf16 a[48:51], a[168:171], v[108:111], a[48:51]
    buffer_load_dwordx4 v2, s[24:27], s12 offen offset:1024 lds
    v_mul_f32 v21, v21, v21
    v_mfma_f32_16x16x32_bf16 a[36:39], a[172:175], v[104:107], a[36:39]
    ds_read_b64_tr_b16 a[156:157], v8 offset:16384
    ds_read_b64_tr_b16 a[158:159], v8 offset:16896
    v_mfma_f32_16x16x32_bf16 a[52:55], a[172:175], v[108:111], a[52:55]
    v_mul_f32 v22, 0xbfb8aa3b, v19
    v_mul_f32 v23, 0xbfb8aa3b, v24
    s_waitcnt lgkmcnt(8)
    v_mfma_f32_16x16x32_bf16 a[8:11], a[128:131], v[104:107], a[8:11]
    ds_read_b64_tr_b16 a[160:161], v5 offset:24576
    ds_read_b64_tr_b16 a[162:163], v5 offset:25088
    v_mfma_f32_16x16x32_bf16 a[24:27], a[128:131], v[108:111], a[24:27]
    buffer_load_dwordx4 v3, s[24:27], s12 offen offset:2048 lds
    v_mfma_f32_16x16x32_bf16 a[12:15], a[132:135], v[104:107], a[12:15]
    ds_read_b64_tr_b16 a[164:165], v6 offset:24576
    v_mfma_f32_16x16x32_bf16 a[28:31], a[132:135], v[108:111], a[28:31]
    ds_read_b64_tr_b16 a[166:167], v6 offset:25088
    v_mfma_f32_16x16x32_bf16 a[40:43], a[136:139], v[104:107], a[40:43]
    ds_read_b64_tr_b16 a[168:169], v7 offset:24576
    ds_read_b64_tr_b16 a[170:171], v7 offset:25088
    v_mfma_f32_16x16x32_bf16 a[56:59], a[136:139], v[108:111], a[56:59]
    buffer_load_dwordx4 v4, s[24:27], s12 offen offset:3072 lds
    v_mfma_f32_16x16x32_bf16 a[44:47], a[140:143], v[104:107], a[44:47]
    ds_read_b64_tr_b16 a[172:173], v8 offset:24576
    v_mfma_f32_16x16x32_bf16 a[60:63], a[140:143], v[108:111], a[60:63]
    ds_read_b64_tr_b16 a[174:175], v8 offset:25088
    s_waitcnt lgkmcnt(8)
    v_mfma_f32_16x16x32_bf16 a[0:3], a[144:147], v[112:115], a[0:3]
    ds_read_b64_tr_b16 a[128:129], v5 offset:20480
    v_mfma_f32_16x16x32_bf16 a[16:19], a[144:147], v[116:119], a[16:19]
    ds_read_b64_tr_b16 a[130:131], v5 offset:20992
    v_mfma_f32_16x16x32_bf16 a[4:7], a[148:151], v[112:115], a[4:7]
    ds_read_b64_tr_b16 a[132:133], v6 offset:20480
    ds_read_b64_tr_b16 a[134:135], v6 offset:20992
    v_mfma_f32_16x16x32_bf16 a[20:23], a[148:151], v[116:119], a[20:23]
    s_add_u32 m0, s11, 81920
    s_sub_u32 s12, s12, s13
    s_cselect_b32 s12, s14, s12
    v_mfma_f32_16x16x32_bf16 a[32:35], a[152:155], v[112:115], a[32:35]
    ds_read_b64_tr_b16 a[136:137], v7 offset:20480
    ds_read_b64_tr_b16 a[138:139], v7 offset:20992
    v_mfma_f32_16x16x32_bf16 a[48:51], a[152:155], v[116:119], a[48:51]
    buffer_load_dwordx4 v1, s[24:27], s12 offen offset:0 lds
    v_mfma_f32_16x16x32_bf16 a[36:39], a[156:159], v[112:115], a[36:39]
    ds_read_b64_tr_b16 a[140:141], v8 offset:20480
    ds_read_b64_tr_b16 a[142:143], v8 offset:20992
    v_mfma_f32_16x16x32_bf16 a[52:55], a[156:159], v[116:119], a[52:55]
    v_add_u32 v84, 98304, v84
    s_waitcnt lgkmcnt(8)
    v_mfma_f32_16x16x32_bf16 a[8:11], a[160:163], v[112:115], a[8:11]
    ds_read_b64_tr_b16 a[144:145], v5 offset:28672
    ds_read_b64_tr_b16 a[146:147], v5 offset:29184
    ds_read_b64_tr_b16 a[148:149], v6 offset:28672
    v_mfma_f32_16x16x32_bf16 a[24:27], a[160:163], v[116:119], a[24:27]
    buffer_load_dwordx4 v2, s[24:27], s12 offen offset:1024 lds
    v_add_u32 v85, 98304, v85
    v_mfma_f32_16x16x32_bf16 a[12:15], a[164:167], v[112:115], a[12:15]
    ds_read_b64_tr_b16 a[150:151], v6 offset:29184
    ds_read_b64_tr_b16 a[152:153], v7 offset:28672
    v_mfma_f32_16x16x32_bf16 a[28:31], a[164:167], v[116:119], a[28:31]
    ds_read_b64_tr_b16 a[154:155], v7 offset:29184
    v_add_u32 v86, 98304, v86
    v_mfma_f32_16x16x32_bf16 a[40:43], a[168:171], v[112:115], a[40:43]
    ds_read_b64_tr_b16 a[156:157], v8 offset:28672
    ds_read_b64_tr_b16 a[158:159], v8 offset:29184
    v_mfma_f32_16x16x32_bf16 a[56:59], a[168:171], v[116:119], a[56:59]
    buffer_load_dwordx4 v3, s[24:27], s12 offen offset:2048 lds
    v_add_u32 v87, 98304, v87
    v_mfma_f32_16x16x32_bf16 a[44:47], a[172:175], v[112:115], a[44:47]
    v_mfma_f32_16x16x32_bf16 a[60:63], a[172:175], v[116:119], a[60:63]
    s_waitcnt vmcnt(7)
    s_barrier
    s_waitcnt lgkmcnt(8)
    v_mfma_f32_16x16x32_bf16 a[0:3], a[128:131], v[120:123], a[0:3]
    ds_read_b64_tr_b16 a[160:161], v5 offset:32768
    ds_read_b64_tr_b16 a[162:163], v5 offset:33280
    v_mfma_f32_16x16x32_bf16 a[16:19], a[128:131], v[124:127], a[16:19]
    buffer_load_dwordx4 v4, s[24:27], s12 offen offset:3072 lds
    v_add_u32 v88, 98304, v88
    v_mfma_f32_16x16x32_bf16 a[4:7], a[132:135], v[120:123], a[4:7]
    ds_read_b64_tr_b16 a[164:165], v6 offset:32768
    ds_read_b64_tr_b16 a[166:167], v6 offset:33280
    v_mfma_f32_16x16x32_bf16 a[20:23], a[132:135], v[124:127], a[20:23]
    s_add_u32 m0, s11, 98304
    v_add_u32 v89, 98304, v89
    v_mfma_f32_16x16x32_bf16 a[32:35], a[136:139], v[120:123], a[32:35]
    ds_read_b64_tr_b16 a[168:169], v7 offset:32768
    ds_read_b64_tr_b16 a[170:171], v7 offset:33280
    v_mfma_f32_16x16x32_bf16 a[48:51], a[136:139], v[124:127], a[48:51]
    buffer_load_dwordx4 v80, s[48:51], s52 offen offset:0 lds
    v_add_u32 v90, 98304, v90
    v_mfma_f32_16x16x32_bf16 a[36:39], a[140:143], v[120:123], a[36:39]
    ds_read_b64_tr_b16 a[172:173], v8 offset:32768
    ds_read_b64_tr_b16 a[174:175], v8 offset:33280
    v_mfma_f32_16x16x32_bf16 a[52:55], a[140:143], v[124:127], a[52:55]
    v_add_u32 v91, 98304, v91
    s_waitcnt lgkmcnt(8)
    v_mfma_f32_16x16x32_bf16 a[8:11], a[144:147], v[120:123], a[8:11]
    ds_read_b64_tr_b16 a[128:129], v5 offset:40960
    ds_read_b64_tr_b16 a[130:131], v5 offset:41472
    v_mfma_f32_16x16x32_bf16 a[24:27], a[144:147], v[124:127], a[24:27]
    buffer_load_dwordx4 v81, s[48:51], s52 offen offset:1024 lds
    v_mfma_f32_16x16x32_bf16 a[12:15], a[148:151], v[120:123], a[12:15]
    ds_read_b64_tr_b16 a[132:133], v6 offset:40960
    v_mfma_f32_16x16x32_bf16 a[28:31], a[148:151], v[124:127], a[28:31]
    ds_read_b64_tr_b16 a[134:135], v6 offset:41472
    v_mfma_f32_16x16x32_bf16 a[40:43], a[152:155], v[120:123], a[40:43]
    ds_read_b64_tr_b16 a[136:137], v7 offset:40960
    ds_read_b64_tr_b16 a[138:139], v7 offset:41472
    v_mfma_f32_16x16x32_bf16 a[56:59], a[152:155], v[124:127], a[56:59]
    buffer_load_dwordx4 v82, s[48:51], s52 offen offset:2048 lds
    v_mfma_f32_16x16x32_bf16 a[44:47], a[156:159], v[120:123], a[44:47]
    ds_read_b64_tr_b16 a[140:141], v8 offset:40960
    v_mfma_f32_16x16x32_bf16 a[60:63], a[156:159], v[124:127], a[60:63]
    ds_read_b64_tr_b16 a[142:143], v8 offset:41472
    s_waitcnt lgkmcnt(8)
    v_mfma_f32_16x16x32_bf16 a[0:3], a[160:163], v[128:131], a[0:3]
    ds_read_b64_tr_b16 a[144:145], v5 offset:36864
    ds_read_b64_tr_b16 a[146:147], v5 offset:37376
    buffer_load_dwordx4 v83, s[48:51], s52 offen offset:3072 lds
    v_mfma_f32_16x16x32_bf16 a[16:19], a[160:163], v[132:135], a[16:19]
    v_dot2_f32_bf16 v32, v144, s58, v92
    v_dot2_f32_bf16 v33, v144, s59, v92
    v_dot2_f32_bf16 v34, v145, s58, v92
    v_dot2_f32_bf16 v35, v145, s59, v92
    v_dot2_f32_bf16 v36, v146, s58, v92
    v_dot2_f32_bf16 v37, v146, s59, v92
    v_dot2_f32_bf16 v38, v147, s58, v92
    v_dot2_f32_bf16 v39, v147, s59, v92
    v_dot2_f32_bf16 v40, v148, s58, v93
    v_dot2_f32_bf16 v41, v148, s59, v93
    v_dot2_f32_bf16 v42, v149, s58, v93
    v_dot2_f32_bf16 v43, v149, s59, v93
    v_dot2_f32_bf16 v44, v150, s58, v93
    v_dot2_f32_bf16 v45, v150, s59, v93
    v_dot2_f32_bf16 v46, v151, s58, v93
    v_dot2_f32_bf16 v47, v151, s59, v93
    v_dot2_f32_bf16 v48, v152, s58, v92
    v_dot2_f32_bf16 v49, v152, s59, v92
    v_dot2_f32_bf16 v50, v153, s58, v92
    v_dot2_f32_bf16 v51, v153, s59, v92
    v_dot2_f32_bf16 v52, v154, s58, v92
    v_dot2_f32_bf16 v53, v154, s59, v92
    v_dot2_f32_bf16 v54, v155, s58, v92
    v_dot2_f32_bf16 v55, v155, s59, v92
    v_dot2_f32_bf16 v56, v156, s58, v93
    v_dot2_f32_bf16 v57, v156, s59, v93
    v_dot2_f32_bf16 v58, v157, s58, v93
    v_dot2_f32_bf16 v59, v157, s59, v93
    v_dot2_f32_bf16 v60, v158, s58, v93
    v_dot2_f32_bf16 v61, v158, s59, v93
    v_dot2_f32_bf16 v62, v159, s58, v93
    v_dot2_f32_bf16 v63, v159, s59, v93
    v_mfma_f32_16x16x32_bf16 a[4:7], a[164:167], v[128:131], a[4:7]
    ds_read_b64_tr_b16 a[148:149], v6 offset:36864
    ds_read_b64_tr_b16 a[150:151], v6 offset:37376
    s_add_u32 m0, s11, 0
    v_mfma_f32_16x16x32_bf16 a[20:23], a[164:167], v[132:135], a[20:23]
    s_sub_u32 s12, s12, s13
    s_cselect_b32 s12, s14, s12
    v_cvt_pk_bf16_f32 v144, v32, v33
    v_cvt_pk_bf16_f32 v145, v34, v35
    v_mfma_f32_16x16x32_bf16 a[32:35], a[168:171], v[128:131], a[32:35]
    ds_read_b64_tr_b16 a[152:153], v7 offset:36864
    ds_read_b64_tr_b16 a[154:155], v7 offset:37376
    v_mfma_f32_16x16x32_bf16 a[48:51], a[168:171], v[132:135], a[48:51]
    buffer_load_dwordx4 v1, s[24:27], s12 offen offset:0 lds
    v_mfma_f32_16x16x32_bf16 a[36:39], a[172:175], v[128:131], a[36:39]
    ds_read_b64_tr_b16 a[156:157], v8 offset:36864
    ds_read_b64_tr_b16 a[158:159], v8 offset:37376
    v_mfma_f32_16x16x32_bf16 a[52:55], a[172:175], v[132:135], a[52:55]
    v_cvt_pk_bf16_f32 v146, v36, v37
    v_cvt_pk_bf16_f32 v147, v38, v39
    s_waitcnt lgkmcnt(8)
    v_mfma_f32_16x16x32_bf16 a[8:11], a[128:131], v[128:131], a[8:11]
    ds_read_b64_tr_b16 a[160:161], v5 offset:45056
    ds_read_b64_tr_b16 a[162:163], v5 offset:45568
    v_mfma_f32_16x16x32_bf16 a[24:27], a[128:131], v[132:135], a[24:27]
    buffer_load_dwordx4 v2, s[24:27], s12 offen offset:1024 lds
    v_cvt_pk_bf16_f32 v148, v40, v41
    v_cvt_pk_bf16_f32 v149, v42, v43
    v_mfma_f32_16x16x32_bf16 a[12:15], a[132:135], v[128:131], a[12:15]
    ds_read_b64_tr_b16 a[164:165], v6 offset:45056
    ds_read_b64_tr_b16 a[166:167], v6 offset:45568
    v_mfma_f32_16x16x32_bf16 a[28:31], a[132:135], v[132:135], a[28:31]
    v_cvt_pk_bf16_f32 v150, v44, v45
    v_cvt_pk_bf16_f32 v151, v46, v47
    v_mfma_f32_16x16x32_bf16 a[40:43], a[136:139], v[128:131], a[40:43]
    ds_read_b64_tr_b16 a[168:169], v7 offset:45056
    ds_read_b64_tr_b16 a[170:171], v7 offset:45568
    v_mfma_f32_16x16x32_bf16 a[56:59], a[136:139], v[132:135], a[56:59]
    buffer_load_dwordx4 v3, s[24:27], s12 offen offset:2048 lds
    v_mfma_f32_16x16x32_bf16 a[44:47], a[140:143], v[128:131], a[44:47]
    ds_read_b64_tr_b16 a[172:173], v8 offset:45056
    v_mfma_f32_16x16x32_bf16 a[60:63], a[140:143], v[132:135], a[60:63]
    ds_read_b64_tr_b16 a[174:175], v8 offset:45568
    s_waitcnt lgkmcnt(8)
    v_mfma_f32_16x16x32_bf16 a[0:3], a[144:147], v[136:139], a[0:3]
    ds_read_b64_tr_b16 a[128:129], v5 offset:49152
    ds_read_b64_tr_b16 a[130:131], v5 offset:49664
    v_mfma_f32_16x16x32_bf16 a[16:19], a[144:147], v[140:143], a[16:19]
    buffer_load_dwordx4 v4, s[24:27], s12 offen offset:3072 lds
    v_cvt_pk_bf16_f32 v152, v48, v49
    v_mfma_f32_16x16x32_bf16 a[4:7], a[148:151], v[136:139], a[4:7]
    ds_read_b64_tr_b16 a[132:133], v6 offset:49152
    ds_read_b64_tr_b16 a[134:135], v6 offset:49664
    s_add_u32 m0, s11, 114688
    v_mfma_f32_16x16x32_bf16 a[20:23], a[148:151], v[140:143], a[20:23]
    s_sub_u32 s12, s12, s13
    s_cselect_b32 s12, s14, s12
    v_cvt_pk_bf16_f32 v153, v50, v51
    v_cvt_pk_bf16_f32 v154, v52, v53
    v_mfma_f32_16x16x32_bf16 a[32:35], a[152:155], v[136:139], a[32:35]
    ds_read_b64_tr_b16 a[136:137], v7 offset:49152
    ds_read_b64_tr_b16 a[138:139], v7 offset:49664
    v_mfma_f32_16x16x32_bf16 a[48:51], a[152:155], v[140:143], a[48:51]
    buffer_load_dwordx4 v1, s[24:27], s12 offen offset:0 lds
    v_mfma_f32_16x16x32_bf16 a[36:39], a[156:159], v[136:139], a[36:39]
    ds_read_b64_tr_b16 a[140:141], v8 offset:49152
    ds_read_b64_tr_b16 a[142:143], v8 offset:49664
    v_mfma_f32_16x16x32_bf16 a[52:55], a[156:159], v[140:143], a[52:55]
    v_cvt_pk_bf16_f32 v155, v54, v55
    v_cvt_pk_bf16_f32 v156, v56, v57
    s_waitcnt lgkmcnt(8)
    v_mfma_f32_16x16x32_bf16 a[8:11], a[160:163], v[136:139], a[8:11]
    ds_read_b64_tr_b16 a[144:145], v5 offset:57344
    ds_read_b64_tr_b16 a[146:147], v5 offset:57856
    v_mfma_f32_16x16x32_bf16 a[24:27], a[160:163], v[140:143], a[24:27]
    buffer_load_dwordx4 v2, s[24:27], s12 offen offset:1024 lds
    v_cvt_pk_bf16_f32 v157, v58, v59
    v_cvt_pk_bf16_f32 v158, v60, v61
    v_mfma_f32_16x16x32_bf16 a[12:15], a[164:167], v[136:139], a[12:15]
    ds_read_b64_tr_b16 a[148:149], v6 offset:57344
    v_mfma_f32_16x16x32_bf16 a[28:31], a[164:167], v[140:143], a[28:31]
    ds_read_b64_tr_b16 a[150:151], v6 offset:57856
    v_cvt_pk_bf16_f32 v159, v62, v63
    v_mfma_f32_16x16x32_bf16 a[40:43], a[168:171], v[136:139], a[40:43]
    ds_read_b64_tr_b16 a[152:153], v7 offset:57344
    ds_read_b64_tr_b16 a[154:155], v7 offset:57856
    v_mfma_f32_16x16x32_bf16 a[56:59], a[168:171], v[140:143], a[56:59]
    buffer_load_dwordx4 v3, s[24:27], s12 offen offset:2048 lds
    v_mfma_f32_16x16x32_bf16 a[44:47], a[172:175], v[136:139], a[44:47]
    ds_read_b64_tr_b16 a[156:157], v8 offset:57344
    v_mfma_f32_16x16x32_bf16 a[60:63], a[172:175], v[140:143], a[60:63]
    ds_read_b64_tr_b16 a[158:159], v8 offset:57856
    s_waitcnt lgkmcnt(8)
    v_mfma_f32_16x16x32_bf16 a[0:3], a[128:131], v[144:147], a[0:3]
    ds_read_b64_tr_b16 a[160:161], v5 offset:53248
    ds_read_b64_tr_b16 a[162:163], v5 offset:53760
    buffer_load_dwordx4 v4, s[24:27], s12 offen offset:3072 lds
    v_mfma_f32_16x16x32_bf16 a[16:19], a[128:131], v[148:151], a[16:19]
    v_dot2_f32_bf16 v32, v160, s58, v92
    v_dot2_f32_bf16 v33, v160, s59, v92
    v_dot2_f32_bf16 v34, v161, s58, v92
    v_dot2_f32_bf16 v35, v161, s59, v92
    v_dot2_f32_bf16 v36, v162, s58, v92
    v_dot2_f32_bf16 v37, v162, s59, v92
    v_dot2_f32_bf16 v38, v163, s58, v92
    v_dot2_f32_bf16 v39, v163, s59, v92
    v_dot2_f32_bf16 v40, v164, s58, v93
    v_dot2_f32_bf16 v41, v164, s59, v93
    v_dot2_f32_bf16 v42, v165, s58, v93
    v_dot2_f32_bf16 v43, v165, s59, v93
    v_dot2_f32_bf16 v44, v166, s58, v93
    v_dot2_f32_bf16 v45, v166, s59, v93
    v_dot2_f32_bf16 v46, v167, s58, v93
    v_dot2_f32_bf16 v47, v167, s59, v93
    v_dot2_f32_bf16 v48, v168, s58, v92
    v_dot2_f32_bf16 v49, v168, s59, v92
    v_dot2_f32_bf16 v50, v169, s58, v92
    v_dot2_f32_bf16 v51, v169, s59, v92
    v_dot2_f32_bf16 v52, v170, s58, v92
    v_dot2_f32_bf16 v53, v170, s59, v92
    v_dot2_f32_bf16 v54, v171, s58, v92
    v_dot2_f32_bf16 v55, v171, s59, v92
    v_dot2_f32_bf16 v56, v172, s58, v93
    v_dot2_f32_bf16 v57, v172, s59, v93
    v_dot2_f32_bf16 v58, v173, s58, v93
    v_dot2_f32_bf16 v59, v173, s59, v93
    v_dot2_f32_bf16 v60, v174, s58, v93
    v_dot2_f32_bf16 v61, v174, s59, v93
    v_dot2_f32_bf16 v62, v175, s58, v93
    v_dot2_f32_bf16 v63, v175, s59, v93
    v_mfma_f32_16x16x32_bf16 a[4:7], a[132:135], v[144:147], a[4:7]
    ds_read_b64_tr_b16 a[164:165], v6 offset:53248
    ds_read_b64_tr_b16 a[166:167], v6 offset:53760
    s_add_u32 m0, s11, 131072
    v_mfma_f32_16x16x32_bf16 a[20:23], a[132:135], v[148:151], a[20:23]
    s_sub_u32 s12, s12, s13
    s_cselect_b32 s12, s14, s12
    v_cvt_pk_bf16_f32 v160, v32, v33
    v_cvt_pk_bf16_f32 v161, v34, v35
    v_mfma_f32_16x16x32_bf16 a[32:35], a[136:139], v[144:147], a[32:35]
    ds_read_b64_tr_b16 a[168:169], v7 offset:53248
    ds_read_b64_tr_b16 a[170:171], v7 offset:53760
    v_mfma_f32_16x16x32_bf16 a[48:51], a[136:139], v[148:151], a[48:51]
    buffer_load_dwordx4 v1, s[24:27], s12 offen offset:0 lds
    v_mfma_f32_16x16x32_bf16 a[36:39], a[140:143], v[144:147], a[36:39]
    ds_read_b64_tr_b16 a[172:173], v8 offset:53248
    ds_read_b64_tr_b16 a[174:175], v8 offset:53760
    v_mfma_f32_16x16x32_bf16 a[52:55], a[140:143], v[148:151], a[52:55]
    v_cvt_pk_bf16_f32 v162, v36, v37
    v_cvt_pk_bf16_f32 v163, v38, v39
    s_waitcnt lgkmcnt(8)
    v_mfma_f32_16x16x32_bf16 a[8:11], a[144:147], v[144:147], a[8:11]
    ds_read_b64_tr_b16 a[128:129], v5 offset:61440
    ds_read_b64_tr_b16 a[130:131], v5 offset:61952
    ds_read_b64_tr_b16 a[132:133], v6 offset:61440
    v_mfma_f32_16x16x32_bf16 a[24:27], a[144:147], v[148:151], a[24:27]
    buffer_load_dwordx4 v2, s[24:27], s12 offen offset:1024 lds
    v_cvt_pk_bf16_f32 v164, v40, v41
    v_cvt_pk_bf16_f32 v165, v42, v43
    v_mfma_f32_16x16x32_bf16 a[12:15], a[148:151], v[144:147], a[12:15]
    ds_read_b64_tr_b16 a[134:135], v6 offset:61952
    ds_read_b64_tr_b16 a[136:137], v7 offset:61440
    v_mfma_f32_16x16x32_bf16 a[28:31], a[148:151], v[148:151], a[28:31]
    ds_read_b64_tr_b16 a[138:139], v7 offset:61952
    v_cvt_pk_bf16_f32 v166, v44, v45
    v_cvt_pk_bf16_f32 v167, v46, v47
    v_mfma_f32_16x16x32_bf16 a[40:43], a[152:155], v[144:147], a[40:43]
    ds_read_b64_tr_b16 a[140:141], v8 offset:61440
    ds_read_b64_tr_b16 a[142:143], v8 offset:61952
    v_mfma_f32_16x16x32_bf16 a[56:59], a[152:155], v[148:151], a[56:59]
    buffer_load_dwordx4 v3, s[24:27], s12 offen offset:2048 lds
    v_mfma_f32_16x16x32_bf16 a[44:47], a[156:159], v[144:147], a[44:47]
    v_mfma_f32_16x16x32_bf16 a[60:63], a[156:159], v[148:151], a[60:63]
    s_waitcnt vmcnt(15)
    s_barrier
    s_waitcnt lgkmcnt(8)
    v_mfma_f32_16x16x32_bf16 a[0:3], a[160:163], v[152:155], a[0:3]
    ds_read_b64_tr_b16 a[144:145], v9 offset:0
    ds_read_b64_tr_b16 a[146:147], v9 offset:512
    v_mfma_f32_16x16x32_bf16 a[16:19], a[160:163], v[156:159], a[16:19]
    buffer_load_dwordx4 v4, s[24:27], s12 offen offset:3072 lds
    v_cvt_pk_bf16_f32 v168, v48, v49
    v_mfma_f32_16x16x32_bf16 a[4:7], a[164:167], v[152:155], a[4:7]
    ds_read_b64_tr_b16 a[148:149], v10 offset:0
    ds_read_b64_tr_b16 a[150:151], v10 offset:512
    s_add_u32 m0, s11, 147456
    v_mfma_f32_16x16x32_bf16 a[20:23], a[164:167], v[156:159], a[20:23]
    s_sub_u32 s12, s12, s13
    s_cselect_b32 s12, s14, s12
    v_cvt_pk_bf16_f32 v169, v50, v51
    v_cvt_pk_bf16_f32 v170, v52, v53
    v_mfma_f32_16x16x32_bf16 a[32:35], a[168:171], v[152:155], a[32:35]
    ds_read_b64_tr_b16 a[152:153], v11 offset:0
    ds_read_b64_tr_b16 a[154:155], v11 offset:512
    v_mfma_f32_16x16x32_bf16 a[48:51], a[168:171], v[156:159], a[48:51]
    buffer_load_dwordx4 v1, s[24:27], s12 offen offset:0 lds
    v_mfma_f32_16x16x32_bf16 a[36:39], a[172:175], v[152:155], a[36:39]
    ds_read_b64_tr_b16 a[156:157], v12 offset:0
    ds_read_b64_tr_b16 a[158:159], v12 offset:512
    v_mfma_f32_16x16x32_bf16 a[52:55], a[172:175], v[156:159], a[52:55]
    v_cvt_pk_bf16_f32 v171, v54, v55
    v_cvt_pk_bf16_f32 v172, v56, v57
    s_waitcnt lgkmcnt(8)
    v_mfma_f32_16x16x32_bf16 a[8:11], a[128:131], v[152:155], a[8:11]
    ds_read_b64_tr_b16 a[160:161], v9 offset:8192
    ds_read_b64_tr_b16 a[162:163], v9 offset:8704
    v_mfma_f32_16x16x32_bf16 a[24:27], a[128:131], v[156:159], a[24:27]
    buffer_load_dwordx4 v2, s[24:27], s12 offen offset:1024 lds
    v_cvt_pk_bf16_f32 v173, v58, v59
    v_cvt_pk_bf16_f32 v174, v60, v61
    v_mfma_f32_16x16x32_bf16 a[12:15], a[132:135], v[152:155], a[12:15]
    ds_read_b64_tr_b16 a[164:165], v10 offset:8192
    v_mfma_f32_16x16x32_bf16 a[28:31], a[132:135], v[156:159], a[28:31]
    ds_read_b64_tr_b16 a[166:167], v10 offset:8704
    v_cvt_pk_bf16_f32 v175, v62, v63
    v_mfma_f32_16x16x32_bf16 a[40:43], a[136:139], v[152:155], a[40:43]
    ds_read_b64_tr_b16 a[168:169], v11 offset:8192
    ds_read_b64_tr_b16 a[170:171], v11 offset:8704
    v_mfma_f32_16x16x32_bf16 a[56:59], a[136:139], v[156:159], a[56:59]
    buffer_load_dwordx4 v3, s[24:27], s12 offen offset:2048 lds
    v_mfma_f32_16x16x32_bf16 a[44:47], a[140:143], v[152:155], a[44:47]
    ds_read_b64_tr_b16 a[172:173], v12 offset:8192
    v_mfma_f32_16x16x32_bf16 a[60:63], a[140:143], v[156:159], a[60:63]
    ds_read_b64_tr_b16 a[174:175], v12 offset:8704
    s_waitcnt lgkmcnt(8)
    v_mfma_f32_16x16x32_bf16 a[0:3], a[144:147], v[160:163], a[0:3]
    ds_read_b64_tr_b16 a[128:129], v9 offset:4096
    ds_read_b64_tr_b16 a[130:131], v9 offset:4608
    buffer_load_dwordx4 v4, s[24:27], s12 offen offset:3072 lds
    v_mfma_f32_16x16x32_bf16 a[16:19], a[144:147], v[164:167], a[16:19]
    v_dot2_f32_bf16 v32, v176, s58, v92
    v_dot2_f32_bf16 v33, v176, s59, v92
    v_dot2_f32_bf16 v34, v177, s58, v92
    v_dot2_f32_bf16 v35, v177, s59, v92
    v_dot2_f32_bf16 v36, v178, s58, v92
    v_dot2_f32_bf16 v37, v178, s59, v92
    v_dot2_f32_bf16 v38, v179, s58, v92
    v_dot2_f32_bf16 v39, v179, s59, v92
    v_dot2_f32_bf16 v40, v180, s58, v93
    v_dot2_f32_bf16 v41, v180, s59, v93
    v_dot2_f32_bf16 v42, v181, s58, v93
    v_dot2_f32_bf16 v43, v181, s59, v93
    v_dot2_f32_bf16 v44, v182, s58, v93
    v_dot2_f32_bf16 v45, v182, s59, v93
    v_dot2_f32_bf16 v46, v183, s58, v93
    v_dot2_f32_bf16 v47, v183, s59, v93
    v_dot2_f32_bf16 v48, v184, s58, v92
    v_dot2_f32_bf16 v49, v184, s59, v92
    v_dot2_f32_bf16 v50, v185, s58, v92
    v_dot2_f32_bf16 v51, v185, s59, v92
    v_dot2_f32_bf16 v52, v186, s58, v92
    v_dot2_f32_bf16 v53, v186, s59, v92
    v_dot2_f32_bf16 v54, v187, s58, v92
    v_dot2_f32_bf16 v55, v187, s59, v92
    v_dot2_f32_bf16 v56, v188, s58, v93
    v_dot2_f32_bf16 v57, v188, s59, v93
    v_dot2_f32_bf16 v58, v189, s58, v93
    v_dot2_f32_bf16 v59, v189, s59, v93
    v_dot2_f32_bf16 v60, v190, s58, v93
    v_dot2_f32_bf16 v61, v190, s59, v93
    v_dot2_f32_bf16 v62, v191, s58, v93
    v_dot2_f32_bf16 v63, v191, s59, v93
    v_mfma_f32_16x16x32_bf16 a[4:7], a[148:151], v[160:163], a[4:7]
    ds_read_b64_tr_b16 a[132:133], v10 offset:4096
    ds_read_b64_tr_b16 a[134:135], v10 offset:4608
    s_add_u32 m0, s11, 16384
    v_mad_u32_u24 v1, v25, s36, v26
    s_lshl_b32 s13, s36, 6
    s_lshl_b32 s92, s36, 3
    s_sub_u32 s92, s92, 1024
    v_add_u32 v1, s37, v1
    v_mfma_f32_16x16x32_bf16 a[20:23], a[148:151], v[164:167], a[20:23]
    s_mul_i32 s14, s13, 9
    s_mov_b32 s12, s38
    v_xor_b32 v2, 64, v1
    v_add_u32 v2, s92, v2
    s_lshl_b32 s92, s92, 1
    v_add_u32 v3, s92, v1
    v_add_u32 v4, s92, v2
    v_cvt_pk_bf16_f32 v176, v32, v33
    v_cvt_pk_bf16_f32 v177, v34, v35
    v_mfma_f32_16x16x32_bf16 a[32:35], a[152:155], v[160:163], a[32:35]
    ds_read_b64_tr_b16 a[136:137], v11 offset:4096
    ds_read_b64_tr_b16 a[138:139], v11 offset:4608
    v_mfma_f32_16x16x32_bf16 a[48:51], a[152:155], v[164:167], a[48:51]
    buffer_load_dwordx4 v1, s[32:35], s12 offen offset:0 lds
    v_mfma_f32_16x16x32_bf16 a[36:39], a[156:159], v[160:163], a[36:39]
    ds_read_b64_tr_b16 a[140:141], v12 offset:4096
    ds_read_b64_tr_b16 a[142:143], v12 offset:4608
    v_mfma_f32_16x16x32_bf16 a[52:55], a[156:159], v[164:167], a[52:55]
    v_cvt_pk_bf16_f32 v178, v36, v37
    v_cvt_pk_bf16_f32 v179, v38, v39
    s_waitcnt lgkmcnt(8)
    v_mfma_f32_16x16x32_bf16 a[8:11], a[160:163], v[160:163], a[8:11]
    ds_read_b64_tr_b16 a[144:145], v9 offset:12288
    ds_read_b64_tr_b16 a[146:147], v9 offset:12800
    v_mfma_f32_16x16x32_bf16 a[24:27], a[160:163], v[164:167], a[24:27]
    v_cvt_pk_bf16_f32 v180, v40, v41
    v_cvt_pk_bf16_f32 v181, v42, v43
    v_mfma_f32_16x16x32_bf16 a[12:15], a[164:167], v[160:163], a[12:15]
    ds_read_b64_tr_b16 a[148:149], v10 offset:12288
    ds_read_b64_tr_b16 a[150:151], v10 offset:12800
    v_mfma_f32_16x16x32_bf16 a[28:31], a[164:167], v[164:167], a[28:31]
    v_cvt_pk_bf16_f32 v182, v44, v45
    v_cvt_pk_bf16_f32 v183, v46, v47
    v_mfma_f32_16x16x32_bf16 a[40:43], a[168:171], v[160:163], a[40:43]
    ds_read_b64_tr_b16 a[152:153], v11 offset:12288
    ds_read_b64_tr_b16 a[154:155], v11 offset:12800
    v_mfma_f32_16x16x32_bf16 a[56:59], a[168:171], v[164:167], a[56:59]
    buffer_load_dwordx4 v2, s[32:35], s12 offen offset:1024 lds
    s_waitcnt vmcnt(18)
    v_mfma_f32_16x16x32_bf16 a[44:47], a[172:175], v[160:163], a[44:47]
    ds_read_b64_tr_b16 a[156:157], v12 offset:12288
    ds_read_b64_tr_b16 a[158:159], v12 offset:12800
    v_mfma_f32_16x16x32_bf16 a[60:63], a[172:175], v[164:167], a[60:63]
    ds_read_b64_tr_b16 v[64:65], v84
    ds_read_b64_tr_b16 v[66:67], v88
    s_waitcnt lgkmcnt(8)
    v_mfma_f32_16x16x32_bf16 a[0:3], a[128:131], v[168:171], a[0:3]
    ds_read_b64_tr_b16 a[160:161], v9 offset:16384
    ds_read_b64_tr_b16 a[162:163], v9 offset:16896
    buffer_load_dwordx4 v3, s[32:35], s12 offen offset:2048 lds
    v_mfma_f32_16x16x32_bf16 a[16:19], a[128:131], v[172:175], a[16:19]
    v_cvt_pk_bf16_f32 v184, v48, v49
    ds_read_b64_tr_b16 v[68:69], v85
    ds_read_b64_tr_b16 v[70:71], v89
    v_mfma_f32_16x16x32_bf16 a[4:7], a[132:135], v[168:171], a[4:7]
    ds_read_b64_tr_b16 a[164:165], v10 offset:16384
    ds_read_b64_tr_b16 a[166:167], v10 offset:16896
    v_mfma_f32_16x16x32_bf16 a[20:23], a[132:135], v[172:175], a[20:23]
    v_cvt_pk_bf16_f32 v185, v50, v51
    v_cvt_pk_bf16_f32 v186, v52, v53
    ds_read_b64_tr_b16 v[72:73], v86
    v_mfma_f32_16x16x32_bf16 a[32:35], a[136:139], v[168:171], a[32:35]
    ds_read_b64_tr_b16 a[168:169], v11 offset:16384
    ds_read_b64_tr_b16 a[170:171], v11 offset:16896
    v_mfma_f32_16x16x32_bf16 a[48:51], a[136:139], v[172:175], a[48:51]
    buffer_load_dwordx4 v4, s[32:35], s12 offen offset:3072 lds
    ds_read_b64_tr_b16 v[74:75], v90
    v_mfma_f32_16x16x32_bf16 a[36:39], a[140:143], v[168:171], a[36:39]
    ds_read_b64_tr_b16 a[172:173], v12 offset:16384
    ds_read_b64_tr_b16 a[174:175], v12 offset:16896
    v_mfma_f32_16x16x32_bf16 a[52:55], a[140:143], v[172:175], a[52:55]
    v_cvt_pk_bf16_f32 v187, v54, v55
    v_cvt_pk_bf16_f32 v188, v56, v57
    s_waitcnt lgkmcnt(8)
    v_mfma_f32_16x16x32_bf16 a[8:11], a[144:147], v[168:171], a[8:11]
    ds_read_b64_tr_b16 a[128:129], v9 offset:24576
    ds_read_b64_tr_b16 a[130:131], v9 offset:25088
    v_mfma_f32_16x16x32_bf16 a[24:27], a[144:147], v[172:175], a[24:27]
    v_cvt_pk_bf16_f32 v189, v58, v59
    v_cvt_pk_bf16_f32 v190, v60, v61
    ds_read_b64_tr_b16 v[76:77], v87
    v_mfma_f32_16x16x32_bf16 a[12:15], a[148:151], v[168:171], a[12:15]
    ds_read_b64_tr_b16 a[132:133], v10 offset:24576
    ds_read_b64_tr_b16 a[134:135], v10 offset:25088
    s_add_u32 m0, s11, 32768
    v_mfma_f32_16x16x32_bf16 a[28:31], a[148:151], v[172:175], a[28:31]
    s_sub_u32 s12, s12, s13
    s_cselect_b32 s12, s14, s12
    v_cvt_pk_bf16_f32 v191, v62, v63
    ds_read_b64_tr_b16 v[78:79], v91
    v_mfma_f32_16x16x32_bf16 a[40:43], a[152:155], v[168:171], a[40:43]
    ds_read_b64_tr_b16 a[136:137], v11 offset:24576
    ds_read_b64_tr_b16 a[138:139], v11 offset:25088
    v_mfma_f32_16x16x32_bf16 a[56:59], a[152:155], v[172:175], a[56:59]
    buffer_load_dwordx4 v1, s[32:35], s12 offen offset:0 lds
    v_mfma_f32_16x16x32_bf16 a[44:47], a[156:159], v[168:171], a[44:47]
    ds_read_b64_tr_b16 a[140:141], v12 offset:24576
    v_mfma_f32_16x16x32_bf16 a[60:63], a[156:159], v[172:175], a[60:63]
    ds_read_b64_tr_b16 a[142:143], v12 offset:25088
    s_waitcnt lgkmcnt(8)
    v_mfma_f32_16x16x32_bf16 a[0:3], a[160:163], v[176:179], a[0:3]
    ds_read_b64_tr_b16 a[144:145], v9 offset:20480
    ds_read_b64_tr_b16 a[146:147], v9 offset:20992
    v_mfma_f32_16x16x32_bf16 a[16:19], a[160:163], v[180:183], a[16:19]
    v_dot2_f32_bf16 v32, v192, s58, v92
    v_dot2_f32_bf16 v33, v192, s59, v92
    v_dot2_f32_bf16 v34, v193, s58, v92
    v_dot2_f32_bf16 v35, v193, s59, v92
    v_dot2_f32_bf16 v36, v194, s58, v92
    v_dot2_f32_bf16 v37, v194, s59, v92
    v_dot2_f32_bf16 v38, v195, s58, v92
    v_dot2_f32_bf16 v39, v195, s59, v92
    v_dot2_f32_bf16 v40, v196, s58, v93
    v_dot2_f32_bf16 v41, v196, s59, v93
    v_dot2_f32_bf16 v42, v197, s58, v93
    v_dot2_f32_bf16 v43, v197, s59, v93
    v_dot2_f32_bf16 v44, v198, s58, v93
    v_dot2_f32_bf16 v45, v198, s59, v93
    v_dot2_f32_bf16 v46, v199, s58, v93
    v_dot2_f32_bf16 v47, v199, s59, v93
    v_dot2_f32_bf16 v48, v200, s58, v92
    v_dot2_f32_bf16 v49, v200, s59, v92
    v_dot2_f32_bf16 v50, v201, s58, v92
    v_dot2_f32_bf16 v51, v201, s59, v92
    v_dot2_f32_bf16 v52, v202, s58, v92
    v_dot2_f32_bf16 v53, v202, s59, v92
    v_dot2_f32_bf16 v54, v203, s58, v92
    v_dot2_f32_bf16 v55, v203, s59, v92
    v_dot2_f32_bf16 v56, v204, s58, v93
    v_dot2_f32_bf16 v57, v204, s59, v93
    v_dot2_f32_bf16 v58, v205, s58, v93
    v_dot2_f32_bf16 v59, v205, s59, v93
    v_dot2_f32_bf16 v60, v206, s58, v93
    v_dot2_f32_bf16 v61, v206, s59, v93
    v_dot2_f32_bf16 v62, v207, s58, v93
    v_dot2_f32_bf16 v63, v207, s59, v93
    v_mfma_f32_16x16x32_bf16 a[4:7], a[164:167], v[176:179], a[4:7]
    ds_read_b64_tr_b16 a[148:149], v10 offset:20480
    ds_read_b64_tr_b16 a[150:151], v10 offset:20992
    v_mfma_f32_16x16x32_bf16 a[20:23], a[164:167], v[180:183], a[20:23]
    v_cvt_pk_bf16_f32 v192, v32, v33
    v_cvt_pk_bf16_f32 v193, v34, v35
    v_mfma_f32_16x16x32_bf16 a[32:35], a[168:171], v[176:179], a[32:35]
    ds_read_b64_tr_b16 a[152:153], v11 offset:20480
    ds_read_b64_tr_b16 a[154:155], v11 offset:20992
    v_mfma_f32_16x16x32_bf16 a[48:51], a[168:171], v[180:183], a[48:51]
    buffer_load_dwordx4 v2, s[32:35], s12 offen offset:1024 lds
    v_mfma_f32_16x16x32_bf16 a[36:39], a[172:175], v[176:179], a[36:39]
    ds_read_b64_tr_b16 a[156:157], v12 offset:20480
    ds_read_b64_tr_b16 a[158:159], v12 offset:20992
    v_mfma_f32_16x16x32_bf16 a[52:55], a[172:175], v[180:183], a[52:55]
    v_cvt_pk_bf16_f32 v194, v36, v37
    v_cvt_pk_bf16_f32 v195, v38, v39
    s_waitcnt lgkmcnt(8)
    v_mfma_f32_16x16x32_bf16 a[8:11], a[128:131], v[176:179], a[8:11]
    ds_read_b64_tr_b16 a[160:161], v9 offset:28672
    ds_read_b64_tr_b16 a[162:163], v9 offset:29184
    v_mfma_f32_16x16x32_bf16 a[24:27], a[128:131], v[180:183], a[24:27]
    ds_read_b64_tr_b16 a[164:165], v10 offset:28672
    v_cvt_pk_bf16_f32 v196, v40, v41
    v_cvt_pk_bf16_f32 v197, v42, v43
    v_mfma_f32_16x16x32_bf16 a[12:15], a[132:135], v[176:179], a[12:15]
    ds_read_b64_tr_b16 a[166:167], v10 offset:29184
    ds_read_b64_tr_b16 a[168:169], v11 offset:28672
    v_mfma_f32_16x16x32_bf16 a[28:31], a[132:135], v[180:183], a[28:31]
    ds_read_b64_tr_b16 a[170:171], v11 offset:29184
    v_cvt_pk_bf16_f32 v198, v44, v45
    v_cvt_pk_bf16_f32 v199, v46, v47
    v_mfma_f32_16x16x32_bf16 a[40:43], a[136:139], v[176:179], a[40:43]
    ds_read_b64_tr_b16 a[172:173], v12 offset:28672
    ds_read_b64_tr_b16 a[174:175], v12 offset:29184
    v_mfma_f32_16x16x32_bf16 a[56:59], a[136:139], v[180:183], a[56:59]
    buffer_load_dwordx4 v3, s[32:35], s12 offen offset:2048 lds
    v_mfma_f32_16x16x32_bf16 a[44:47], a[140:143], v[176:179], a[44:47]
    v_mfma_f32_16x16x32_bf16 a[60:63], a[140:143], v[180:183], a[60:63]
    s_waitcnt vmcnt(15)
    s_barrier
    s_waitcnt lgkmcnt(8)
    v_mfma_f32_16x16x32_bf16 a[0:3], a[144:147], v[184:187], a[0:3]
    ds_read_b64_tr_b16 a[128:129], v5 offset:0
    ds_read_b64_tr_b16 a[130:131], v5 offset:512
    v_mfma_f32_16x16x32_bf16 a[16:19], a[144:147], v[188:191], a[16:19]
    buffer_load_dwordx4 v4, s[32:35], s12 offen offset:3072 lds
    v_cvt_pk_bf16_f32 v200, v48, v49
    v_mfma_f32_16x16x32_bf16 a[4:7], a[148:151], v[184:187], a[4:7]
    ds_read_b64_tr_b16 a[132:133], v6 offset:0
    ds_read_b64_tr_b16 a[134:135], v6 offset:512
    s_add_u32 m0, s11, 49152
    v_mfma_f32_16x16x32_bf16 a[20:23], a[148:151], v[188:191], a[20:23]
    s_sub_u32 s12, s12, s13
    s_cselect_b32 s12, s14, s12
    v_cvt_pk_bf16_f32 v201, v50, v51
    v_cvt_pk_bf16_f32 v202, v52, v53
    v_mfma_f32_16x16x32_bf16 a[32:35], a[152:155], v[184:187], a[32:35]
    ds_read_b64_tr_b16 a[136:137], v7 offset:0
    ds_read_b64_tr_b16 a[138:139], v7 offset:512
    v_mfma_f32_16x16x32_bf16 a[48:51], a[152:155], v[188:191], a[48:51]
    buffer_load_dwordx4 v1, s[32:35], s12 offen offset:0 lds
    v_mfma_f32_16x16x32_bf16 a[36:39], a[156:159], v[184:187], a[36:39]
    ds_read_b64_tr_b16 a[140:141], v8 offset:0
    ds_read_b64_tr_b16 a[142:143], v8 offset:512
    v_mfma_f32_16x16x32_bf16 a[52:55], a[156:159], v[188:191], a[52:55]
    v_cvt_pk_bf16_f32 v203, v54, v55
    v_cvt_pk_bf16_f32 v204, v56, v57
    s_waitcnt lgkmcnt(8)
    v_mfma_f32_16x16x32_bf16 a[8:11], a[160:163], v[184:187], a[8:11]
    ds_read_b64_tr_b16 a[144:145], v5 offset:8192
    ds_read_b64_tr_b16 a[146:147], v5 offset:8704
    v_mfma_f32_16x16x32_bf16 a[24:27], a[160:163], v[188:191], a[24:27]
    v_cvt_pk_bf16_f32 v205, v58, v59
    v_cvt_pk_bf16_f32 v206, v60, v61
    v_mfma_f32_16x16x32_bf16 a[12:15], a[164:167], v[184:187], a[12:15]
    ds_read_b64_tr_b16 a[148:149], v6 offset:8192
    v_mfma_f32_16x16x32_bf16 a[28:31], a[164:167], v[188:191], a[28:31]
    ds_read_b64_tr_b16 a[150:151], v6 offset:8704
    v_cvt_pk_bf16_f32 v207, v62, v63
    v_mfma_f32_16x16x32_bf16 a[40:43], a[168:171], v[184:187], a[40:43]
    ds_read_b64_tr_b16 a[152:153], v7 offset:8192
    ds_read_b64_tr_b16 a[154:155], v7 offset:8704
    buffer_load_dwordx4 v2, s[32:35], s12 offen offset:1024 lds
    v_mfma_f32_16x16x32_bf16 a[56:59], a[168:171], v[188:191], a[56:59]
    buffer_store_dwordx4 v[64:67], v31, s[16:19], s53 offen sc1
    v_mfma_f32_16x16x32_bf16 a[44:47], a[172:175], v[184:187], a[44:47]
    ds_read_b64_tr_b16 a[156:157], v8 offset:8192
    ds_read_b64_tr_b16 a[158:159], v8 offset:8704
    v_mfma_f32_16x16x32_bf16 a[60:63], a[172:175], v[188:191], a[60:63]
    buffer_store_dwordx4 v[68:71], v31, s[16:19], s54 offen sc1
    s_waitcnt lgkmcnt(8)
    v_mfma_f32_16x16x32_bf16 a[0:3], a[128:131], v[192:195], a[0:3]
    ds_read_b64_tr_b16 a[160:161], v5 offset:4096
    ds_read_b64_tr_b16 a[162:163], v5 offset:4608
    v_mfma_f32_16x16x32_bf16 a[16:19], a[128:131], v[196:199], a[16:19]
    v_dot2_f32_bf16 v32, v208, s58, v92
    v_dot2_f32_bf16 v33, v208, s59, v92
    v_dot2_f32_bf16 v34, v209, s58, v92
    v_dot2_f32_bf16 v35, v209, s59, v92
    v_dot2_f32_bf16 v36, v210, s58, v92
    v_dot2_f32_bf16 v37, v210, s59, v92
    v_dot2_f32_bf16 v38, v211, s58, v92
    v_dot2_f32_bf16 v39, v211, s59, v92
    v_dot2_f32_bf16 v40, v212, s58, v93
    v_dot2_f32_bf16 v41, v212, s59, v93
    v_dot2_f32_bf16 v42, v213, s58, v93
    v_dot2_f32_bf16 v43, v213, s59, v93
    v_dot2_f32_bf16 v44, v214, s58, v93
    v_dot2_f32_bf16 v45, v214, s59, v93
    v_dot2_f32_bf16 v46, v215, s58, v93
    v_dot2_f32_bf16 v47, v215, s59, v93
    v_dot2_f32_bf16 v48, v216, s58, v92
    v_dot2_f32_bf16 v49, v216, s59, v92
    v_dot2_f32_bf16 v50, v217, s58, v92
    v_dot2_f32_bf16 v51, v217, s59, v92
    v_dot2_f32_bf16 v52, v218, s58, v92
    v_dot2_f32_bf16 v53, v218, s59, v92
    v_dot2_f32_bf16 v54, v219, s58, v92
    v_dot2_f32_bf16 v55, v219, s59, v92
    v_dot2_f32_bf16 v56, v220, s58, v93
    v_dot2_f32_bf16 v57, v220, s59, v93
    v_dot2_f32_bf16 v58, v221, s58, v93
    v_dot2_f32_bf16 v59, v221, s59, v93
    v_dot2_f32_bf16 v60, v222, s58, v93
    v_dot2_f32_bf16 v61, v222, s59, v93
    v_dot2_f32_bf16 v62, v223, s58, v93
    v_dot2_f32_bf16 v63, v223, s59, v93
    v_mfma_f32_16x16x32_bf16 a[4:7], a[132:135], v[192:195], a[4:7]
    ds_read_b64_tr_b16 a[164:165], v6 offset:4096
    ds_read_b64_tr_b16 a[166:167], v6 offset:4608
    v_cvt_pk_bf16_f32 v208, v32, v33
    v_cvt_pk_bf16_f32 v209, v34, v35
    v_mfma_f32_16x16x32_bf16 a[20:23], a[132:135], v[196:199], a[20:23]
    buffer_store_dwordx4 v[72:75], v31, s[16:19], s55 offen sc1
    v_mfma_f32_16x16x32_bf16 a[32:35], a[136:139], v[192:195], a[32:35]
    ds_read_b64_tr_b16 a[168:169], v7 offset:4096
    ds_read_b64_tr_b16 a[170:171], v7 offset:4608
    buffer_load_dwordx4 v3, s[32:35], s12 offen offset:2048 lds
    v_mfma_f32_16x16x32_bf16 a[48:51], a[136:139], v[196:199], a[48:51]
    buffer_store_dwordx4 v[76:79], v31, s[16:19], s56 offen sc1
    v_mfma_f32_16x16x32_bf16 a[36:39], a[140:143], v[192:195], a[36:39]
    ds_read_b64_tr_b16 a[172:173], v8 offset:4096
    ds_read_b64_tr_b16 a[174:175], v8 offset:4608
    v_mfma_f32_16x16x32_bf16 a[52:55], a[140:143], v[196:199], a[52:55]
    v_cvt_pk_bf16_f32 v210, v36, v37
    v_cvt_pk_bf16_f32 v211, v38, v39
    s_waitcnt lgkmcnt(8)
    v_mfma_f32_16x16x32_bf16 a[8:11], a[144:147], v[192:195], a[8:11]
    ds_read_b64_tr_b16 a[128:129], v5 offset:12288
    ds_read_b64_tr_b16 a[130:131], v5 offset:12800
    v_mfma_f32_16x16x32_bf16 a[24:27], a[144:147], v[196:199], a[24:27]
    v_cvt_pk_bf16_f32 v212, v40, v41
    v_cvt_pk_bf16_f32 v213, v42, v43
    v_mfma_f32_16x16x32_bf16 a[12:15], a[148:151], v[192:195], a[12:15]
    ds_read_b64_tr_b16 a[132:133], v6 offset:12288
    ds_read_b64_tr_b16 a[134:135], v6 offset:12800
    v_mfma_f32_16x16x32_bf16 a[28:31], a[148:151], v[196:199], a[28:31]
    v_cvt_pk_bf16_f32 v214, v44, v45
    v_cvt_pk_bf16_f32 v215, v46, v47
    v_mfma_f32_16x16x32_bf16 a[40:43], a[152:155], v[192:195], a[40:43]
    ds_read_b64_tr_b16 a[136:137], v7 offset:12288
    ds_read_b64_tr_b16 a[138:139], v7 offset:12800
    v_mfma_f32_16x16x32_bf16 a[56:59], a[152:155], v[196:199], a[56:59]
    buffer_load_dwordx4 v4, s[32:35], s12 offen offset:3072 lds
    v_mfma_f32_16x16x32_bf16 a[44:47], a[156:159], v[192:195], a[44:47]
    ds_read_b64_tr_b16 a[140:141], v8 offset:12288
    v_mfma_f32_16x16x32_bf16 a[60:63], a[156:159], v[196:199], a[60:63]
    ds_read_b64_tr_b16 a[142:143], v8 offset:12800
    s_waitcnt lgkmcnt(8)
    v_mfma_f32_16x16x32_bf16 a[0:3], a[160:163], v[200:203], a[0:3]
    ds_read_b64_tr_b16 a[144:145], v9 offset:49152
    v_mfma_f32_16x16x32_bf16 a[16:19], a[160:163], v[204:207], a[16:19]
    ds_read_b64_tr_b16 a[146:147], v9 offset:49664
    v_cvt_pk_bf16_f32 v216, v48, v49
    v_mfma_f32_16x16x32_bf16 a[4:7], a[164:167], v[200:203], a[4:7]
    ds_read_b64_tr_b16 a[148:149], v10 offset:49152
    ds_read_b64_tr_b16 a[150:151], v10 offset:49664
    s_add_u32 m0, s11, 65536
    v_mfma_f32_16x16x32_bf16 a[20:23], a[164:167], v[204:207], a[20:23]
    s_sub_u32 s12, s12, s13
    s_cselect_b32 s12, s14, s12
    v_cvt_pk_bf16_f32 v217, v50, v51
    v_cvt_pk_bf16_f32 v218, v52, v53
    v_mfma_f32_16x16x32_bf16 a[32:35], a[168:171], v[200:203], a[32:35]
    ds_read_b64_tr_b16 a[152:153], v11 offset:49152
    ds_read_b64_tr_b16 a[154:155], v11 offset:49664
    v_mfma_f32_16x16x32_bf16 a[48:51], a[168:171], v[204:207], a[48:51]
    buffer_load_dwordx4 v1, s[32:35], s12 offen offset:0 lds
    v_mfma_f32_16x16x32_bf16 a[36:39], a[172:175], v[200:203], a[36:39]
    ds_read_b64_tr_b16 a[156:157], v12 offset:49152
    ds_read_b64_tr_b16 a[158:159], v12 offset:49664
    v_mfma_f32_16x16x32_bf16 a[52:55], a[172:175], v[204:207], a[52:55]
    v_cvt_pk_bf16_f32 v219, v54, v55
    v_cvt_pk_bf16_f32 v220, v56, v57
    s_waitcnt lgkmcnt(8)
    v_mfma_f32_16x16x32_bf16 a[8:11], a[128:131], v[200:203], a[8:11]
    ds_read_b64_tr_b16 a[160:161], v9 offset:57344
    ds_read_b64_tr_b16 a[162:163], v9 offset:57856
    v_mfma_f32_16x16x32_bf16 a[24:27], a[128:131], v[204:207], a[24:27]
    v_cvt_pk_bf16_f32 v221, v58, v59
    v_cvt_pk_bf16_f32 v222, v60, v61
    v_mfma_f32_16x16x32_bf16 a[12:15], a[132:135], v[200:203], a[12:15]
    ds_read_b64_tr_b16 a[164:165], v10 offset:57344
    v_mfma_f32_16x16x32_bf16 a[28:31], a[132:135], v[204:207], a[28:31]
    ds_read_b64_tr_b16 a[166:167], v10 offset:57856
    v_cvt_pk_bf16_f32 v223, v62, v63
    v_mfma_f32_16x16x32_bf16 a[40:43], a[136:139], v[200:203], a[40:43]
    ds_read_b64_tr_b16 a[168:169], v11 offset:57344
    ds_read_b64_tr_b16 a[170:171], v11 offset:57856
    buffer_load_dwordx4 v2, s[32:35], s12 offen offset:1024 lds
    v_mfma_f32_16x16x32_bf16 a[56:59], a[136:139], v[204:207], a[56:59]
    s_mov_b64 exec, 16383
    buffer_load_dword v94, v94, s[32:35], 0 offen offset:2048
    s_mov_b64 exec, -1
    v_mfma_f32_16x16x32_bf16 a[44:47], a[140:143], v[200:203], a[44:47]
    ds_read_b64_tr_b16 a[172:173], v12 offset:57344
    v_mfma_f32_16x16x32_bf16 a[60:63], a[140:143], v[204:207], a[60:63]
    ds_read_b64_tr_b16 a[174:175], v12 offset:57856
    s_waitcnt lgkmcnt(8)
    v_mfma_f32_16x16x32_bf16 a[0:3], a[144:147], v[208:211], a[0:3]
    ds_read_b64_tr_b16 a[128:129], v9 offset:53248
    ds_read_b64_tr_b16 a[130:131], v9 offset:53760
    v_mfma_f32_16x16x32_bf16 a[16:19], a[144:147], v[212:215], a[16:19]
    v_dot2_f32_bf16 v32, v224, s58, v92
    v_dot2_f32_bf16 v33, v224, s59, v92
    v_dot2_f32_bf16 v34, v225, s58, v92
    v_dot2_f32_bf16 v35, v225, s59, v92
    v_dot2_f32_bf16 v36, v226, s58, v92
    v_dot2_f32_bf16 v37, v226, s59, v92
    v_dot2_f32_bf16 v38, v227, s58, v92
    v_dot2_f32_bf16 v39, v227, s59, v92
    v_dot2_f32_bf16 v40, v228, s58, v93
    v_dot2_f32_bf16 v41, v228, s59, v93
    v_dot2_f32_bf16 v42, v229, s58, v93
    v_dot2_f32_bf16 v43, v229, s59, v93
    v_dot2_f32_bf16 v44, v230, s58, v93
    v_dot2_f32_bf16 v45, v230, s59, v93
    v_dot2_f32_bf16 v46, v231, s58, v93
    v_dot2_f32_bf16 v47, v231, s59, v93
    v_dot2_f32_bf16 v48, v232, s58, v92
    v_dot2_f32_bf16 v49, v232, s59, v92
    v_dot2_f32_bf16 v50, v233, s58, v92
    v_dot2_f32_bf16 v51, v233, s59, v92
    v_dot2_f32_bf16 v52, v234, s58, v92
    v_dot2_f32_bf16 v53, v234, s59, v92
    v_dot2_f32_bf16 v54, v235, s58, v92
    v_dot2_f32_bf16 v55, v235, s59, v92
    v_dot2_f32_bf16 v56, v236, s58, v93
    v_dot2_f32_bf16 v57, v236, s59, v93
    v_dot2_f32_bf16 v58, v237, s58, v93
    v_dot2_f32_bf16 v59, v237, s59, v93
    v_dot2_f32_bf16 v60, v238, s58, v93
    v_dot2_f32_bf16 v61, v238, s59, v93
    v_dot2_f32_bf16 v62, v239, s58, v93
    v_dot2_f32_bf16 v63, v239, s59, v93
    v_mfma_f32_16x16x32_bf16 a[4:7], a[148:151], v[208:211], a[4:7]
    ds_read_b64_tr_b16 a[132:133], v10 offset:53248
    ds_read_b64_tr_b16 a[134:135], v10 offset:53760
    v_mfma_f32_16x16x32_bf16 a[20:23], a[148:151], v[212:215], a[20:23]
    v_cvt_pk_bf16_f32 v224, v32, v33
    v_cvt_pk_bf16_f32 v225, v34, v35
    v_mfma_f32_16x16x32_bf16 a[32:35], a[152:155], v[208:211], a[32:35]
    ds_read_b64_tr_b16 a[136:137], v11 offset:53248
    ds_read_b64_tr_b16 a[138:139], v11 offset:53760
    v_mfma_f32_16x16x32_bf16 a[48:51], a[152:155], v[212:215], a[48:51]
    buffer_load_dwordx4 v3, s[32:35], s12 offen offset:2048 lds
    v_mfma_f32_16x16x32_bf16 a[36:39], a[156:159], v[208:211], a[36:39]
    ds_read_b64_tr_b16 a[140:141], v12 offset:53248
    ds_read_b64_tr_b16 a[142:143], v12 offset:53760
    v_mfma_f32_16x16x32_bf16 a[52:55], a[156:159], v[212:215], a[52:55]
    v_cvt_pk_bf16_f32 v226, v36, v37
    v_cvt_pk_bf16_f32 v227, v38, v39
    s_waitcnt lgkmcnt(8)
    v_mfma_f32_16x16x32_bf16 a[8:11], a[160:163], v[208:211], a[8:11]
    ds_read_b64_tr_b16 a[144:145], v9 offset:61440
    ds_read_b64_tr_b16 a[146:147], v9 offset:61952
    v_mfma_f32_16x16x32_bf16 a[24:27], a[160:163], v[212:215], a[24:27]
    ds_read_b64_tr_b16 a[148:149], v10 offset:61440
    v_cvt_pk_bf16_f32 v228, v40, v41
    v_cvt_pk_bf16_f32 v229, v42, v43
    v_mfma_f32_16x16x32_bf16 a[12:15], a[164:167], v[208:211], a[12:15]
    ds_read_b64_tr_b16 a[150:151], v10 offset:61952
    ds_read_b64_tr_b16 a[152:153], v11 offset:61440
    v_mfma_f32_16x16x32_bf16 a[28:31], a[164:167], v[212:215], a[28:31]
    ds_read_b64_tr_b16 a[154:155], v11 offset:61952
    v_cvt_pk_bf16_f32 v230, v44, v45
    v_cvt_pk_bf16_f32 v231, v46, v47
    v_mfma_f32_16x16x32_bf16 a[40:43], a[168:171], v[208:211], a[40:43]
    ds_read_b64_tr_b16 a[156:157], v12 offset:61440
    ds_read_b64_tr_b16 a[158:159], v12 offset:61952
    v_mfma_f32_16x16x32_bf16 a[56:59], a[168:171], v[212:215], a[56:59]
    buffer_load_dwordx4 v4, s[32:35], s12 offen offset:3072 lds
    v_mfma_f32_16x16x32_bf16 a[44:47], a[172:175], v[208:211], a[44:47]
    v_mfma_f32_16x16x32_bf16 a[60:63], a[172:175], v[212:215], a[60:63]
    s_waitcnt vmcnt(21)
    s_barrier
    s_waitcnt lgkmcnt(8)
    v_mfma_f32_16x16x32_bf16 a[0:3], a[128:131], v[216:219], a[0:3]
    ds_read_b64_tr_b16 a[160:161], v13 offset:0
    v_mfma_f32_16x16x32_bf16 a[16:19], a[128:131], v[220:223], a[16:19]
    ds_read_b64_tr_b16 a[162:163], v13 offset:512
    v_cvt_pk_bf16_f32 v232, v48, v49
    v_mfma_f32_16x16x32_bf16 a[4:7], a[132:135], v[216:219], a[4:7]
    ds_read_b64_tr_b16 a[164:165], v14 offset:0
    ds_read_b64_tr_b16 a[166:167], v14 offset:512
    s_add_u32 m0, s11, 0
    v_mfma_f32_16x16x32_bf16 a[20:23], a[132:135], v[220:223], a[20:23]
    s_sub_u32 s12, s12, s13
    s_cselect_b32 s12, s14, s12
    v_cvt_pk_bf16_f32 v233, v50, v51
    v_cvt_pk_bf16_f32 v234, v52, v53
    v_mfma_f32_16x16x32_bf16 a[32:35], a[136:139], v[216:219], a[32:35]
    ds_read_b64_tr_b16 a[168:169], v15 offset:0
    ds_read_b64_tr_b16 a[170:171], v15 offset:512
    v_mfma_f32_16x16x32_bf16 a[48:51], a[136:139], v[220:223], a[48:51]
    buffer_load_dwordx4 v1, s[32:35], s12 offen offset:0 lds
    v_mfma_f32_16x16x32_bf16 a[36:39], a[140:143], v[216:219], a[36:39]
    ds_read_b64_tr_b16 a[172:173], v16 offset:0
    ds_read_b64_tr_b16 a[174:175], v16 offset:512
    v_mfma_f32_16x16x32_bf16 a[52:55], a[140:143], v[220:223], a[52:55]
    v_cvt_pk_bf16_f32 v235, v54, v55
    v_cvt_pk_bf16_f32 v236, v56, v57
    s_waitcnt lgkmcnt(8)
    v_mfma_f32_16x16x32_bf16 a[8:11], a[144:147], v[216:219], a[8:11]
    ds_read_b64_tr_b16 a[128:129], v13 offset:8192
    ds_read_b64_tr_b16 a[130:131], v13 offset:8704
    v_cvt_pk_bf16_f32 v237, v58, v59
    v_cvt_pk_bf16_f32 v238, v60, v61
    s_waitcnt vmcnt(7)
    v_mov_b64 v[80:81], s[60:61]
    s_add_u32 s100, s62, 8192
    v_mfma_f32_16x16x32_bf16 a[24:27], a[144:147], v[220:223], a[24:27]
    s_mov_b64 exec, 1
    buffer_store_dwordx2 v[80:81], off, s[16:19], s100 sc1
    s_mov_b64 exec, -1
    v_mfma_f32_16x16x32_bf16 a[12:15], a[148:151], v[216:219], a[12:15]
    ds_read_b64_tr_b16 a[132:133], v14 offset:8192
    v_mfma_f32_16x16x32_bf16 a[28:31], a[148:151], v[220:223], a[28:31]
    ds_read_b64_tr_b16 a[134:135], v14 offset:8704
    v_cvt_pk_bf16_f32 v239, v62, v63
    v_mfma_f32_16x16x32_bf16 a[40:43], a[152:155], v[216:219], a[40:43]
    ds_read_b64_tr_b16 a[136:137], v15 offset:8192
    ds_read_b64_tr_b16 a[138:139], v15 offset:8704
    v_mfma_f32_16x16x32_bf16 a[56:59], a[152:155], v[220:223], a[56:59]
    buffer_load_dwordx4 v2, s[32:35], s12 offen offset:1024 lds
    v_mfma_f32_16x16x32_bf16 a[44:47], a[156:159], v[216:219], a[44:47]
    ds_read_b64_tr_b16 a[140:141], v16 offset:8192
    v_mfma_f32_16x16x32_bf16 a[60:63], a[156:159], v[220:223], a[60:63]
    ds_read_b64_tr_b16 a[142:143], v16 offset:8704
    s_waitcnt lgkmcnt(8)
    v_mfma_f32_16x16x32_bf16 a[0:3], a[160:163], v[224:227], a[0:3]
    ds_read_b64_tr_b16 a[144:145], v13 offset:4096
    ds_read_b64_tr_b16 a[146:147], v13 offset:4608
    v_mfma_f32_16x16x32_bf16 a[16:19], a[160:163], v[228:231], a[16:19]
    v_dot2_f32_bf16 v32, v240, s58, v92
    v_dot2_f32_bf16 v33, v240, s59, v92
    v_dot2_f32_bf16 v34, v241, s58, v92
    v_dot2_f32_bf16 v35, v241, s59, v92
    v_dot2_f32_bf16 v36, v242, s58, v92
    v_dot2_f32_bf16 v37, v242, s59, v92
    v_dot2_f32_bf16 v38, v243, s58, v92
    v_dot2_f32_bf16 v39, v243, s59, v92
    v_dot2_f32_bf16 v40, v244, s58, v93
    v_dot2_f32_bf16 v41, v244, s59, v93
    v_dot2_f32_bf16 v42, v245, s58, v93
    v_dot2_f32_bf16 v43, v245, s59, v93
    v_dot2_f32_bf16 v44, v246, s58, v93
    v_dot2_f32_bf16 v45, v246, s59, v93
    v_dot2_f32_bf16 v46, v247, s58, v93
    v_dot2_f32_bf16 v47, v247, s59, v93
    v_dot2_f32_bf16 v48, v248, s58, v92
    v_dot2_f32_bf16 v49, v248, s59, v92
    v_dot2_f32_bf16 v50, v249, s58, v92
    v_dot2_f32_bf16 v51, v249, s59, v92
    v_dot2_f32_bf16 v52, v250, s58, v92
    v_dot2_f32_bf16 v53, v250, s59, v92
    v_dot2_f32_bf16 v54, v251, s58, v92
    v_dot2_f32_bf16 v55, v251, s59, v92
    v_dot2_f32_bf16 v56, v252, s58, v93
    v_dot2_f32_bf16 v57, v252, s59, v93
    v_dot2_f32_bf16 v58, v253, s58, v93
    v_dot2_f32_bf16 v59, v253, s59, v93
    v_dot2_f32_bf16 v60, v254, s58, v93
    v_dot2_f32_bf16 v61, v254, s59, v93
    v_dot2_f32_bf16 v62, v255, s58, v93
    v_dot2_f32_bf16 v63, v255, s59, v93
    v_mfma_f32_16x16x32_bf16 a[4:7], a[164:167], v[224:227], a[4:7]
    ds_read_b64_tr_b16 a[148:149], v14 offset:4096
    ds_read_b64_tr_b16 a[150:151], v14 offset:4608
    v_mfma_f32_16x16x32_bf16 a[20:23], a[164:167], v[228:231], a[20:23]
    v_cvt_pk_bf16_f32 v240, v32, v33
    v_cvt_pk_bf16_f32 v241, v34, v35
    v_mfma_f32_16x16x32_bf16 a[32:35], a[168:171], v[224:227], a[32:35]
    ds_read_b64_tr_b16 a[152:153], v15 offset:4096
    ds_read_b64_tr_b16 a[154:155], v15 offset:4608
    v_mfma_f32_16x16x32_bf16 a[48:51], a[168:171], v[228:231], a[48:51]
    buffer_load_dwordx4 v3, s[32:35], s12 offen offset:2048 lds
    v_mfma_f32_16x16x32_bf16 a[36:39], a[172:175], v[224:227], a[36:39]
    ds_read_b64_tr_b16 a[156:157], v16 offset:4096
    ds_read_b64_tr_b16 a[158:159], v16 offset:4608
    v_mfma_f32_16x16x32_bf16 a[52:55], a[172:175], v[228:231], a[52:55]
    v_cvt_pk_bf16_f32 v242, v36, v37
    v_cvt_pk_bf16_f32 v243, v38, v39
    s_waitcnt lgkmcnt(8)
    v_mfma_f32_16x16x32_bf16 a[8:11], a[128:131], v[224:227], a[8:11]
    ds_read_b64_tr_b16 a[160:161], v13 offset:12288
    ds_read_b64_tr_b16 a[162:163], v13 offset:12800
    v_mfma_f32_16x16x32_bf16 a[24:27], a[128:131], v[228:231], a[24:27]
    v_cvt_pk_bf16_f32 v244, v40, v41
    v_cvt_pk_bf16_f32 v245, v42, v43
    v_mfma_f32_16x16x32_bf16 a[12:15], a[132:135], v[224:227], a[12:15]
    ds_read_b64_tr_b16 a[164:165], v14 offset:12288
    ds_read_b64_tr_b16 a[166:167], v14 offset:12800
    v_mfma_f32_16x16x32_bf16 a[28:31], a[132:135], v[228:231], a[28:31]
    v_cvt_pk_bf16_f32 v246, v44, v45
    v_cvt_pk_bf16_f32 v247, v46, v47
    v_mfma_f32_16x16x32_bf16 a[40:43], a[136:139], v[224:227], a[40:43]
    ds_read_b64_tr_b16 a[168:169], v15 offset:12288
    ds_read_b64_tr_b16 a[170:171], v15 offset:12800
    v_mfma_f32_16x16x32_bf16 a[56:59], a[136:139], v[228:231], a[56:59]
    buffer_load_dwordx4 v4, s[32:35], s12 offen offset:3072 lds
    v_mfma_f32_16x16x32_bf16 a[44:47], a[140:143], v[224:227], a[44:47]
    ds_read_b64_tr_b16 a[172:173], v16 offset:12288
    v_mfma_f32_16x16x32_bf16 a[60:63], a[140:143], v[228:231], a[60:63]
    ds_read_b64_tr_b16 a[174:175], v16 offset:12800
    s_waitcnt lgkmcnt(8)
    v_mfma_f32_16x16x32_bf16 a[0:3], a[144:147], v[232:235], a[0:3]
    ds_read_b64_tr_b16 a[128:129], v13 offset:16384
    v_mfma_f32_16x16x32_bf16 a[16:19], a[144:147], v[236:239], a[16:19]
    ds_read_b64_tr_b16 a[130:131], v13 offset:16896
    v_cvt_pk_bf16_f32 v248, v48, v49
    v_mfma_f32_16x16x32_bf16 a[4:7], a[148:151], v[232:235], a[4:7]
    ds_read_b64_tr_b16 a[132:133], v14 offset:16384
    ds_read_b64_tr_b16 a[134:135], v14 offset:16896
    s_add_u32 m0, s11, 81920
    v_mfma_f32_16x16x32_bf16 a[20:23], a[148:151], v[236:239], a[20:23]
    s_sub_u32 s12, s12, s13
    s_cselect_b32 s12, s14, s12
    v_cvt_pk_bf16_f32 v249, v50, v51
    v_cvt_pk_bf16_f32 v250, v52, v53
    v_mfma_f32_16x16x32_bf16 a[32:35], a[152:155], v[232:235], a[32:35]
    ds_read_b64_tr_b16 a[136:137], v15 offset:16384
    ds_read_b64_tr_b16 a[138:139], v15 offset:16896
    v_mfma_f32_16x16x32_bf16 a[48:51], a[152:155], v[236:239], a[48:51]
    buffer_load_dwordx4 v1, s[32:35], s12 offen offset:0 lds
    v_mfma_f32_16x16x32_bf16 a[36:39], a[156:159], v[232:235], a[36:39]
    ds_read_b64_tr_b16 a[140:141], v16 offset:16384
    ds_read_b64_tr_b16 a[142:143], v16 offset:16896
    v_mfma_f32_16x16x32_bf16 a[52:55], a[156:159], v[236:239], a[52:55]
    v_cvt_pk_bf16_f32 v251, v54, v55
    v_cvt_pk_bf16_f32 v252, v56, v57
    s_waitcnt lgkmcnt(8)
    v_mfma_f32_16x16x32_bf16 a[8:11], a[160:163], v[232:235], a[8:11]
    ds_read_b64_tr_b16 a[144:145], v13 offset:24576
    ds_read_b64_tr_b16 a[146:147], v13 offset:25088
    v_mfma_f32_16x16x32_bf16 a[24:27], a[160:163], v[236:239], a[24:27]
    v_cvt_pk_bf16_f32 v253, v58, v59
    v_cvt_pk_bf16_f32 v254, v60, v61
    v_mfma_f32_16x16x32_bf16 a[12:15], a[164:167], v[232:235], a[12:15]
    ds_read_b64_tr_b16 a[148:149], v14 offset:24576
    v_mfma_f32_16x16x32_bf16 a[28:31], a[164:167], v[236:239], a[28:31]
    ds_read_b64_tr_b16 a[150:151], v14 offset:25088
    v_cvt_pk_bf16_f32 v255, v62, v63
    v_mfma_f32_16x16x32_bf16 a[40:43], a[168:171], v[232:235], a[40:43]
    ds_read_b64_tr_b16 a[152:153], v15 offset:24576
    ds_read_b64_tr_b16 a[154:155], v15 offset:25088
    v_mfma_f32_16x16x32_bf16 a[56:59], a[168:171], v[236:239], a[56:59]
    buffer_load_dwordx4 v2, s[32:35], s12 offen offset:1024 lds
    v_mfma_f32_16x16x32_bf16 a[44:47], a[172:175], v[232:235], a[44:47]
    ds_read_b64_tr_b16 a[156:157], v16 offset:24576
    v_mfma_f32_16x16x32_bf16 a[60:63], a[172:175], v[236:239], a[60:63]
    ds_read_b64_tr_b16 a[158:159], v16 offset:25088
    s_waitcnt lgkmcnt(8)
    v_mfma_f32_16x16x32_bf16 a[0:3], a[128:131], v[240:243], a[0:3]
    ds_read_b64_tr_b16 a[160:161], v13 offset:20480
    v_mfma_f32_16x16x32_bf16 a[16:19], a[128:131], v[244:247], a[16:19]
    ds_read_b64_tr_b16 a[162:163], v13 offset:20992
    v_mfma_f32_16x16x32_bf16 a[4:7], a[132:135], v[240:243], a[4:7]
    ds_read_b64_tr_b16 a[164:165], v14 offset:20480
    v_mfma_f32_16x16x32_bf16 a[20:23], a[132:135], v[244:247], a[20:23]
    ds_read_b64_tr_b16 a[166:167], v14 offset:20992
    v_mfma_f32_16x16x32_bf16 a[32:35], a[136:139], v[240:243], a[32:35]
    ds_read_b64_tr_b16 a[168:169], v15 offset:20480
    ds_read_b64_tr_b16 a[170:171], v15 offset:20992
    v_mfma_f32_16x16x32_bf16 a[48:51], a[136:139], v[244:247], a[48:51]
    buffer_load_dwordx4 v3, s[32:35], s12 offen offset:2048 lds
    v_mfma_f32_16x16x32_bf16 a[36:39], a[140:143], v[240:243], a[36:39]
    ds_read_b64_tr_b16 a[172:173], v16 offset:20480
    v_mfma_f32_16x16x32_bf16 a[52:55], a[140:143], v[244:247], a[52:55]
    ds_read_b64_tr_b16 a[174:175], v16 offset:20992
    s_waitcnt lgkmcnt(8)
    v_mfma_f32_16x16x32_bf16 a[8:11], a[144:147], v[240:243], a[8:11]
    ds_read_b64_tr_b16 a[128:129], v13 offset:28672
    v_mfma_f32_16x16x32_bf16 a[24:27], a[144:147], v[244:247], a[24:27]
    ds_read_b64_tr_b16 a[130:131], v13 offset:29184
    ds_read_b64_tr_b16 a[132:133], v14 offset:28672
    v_mfma_f32_16x16x32_bf16 a[12:15], a[148:151], v[240:243], a[12:15]
    ds_read_b64_tr_b16 a[134:135], v14 offset:29184
    v_mfma_f32_16x16x32_bf16 a[28:31], a[148:151], v[244:247], a[28:31]
    ds_read_b64_tr_b16 a[136:137], v15 offset:28672
    ds_read_b64_tr_b16 a[138:139], v15 offset:29184
    v_mfma_f32_16x16x32_bf16 a[40:43], a[152:155], v[240:243], a[40:43]
    ds_read_b64_tr_b16 a[140:141], v16 offset:28672
    ds_read_b64_tr_b16 a[142:143], v16 offset:29184
    v_mfma_f32_16x16x32_bf16 a[56:59], a[152:155], v[244:247], a[56:59]
    buffer_load_dwordx4 v4, s[32:35], s12 offen offset:3072 lds
    v_mfma_f32_16x16x32_bf16 a[44:47], a[156:159], v[240:243], a[44:47]
    v_mfma_f32_16x16x32_bf16 a[60:63], a[156:159], v[244:247], a[60:63]
    s_waitcnt vmcnt(22)
    s_barrier
    s_waitcnt lgkmcnt(8)
    v_mfma_f32_16x16x32_bf16 a[0:3], a[160:163], v[248:251], a[0:3]
    ds_read_b64_tr_b16 a[144:145], v5 offset:16384
    v_mfma_f32_16x16x32_bf16 a[16:19], a[160:163], v[252:255], a[16:19]
    ds_read_b64_tr_b16 a[146:147], v5 offset:16896
    v_mfma_f32_16x16x32_bf16 a[4:7], a[164:167], v[248:251], a[4:7]
    ds_read_b64_tr_b16 a[148:149], v6 offset:16384
    ds_read_b64_tr_b16 a[150:151], v6 offset:16896
    v_mfma_f32_16x16x32_bf16 a[20:23], a[164:167], v[252:255], a[20:23]
    s_add_u32 m0, s11, 98304
    s_sub_u32 s12, s12, s13
    s_cselect_b32 s12, s14, s12
    v_mfma_f32_16x16x32_bf16 a[32:35], a[168:171], v[248:251], a[32:35]
    ds_read_b64_tr_b16 a[152:153], v7 offset:16384
    ds_read_b64_tr_b16 a[154:155], v7 offset:16896
    v_mfma_f32_16x16x32_bf16 a[48:51], a[168:171], v[252:255], a[48:51]
    buffer_load_dwordx4 v1, s[32:35], s12 offen offset:0 lds
    v_mfma_f32_16x16x32_bf16 a[36:39], a[172:175], v[248:251], a[36:39]
    ds_read_b64_tr_b16 a[156:157], v8 offset:16384
    v_mfma_f32_16x16x32_bf16 a[52:55], a[172:175], v[252:255], a[52:55]
    ds_read_b64_tr_b16 a[158:159], v8 offset:16896
    s_waitcnt lgkmcnt(8)
    v_mfma_f32_16x16x32_bf16 a[8:11], a[128:131], v[248:251], a[8:11]
    ds_read_b64_tr_b16 a[160:161], v5 offset:24576
    v_mfma_f32_16x16x32_bf16 a[24:27], a[128:131], v[252:255], a[24:27]
    ds_read_b64_tr_b16 a[162:163], v5 offset:25088
    v_mfma_f32_16x16x32_bf16 a[12:15], a[132:135], v[248:251], a[12:15]
    ds_read_b64_tr_b16 a[164:165], v6 offset:24576
    v_mfma_f32_16x16x32_bf16 a[28:31], a[132:135], v[252:255], a[28:31]
    ds_read_b64_tr_b16 a[166:167], v6 offset:25088
    v_mfma_f32_16x16x32_bf16 a[40:43], a[136:139], v[248:251], a[40:43]
    ds_read_b64_tr_b16 a[168:169], v7 offset:24576
    ds_read_b64_tr_b16 a[170:171], v7 offset:25088
    v_mfma_f32_16x16x32_bf16 a[56:59], a[136:139], v[252:255], a[56:59]
    buffer_load_dwordx4 v2, s[32:35], s12 offen offset:1024 lds
    v_mfma_f32_16x16x32_bf16 a[44:47], a[140:143], v[248:251], a[44:47]
    ds_read_b64_tr_b16 a[172:173], v8 offset:24576
    v_mfma_f32_16x16x32_bf16 a[60:63], a[140:143], v[252:255], a[60:63]
    ds_read_b64_tr_b16 a[174:175], v8 offset:25088
    s_waitcnt lgkmcnt(8)
    v_mfma_f32_16x16x32_bf16 a[64:67], a[144:147], v[96:99], 0
    ds_read_b64_tr_b16 a[128:129], v5 offset:20480
    v_mfma_f32_16x16x32_bf16 a[80:83], a[144:147], v[100:103], 0
    ds_read_b64_tr_b16 a[130:131], v5 offset:20992
    v_mfma_f32_16x16x32_bf16 a[68:71], a[148:151], v[96:99], 0
    ds_read_b64_tr_b16 a[132:133], v6 offset:20480
    v_mfma_f32_16x16x32_bf16 a[84:87], a[148:151], v[100:103], 0
    ds_read_b64_tr_b16 a[134:135], v6 offset:20992
    v_mfma_f32_16x16x32_bf16 a[96:99], a[152:155], v[96:99], 0
    ds_read_b64_tr_b16 a[136:137], v7 offset:20480
    ds_read_b64_tr_b16 a[138:139], v7 offset:20992
    v_mfma_f32_16x16x32_bf16 a[112:115], a[152:155], v[100:103], 0
    buffer_load_dwordx4 v3, s[32:35], s12 offen offset:2048 lds
    v_mfma_f32_16x16x32_bf16 a[100:103], a[156:159], v[96:99], 0
    ds_read_b64_tr_b16 a[140:141], v8 offset:20480
    v_mfma_f32_16x16x32_bf16 a[116:119], a[156:159], v[100:103], 0
    ds_read_b64_tr_b16 a[142:143], v8 offset:20992
    s_waitcnt lgkmcnt(8)
    v_mfma_f32_16x16x32_bf16 a[72:75], a[160:163], v[96:99], 0
    ds_read_b64_tr_b16 a[144:145], v5 offset:28672
    v_mfma_f32_16x16x32_bf16 a[88:91], a[160:163], v[100:103], 0
    ds_read_b64_tr_b16 a[146:147], v5 offset:29184
    s_add_u32 s30, s31, 4096
    v_mfma_f32_16x16x32_bf16 a[76:79], a[164:167], v[96:99], 0
    ds_read_b64_tr_b16 a[148:149], v6 offset:28672
    ds_read_b64_tr_b16 a[150:151], v6 offset:29184
    v_accvgpr_read_b32 v32, a0
    v_mfma_f32_16x16x32_bf16 a[92:95], a[164:167], v[100:103], 0
    v_accvgpr_read_b32 v33, a1
    v_accvgpr_read_b32 v34, a2
    v_accvgpr_read_b32 v35, a3
    v_accvgpr_read_b32 v36, a4
    v_mfma_f32_16x16x32_bf16 a[104:107], a[168:171], v[96:99], 0
    ds_read_b64_tr_b16 a[152:153], v7 offset:28672
    ds_read_b64_tr_b16 a[154:155], v7 offset:29184
    v_mfma_f32_16x16x32_bf16 a[120:123], a[168:171], v[100:103], 0
    buffer_load_dwordx4 v4, s[32:35], s12 offen offset:3072 lds
    v_accvgpr_read_b32 v37, a5
    v_mfma_f32_16x16x32_bf16 a[108:111], a[172:175], v[96:99], 0
    ds_read_b64_tr_b16 a[156:157], v8 offset:28672
    ds_read_b64_tr_b16 a[158:159], v8 offset:29184
    v_accvgpr_read_b32 v38, a6
    v_mfma_f32_16x16x32_bf16 a[124:127], a[172:175], v[100:103], 0
    v_accvgpr_read_b32 v39, a7
    v_accvgpr_read_b32 v40, a8
    s_waitcnt lgkmcnt(8)
    v_mfma_f32_16x16x32_bf16 a[64:67], a[128:131], v[104:107], a[64:67]
    ds_read_b64_tr_b16 a[160:161], v5 offset:32768
    v_mfma_f32_16x16x32_bf16 a[80:83], a[128:131], v[108:111], a[80:83]
    ds_read_b64_tr_b16 a[162:163], v5 offset:33280
    v_accvgpr_read_b32 v41, a9
    v_mfma_f32_16x16x32_bf16 a[68:71], a[132:135], v[104:107], a[68:71]
    ds_read_b64_tr_b16 a[164:165], v6 offset:32768
    ds_read_b64_tr_b16 a[166:167], v6 offset:33280
    s_add_u32 m0, s11, 114688
    s_sub_u32 s12, s12, s13
    s_cselect_b32 s12, s14, s12
    v_mfma_f32_16x16x32_bf16 a[84:87], a[132:135], v[108:111], a[84:87]
    v_accvgpr_read_b32 v42, a10
    v_accvgpr_read_b32 v43, a11
    v_accvgpr_read_b32 v44, a12
    v_accvgpr_read_b32 v45, a13
    v_accvgpr_read_b32 v46, a14
    v_mfma_f32_16x16x32_bf16 a[96:99], a[136:139], v[104:107], a[96:99]
    ds_read_b64_tr_b16 a[168:169], v7 offset:32768
    ds_read_b64_tr_b16 a[170:171], v7 offset:33280
    v_mfma_f32_16x16x32_bf16 a[112:115], a[136:139], v[108:111], a[112:115]
    buffer_load_dwordx4 v1, s[32:35], s12 offen offset:0 lds
    v_mfma_f32_16x16x32_bf16 a[100:103], a[140:143], v[104:107], a[100:103]
    ds_read_b64_tr_b16 a[172:173], v8 offset:32768
    ds_read_b64_tr_b16 a[174:175], v8 offset:33280
    v_accvgpr_read_b32 v47, a15
    v_mfma_f32_16x16x32_bf16 a[116:119], a[140:143], v[108:111], a[116:119]
    v_mul_f32 v32, v19, v32
    v_mul_f32 v33, v19, v33
    s_waitcnt lgkmcnt(8)
    v_mfma_f32_16x16x32_bf16 a[72:75], a[144:147], v[104:107], a[72:75]
    ds_read_b64_tr_b16 a[128:129], v5 offset:40960
    v_mfma_f32_16x16x32_bf16 a[88:91], a[144:147], v[108:111], a[88:91]
    ds_read_b64_tr_b16 a[130:131], v5 offset:41472
    v_mul_f32 v34, v19, v34
    v_mfma_f32_16x16x32_bf16 a[76:79], a[148:151], v[104:107], a[76:79]
    ds_read_b64_tr_b16 a[132:133], v6 offset:40960
    ds_read_b64_tr_b16 a[134:135], v6 offset:41472
    v_mul_f32 v35, v19, v35
    v_mfma_f32_16x16x32_bf16 a[92:95], a[148:151], v[108:111], a[92:95]
    v_mul_f32 v36, v19, v36
    v_mul_f32 v37, v19, v37
    v_mul_f32 v38, v19, v38
    v_mul_f32 v39, v19, v39
    v_mfma_f32_16x16x32_bf16 a[104:107], a[152:155], v[104:107], a[104:107]
    ds_read_b64_tr_b16 a[136:137], v7 offset:40960
    ds_read_b64_tr_b16 a[138:139], v7 offset:41472
    v_mfma_f32_16x16x32_bf16 a[120:123], a[152:155], v[108:111], a[120:123]
    buffer_load_dwordx4 v2, s[32:35], s12 offen offset:1024 lds
    v_mul_f32 v40, v19, v40
    v_mfma_f32_16x16x32_bf16 a[108:111], a[156:159], v[104:107], a[108:111]
    ds_read_b64_tr_b16 a[140:141], v8 offset:40960
    ds_read_b64_tr_b16 a[142:143], v8 offset:41472
    v_mul_f32 v41, v19, v41
    v_mfma_f32_16x16x32_bf16 a[124:127], a[156:159], v[108:111], a[124:127]
    v_mul_f32 v42, v19, v42
    v_mul_f32 v43, v19, v43
    s_waitcnt lgkmcnt(8)
    v_mfma_f32_16x16x32_bf16 a[64:67], a[160:163], v[112:115], a[64:67]
    ds_read_b64_tr_b16 a[144:145], v5 offset:36864
    v_mfma_f32_16x16x32_bf16 a[80:83], a[160:163], v[116:119], a[80:83]
    ds_read_b64_tr_b16 a[146:147], v5 offset:37376
    v_mul_f32 v44, v19, v44
    v_mfma_f32_16x16x32_bf16 a[68:71], a[164:167], v[112:115], a[68:71]
    ds_read_b64_tr_b16 a[148:149], v6 offset:36864
    ds_read_b64_tr_b16 a[150:151], v6 offset:37376
    v_mul_f32 v45, v19, v45
    v_mfma_f32_16x16x32_bf16 a[84:87], a[164:167], v[116:119], a[84:87]
    v_mul_f32 v46, v19, v46
    v_mul_f32 v47, v19, v47
    v_cvt_pk_bf16_f32 v48, v32, v33
    v_cvt_pk_bf16_f32 v49, v34, v35
    v_mfma_f32_16x16x32_bf16 a[96:99], a[168:171], v[112:115], a[96:99]
    ds_read_b64_tr_b16 a[152:153], v7 offset:36864
    ds_read_b64_tr_b16 a[154:155], v7 offset:37376
    v_mfma_f32_16x16x32_bf16 a[112:115], a[168:171], v[116:119], a[112:115]
    buffer_load_dwordx4 v3, s[32:35], s12 offen offset:2048 lds
    v_mfma_f32_16x16x32_bf16 a[100:103], a[172:175], v[112:115], a[100:103]
    ds_read_b64_tr_b16 a[156:157], v8 offset:36864
    ds_read_b64_tr_b16 a[158:159], v8 offset:37376
    v_cvt_pk_bf16_f32 v50, v36, v37
    v_mfma_f32_16x16x32_bf16 a[116:119], a[172:175], v[116:119], a[116:119]
    v_cvt_pk_bf16_f32 v51, v38, v39
    v_cvt_pk_bf16_f32 v52, v40, v41
    s_waitcnt lgkmcnt(8)
    v_mfma_f32_16x16x32_bf16 a[72:75], a[128:131], v[112:115], a[72:75]
    ds_read_b64_tr_b16 a[160:161], v5 offset:45056
    v_mfma_f32_16x16x32_bf16 a[88:91], a[128:131], v[116:119], a[88:91]
    ds_read_b64_tr_b16 a[162:163], v5 offset:45568
    ds_read_b64_tr_b16 a[164:165], v6 offset:45056
    v_mfma_f32_16x16x32_bf16 a[76:79], a[132:135], v[112:115], a[76:79]
    ds_read_b64_tr_b16 a[166:167], v6 offset:45568
    ds_read_b64_tr_b16 a[168:169], v7 offset:45056
    ds_read_b64_tr_b16 a[170:171], v7 offset:45568
    v_cvt_pk_bf16_f32 v53, v42, v43
    v_cvt_pk_bf16_f32 v54, v44, v45
    v_mfma_f32_16x16x32_bf16 a[92:95], a[132:135], v[116:119], a[92:95]
    v_cvt_pk_bf16_f32 v55, v46, v47
    buffer_store_dwordx2 v[48:49], v17, s[16:19], s31 offen offset:0 sc1
    v_mfma_f32_16x16x32_bf16 a[104:107], a[136:139], v[112:115], a[104:107]
    ds_read_b64_tr_b16 a[172:173], v8 offset:45056
    ds_read_b64_tr_b16 a[174:175], v8 offset:45568
    v_mfma_f32_16x16x32_bf16 a[120:123], a[136:139], v[116:119], a[120:123]
    buffer_load_dwordx4 v4, s[32:35], s12 offen offset:3072 lds
    v_mfma_f32_16x16x32_bf16 a[108:111], a[140:143], v[112:115], a[108:111]
    v_mfma_f32_16x16x32_bf16 a[124:127], a[140:143], v[116:119], a[124:127]
    s_waitcnt vmcnt(18)
    s_barrier
    s_waitcnt lgkmcnt(8)
    v_mfma_f32_16x16x32_bf16 a[64:67], a[144:147], v[120:123], a[64:67]
    ds_read_b64_tr_b16 a[128:129], v5 offset:49152
    v_mfma_f32_16x16x32_bf16 a[80:83], a[144:147], v[124:127], a[80:83]
    ds_read_b64_tr_b16 a[130:131], v5 offset:49664
    v_mfma_f32_16x16x32_bf16 a[68:71], a[148:151], v[120:123], a[68:71]
    ds_read_b64_tr_b16 a[132:133], v6 offset:49152
    ds_read_b64_tr_b16 a[134:135], v6 offset:49664
    s_add_u32 m0, s11, 16384
    s_sub_u32 s12, s12, s13
    s_cselect_b32 s12, s14, s12
    v_mfma_f32_16x16x32_bf16 a[84:87], a[148:151], v[124:127], a[84:87]
    buffer_store_dwordx2 v[50:51], v17, s[16:19], s31 offen offset:1024 sc1
    buffer_store_dwordx2 v[52:53], v17, s[16:19], s30 offen offset:0 sc1
    v_mfma_f32_16x16x32_bf16 a[96:99], a[152:155], v[120:123], a[96:99]
    ds_read_b64_tr_b16 a[136:137], v7 offset:49152
    ds_read_b64_tr_b16 a[138:139], v7 offset:49664
    v_mfma_f32_16x16x32_bf16 a[112:115], a[152:155], v[124:127], a[112:115]
    buffer_load_dwordx4 v1, s[32:35], s12 offen offset:0 lds
    v_mfma_f32_16x16x32_bf16 a[100:103], a[156:159], v[120:123], a[100:103]
    ds_read_b64_tr_b16 a[140:141], v8 offset:49152
    ds_read_b64_tr_b16 a[142:143], v8 offset:49664
    v_mfma_f32_16x16x32_bf16 a[116:119], a[156:159], v[124:127], a[116:119]
    buffer_store_dwordx2 v[54:55], v17, s[16:19], s30 offen offset:1024 sc1
    s_waitcnt lgkmcnt(8)
    v_mfma_f32_16x16x32_bf16 a[72:75], a[160:163], v[120:123], a[72:75]
    ds_read_b64_tr_b16 a[144:145], v5 offset:57344
    v_mfma_f32_16x16x32_bf16 a[88:91], a[160:163], v[124:127], a[88:91]
    ds_read_b64_tr_b16 a[146:147], v5 offset:57856
    v_mfma_f32_16x16x32_bf16 a[76:79], a[164:167], v[120:123], a[76:79]
    ds_read_b64_tr_b16 a[148:149], v6 offset:57344
    ds_read_b64_tr_b16 a[150:151], v6 offset:57856
    v_accvgpr_read_b32 v32, a16
    v_mfma_f32_16x16x32_bf16 a[92:95], a[164:167], v[124:127], a[92:95]
    v_accvgpr_read_b32 v33, a17
    v_accvgpr_read_b32 v34, a18
    v_accvgpr_read_b32 v35, a19
    v_mfma_f32_16x16x32_bf16 a[104:107], a[168:171], v[120:123], a[104:107]
    ds_read_b64_tr_b16 a[152:153], v7 offset:57344
    ds_read_b64_tr_b16 a[154:155], v7 offset:57856
    v_mfma_f32_16x16x32_bf16 a[120:123], a[168:171], v[124:127], a[120:123]
    buffer_load_dwordx4 v2, s[32:35], s12 offen offset:1024 lds
    v_accvgpr_read_b32 v36, a20
    v_mfma_f32_16x16x32_bf16 a[108:111], a[172:175], v[120:123], a[108:111]
    ds_read_b64_tr_b16 a[156:157], v8 offset:57344
    ds_read_b64_tr_b16 a[158:159], v8 offset:57856
    v_accvgpr_read_b32 v37, a21
    v_mfma_f32_16x16x32_bf16 a[124:127], a[172:175], v[124:127], a[124:127]
    v_accvgpr_read_b32 v38, a22
    v_accvgpr_read_b32 v39, a23
    s_waitcnt lgkmcnt(8)
    v_mfma_f32_16x16x32_bf16 a[64:67], a[128:131], v[128:131], a[64:67]
    ds_read_b64_tr_b16 a[160:161], v5 offset:53248
    v_mfma_f32_16x16x32_bf16 a[80:83], a[128:131], v[132:135], a[80:83]
    ds_read_b64_tr_b16 a[162:163], v5 offset:53760
    v_accvgpr_read_b32 v40, a24
    v_mfma_f32_16x16x32_bf16 a[68:71], a[132:135], v[128:131], a[68:71]
    ds_read_b64_tr_b16 a[164:165], v6 offset:53248
    ds_read_b64_tr_b16 a[166:167], v6 offset:53760
    v_accvgpr_read_b32 v41, a25
    v_mfma_f32_16x16x32_bf16 a[84:87], a[132:135], v[132:135], a[84:87]
    v_accvgpr_read_b32 v42, a26
    v_accvgpr_read_b32 v43, a27
    v_accvgpr_read_b32 v44, a28
    v_accvgpr_read_b32 v45, a29
    v_mfma_f32_16x16x32_bf16 a[96:99], a[136:139], v[128:131], a[96:99]
    ds_read_b64_tr_b16 a[168:169], v7 offset:53248
    ds_read_b64_tr_b16 a[170:171], v7 offset:53760
    v_mfma_f32_16x16x32_bf16 a[112:115], a[136:139], v[132:135], a[112:115]
    buffer_load_dwordx4 v3, s[32:35], s12 offen offset:2048 lds
    v_accvgpr_read_b32 v46, a30
    v_mfma_f32_16x16x32_bf16 a[100:103], a[140:143], v[128:131], a[100:103]
    ds_read_b64_tr_b16 a[172:173], v8 offset:53248
    ds_read_b64_tr_b16 a[174:175], v8 offset:53760
    v_accvgpr_read_b32 v47, a31
    v_mfma_f32_16x16x32_bf16 a[116:119], a[140:143], v[132:135], a[116:119]
    v_mul_f32 v32, v24, v32
    v_mul_f32 v33, v24, v33
    s_waitcnt lgkmcnt(8)
    v_mfma_f32_16x16x32_bf16 a[72:75], a[144:147], v[128:131], a[72:75]
    ds_read_b64_tr_b16 a[128:129], v5 offset:61440
    v_mfma_f32_16x16x32_bf16 a[88:91], a[144:147], v[132:135], a[88:91]
    ds_read_b64_tr_b16 a[130:131], v5 offset:61952
    v_mul_f32 v34, v24, v34
    v_mfma_f32_16x16x32_bf16 a[76:79], a[148:151], v[128:131], a[76:79]
    ds_read_b64_tr_b16 a[132:133], v6 offset:61440
    ds_read_b64_tr_b16 a[134:135], v6 offset:61952
    v_mul_f32 v35, v24, v35
    v_mfma_f32_16x16x32_bf16 a[92:95], a[148:151], v[132:135], a[92:95]
    v_mul_f32 v36, v24, v36
    v_mul_f32 v37, v24, v37
    v_mul_f32 v38, v24, v38
    v_mfma_f32_16x16x32_bf16 a[104:107], a[152:155], v[128:131], a[104:107]
    ds_read_b64_tr_b16 a[136:137], v7 offset:61440
    ds_read_b64_tr_b16 a[138:139], v7 offset:61952
    v_mfma_f32_16x16x32_bf16 a[120:123], a[152:155], v[132:135], a[120:123]
    buffer_load_dwordx4 v4, s[32:35], s12 offen offset:3072 lds
    v_mul_f32 v39, v24, v39
    v_mfma_f32_16x16x32_bf16 a[108:111], a[156:159], v[128:131], a[108:111]
    ds_read_b64_tr_b16 a[140:141], v8 offset:61440
    ds_read_b64_tr_b16 a[142:143], v8 offset:61952
    v_mul_f32 v40, v24, v40
    v_mfma_f32_16x16x32_bf16 a[124:127], a[156:159], v[132:135], a[124:127]
    v_mul_f32 v41, v24, v41
    v_mul_f32 v42, v24, v42
    s_waitcnt lgkmcnt(8)
    v_mfma_f32_16x16x32_bf16 a[64:67], a[160:163], v[136:139], a[64:67]
    ds_read_b64_tr_b16 a[144:145], v9 offset:0
    v_mfma_f32_16x16x32_bf16 a[80:83], a[160:163], v[140:143], a[80:83]
    ds_read_b64_tr_b16 a[146:147], v9 offset:512
    v_mul_f32 v43, v24, v43
    v_mfma_f32_16x16x32_bf16 a[68:71], a[164:167], v[136:139], a[68:71]
    ds_read_b64_tr_b16 a[148:149], v10 offset:0
    ds_read_b64_tr_b16 a[150:151], v10 offset:512
    s_add_u32 m0, s11, 131072
    s_sub_u32 s12, s12, s13
    s_cselect_b32 s12, s14, s12
    v_mfma_f32_16x16x32_bf16 a[84:87], a[164:167], v[140:143], a[84:87]
    v_mul_f32 v44, v24, v44
    v_mul_f32 v45, v24, v45
    v_mul_f32 v46, v24, v46
    v_mul_f32 v47, v24, v47
    v_cvt_pk_bf16_f32 v56, v32, v33
    v_mfma_f32_16x16x32_bf16 a[96:99], a[168:171], v[136:139], a[96:99]
    ds_read_b64_tr_b16 a[152:153], v11 offset:0
    ds_read_b64_tr_b16 a[154:155], v11 offset:512
    v_mfma_f32_16x16x32_bf16 a[112:115], a[168:171], v[140:143], a[112:115]
    buffer_load_dwordx4 v1, s[32:35], s12 offen offset:0 lds
    v_cvt_pk_bf16_f32 v57, v34, v35
    v_mfma_f32_16x16x32_bf16 a[100:103], a[172:175], v[136:139], a[100:103]
    ds_read_b64_tr_b16 a[156:157], v12 offset:0
    ds_read_b64_tr_b16 a[158:159], v12 offset:512
    v_cvt_pk_bf16_f32 v58, v36, v37
    v_mfma_f32_16x16x32_bf16 a[116:119], a[172:175], v[140:143], a[116:119]
    v_cvt_pk_bf16_f32 v59, v38, v39
    v_cvt_pk_bf16_f32 v60, v40, v41
    s_waitcnt lgkmcnt(8)
    v_mfma_f32_16x16x32_bf16 a[72:75], a[128:131], v[136:139], a[72:75]
    ds_read_b64_tr_b16 a[160:161], v9 offset:8192
    v_mfma_f32_16x16x32_bf16 a[88:91], a[128:131], v[140:143], a[88:91]
    ds_read_b64_tr_b16 a[162:163], v9 offset:8704
    v_cvt_pk_bf16_f32 v61, v42, v43
    v_mfma_f32_16x16x32_bf16 a[76:79], a[132:135], v[136:139], a[76:79]
    ds_read_b64_tr_b16 a[164:165], v10 offset:8192
    ds_read_b64_tr_b16 a[166:167], v10 offset:8704
    v_cvt_pk_bf16_f32 v62, v44, v45
    v_cvt_pk_bf16_f32 v63, v46, v47
    v_mfma_f32_16x16x32_bf16 a[92:95], a[132:135], v[140:143], a[92:95]
    buffer_store_dwordx2 v[56:57], v17, s[16:19], s31 offen offset:128 sc1
    v_mfma_f32_16x16x32_bf16 a[104:107], a[136:139], v[136:139], a[104:107]
    ds_read_b64_tr_b16 a[168:169], v11 offset:8192
    ds_read_b64_tr_b16 a[170:171], v11 offset:8704
    v_mfma_f32_16x16x32_bf16 a[120:123], a[136:139], v[140:143], a[120:123]
    buffer_load_dwordx4 v2, s[32:35], s12 offen offset:1024 lds
    v_mfma_f32_16x16x32_bf16 a[108:111], a[140:143], v[136:139], a[108:111]
    ds_read_b64_tr_b16 a[172:173], v12 offset:8192
    ds_read_b64_tr_b16 a[174:175], v12 offset:8704
    v_mfma_f32_16x16x32_bf16 a[124:127], a[140:143], v[140:143], a[124:127]
    buffer_store_dwordx2 v[58:59], v17, s[16:19], s31 offen offset:1152 sc1
    s_waitcnt lgkmcnt(8)
    v_mfma_f32_16x16x32_bf16 a[64:67], a[144:147], v[144:147], a[64:67]
    ds_read_b64_tr_b16 a[128:129], v9 offset:4096
    ds_read_b64_tr_b16 a[130:131], v9 offset:4608
    v_mfma_f32_16x16x32_bf16 a[80:83], a[144:147], v[148:151], a[80:83]
    buffer_store_dwordx2 v[60:61], v17, s[16:19], s30 offen offset:128 sc1
    v_mfma_f32_16x16x32_bf16 a[68:71], a[148:151], v[144:147], a[68:71]
    ds_read_b64_tr_b16 a[132:133], v10 offset:4096
    ds_read_b64_tr_b16 a[134:135], v10 offset:4608
    v_mfma_f32_16x16x32_bf16 a[84:87], a[148:151], v[148:151], a[84:87]
    buffer_store_dwordx2 v[62:63], v17, s[16:19], s30 offen offset:1152 sc1
    v_mfma_f32_16x16x32_bf16 a[96:99], a[152:155], v[144:147], a[96:99]
    ds_read_b64_tr_b16 a[136:137], v11 offset:4096
    ds_read_b64_tr_b16 a[138:139], v11 offset:4608
    v_mfma_f32_16x16x32_bf16 a[112:115], a[152:155], v[148:151], a[112:115]
    buffer_load_dwordx4 v3, s[32:35], s12 offen offset:2048 lds
    v_accvgpr_read_b32 v32, a32
    v_mfma_f32_16x16x32_bf16 a[100:103], a[156:159], v[144:147], a[100:103]
    ds_read_b64_tr_b16 a[140:141], v12 offset:4096
    ds_read_b64_tr_b16 a[142:143], v12 offset:4608
    v_accvgpr_read_b32 v33, a33
    v_mfma_f32_16x16x32_bf16 a[116:119], a[156:159], v[148:151], a[116:119]
    v_accvgpr_read_b32 v34, a34
    v_accvgpr_read_b32 v35, a35
    s_waitcnt lgkmcnt(8)
    v_mfma_f32_16x16x32_bf16 a[72:75], a[160:163], v[144:147], a[72:75]
    ds_read_b64_tr_b16 a[144:145], v9 offset:12288
    v_mfma_f32_16x16x32_bf16 a[88:91], a[160:163], v[148:151], a[88:91]
    ds_read_b64_tr_b16 a[146:147], v9 offset:12800
    ds_read_b64_tr_b16 a[148:149], v10 offset:12288
    v_mfma_f32_16x16x32_bf16 a[76:79], a[164:167], v[144:147], a[76:79]
    ds_read_b64_tr_b16 a[150:151], v10 offset:12800
    ds_read_b64_tr_b16 a[152:153], v11 offset:12288
    ds_read_b64_tr_b16 a[154:155], v11 offset:12800
    v_mfma_f32_16x16x32_bf16 a[92:95], a[164:167], v[148:151], a[92:95]
    v_accvgpr_read_b32 v36, a36
    v_accvgpr_read_b32 v37, a37
    v_accvgpr_read_b32 v38, a38
    v_mfma_f32_16x16x32_bf16 a[104:107], a[168:171], v[144:147], a[104:107]
    ds_read_b64_tr_b16 a[156:157], v12 offset:12288
    ds_read_b64_tr_b16 a[158:159], v12 offset:12800
    v_mfma_f32_16x16x32_bf16 a[120:123], a[168:171], v[148:151], a[120:123]
    buffer_load_dwordx4 v4, s[32:35], s12 offen offset:3072 lds
    v_accvgpr_read_b32 v39, a39
    v_mfma_f32_16x16x32_bf16 a[108:111], a[172:175], v[144:147], a[108:111]
    v_mfma_f32_16x16x32_bf16 a[124:127], a[172:175], v[148:151], a[124:127]
    s_waitcnt vmcnt(24)
    s_barrier
    s_waitcnt lgkmcnt(8)
    v_mfma_f32_16x16x32_bf16 a[64:67], a[128:131], v[152:155], a[64:67]
    ds_read_b64_tr_b16 a[160:161], v5 offset:0
    v_mfma_f32_16x16x32_bf16 a[80:83], a[128:131], v[156:159], a[80:83]
    ds_read_b64_tr_b16 a[162:163], v5 offset:512
    v_accvgpr_read_b32 v40, a40
    v_mfma_f32_16x16x32_bf16 a[68:71], a[132:135], v[152:155], a[68:71]
    ds_read_b64_tr_b16 a[164:165], v6 offset:0
    ds_read_b64_tr_b16 a[166:167], v6 offset:512
    s_add_u32 m0, s11, 32768
    v_mad_u32_u24 v1, v25, s44, v26
    s_lshl_b32 s13, s44, 6
    s_lshl_b32 s92, s44, 3
    s_sub_u32 s92, s92, 1024
    v_add_u32 v1, s45, v1
    s_mul_i32 s14, s13, 9
    v_mfma_f32_16x16x32_bf16 a[84:87], a[132:135], v[156:159], a[84:87]
    s_mov_b32 s12, s46
    v_xor_b32 v2, 64, v1
    v_add_u32 v2, s92, v2
    s_lshl_b32 s92, s92, 1
    v_add_u32 v3, s92, v1
    v_add_u32 v4, s92, v2
    v_accvgpr_read_b32 v41, a41
    v_accvgpr_read_b32 v42, a42
    v_accvgpr_read_b32 v43, a43
    v_accvgpr_read_b32 v44, a44
    v_mfma_f32_16x16x32_bf16 a[96:99], a[136:139], v[152:155], a[96:99]
    ds_read_b64_tr_b16 a[168:169], v7 offset:0
    ds_read_b64_tr_b16 a[170:171], v7 offset:512
    v_mfma_f32_16x16x32_bf16 a[112:115], a[136:139], v[156:159], a[112:115]
    buffer_load_dwordx4 v1, s[40:43], s12 offen offset:0 lds
    v_accvgpr_read_b32 v45, a45
    v_mfma_f32_16x16x32_bf16 a[100:103], a[140:143], v[152:155], a[100:103]
    ds_read_b64_tr_b16 a[172:173], v8 offset:0
    ds_read_b64_tr_b16 a[174:175], v8 offset:512
    v_accvgpr_read_b32 v46, a46
    v_mfma_f32_16x16x32_bf16 a[116:119], a[140:143], v[156:159], a[116:119]
    v_accvgpr_read_b32 v47, a47
    v_mul_f32 v32, v19, v32
    s_waitcnt lgkmcnt(8)
    v_mfma_f32_16x16x32_bf16 a[72:75], a[144:147], v[152:155], a[72:75]
    ds_read_b64_tr_b16 a[128:129], v5 offset:8192
    v_mfma_f32_16x16x32_bf16 a[88:91], a[144:147], v[156:159], a[88:91]
    ds_read_b64_tr_b16 a[130:131], v5 offset:8704
    v_mul_f32 v33, v19, v33
    v_mfma_f32_16x16x32_bf16 a[76:79], a[148:151], v[152:155], a[76:79]
    ds_read_b64_tr_b16 a[132:133], v6 offset:8192
    ds_read_b64_tr_b16 a[134:135], v6 offset:8704
    v_mul_f32 v34, v19, v34
    v_mfma_f32_16x16x32_bf16 a[92:95], a[148:151], v[156:159], a[92:95]
    v_mul_f32 v35, v19, v35
    v_mul_f32 v36, v19, v36
    v_mul_f32 v37, v19, v37
    v_mul_f32 v38, v19, v38
    v_mfma_f32_16x16x32_bf16 a[104:107], a[152:155], v[152:155], a[104:107]
    ds_read_b64_tr_b16 a[136:137], v7 offset:8192
    ds_read_b64_tr_b16 a[138:139], v7 offset:8704
    v_mfma_f32_16x16x32_bf16 a[120:123], a[152:155], v[156:159], a[120:123]
    buffer_load_dwordx4 v2, s[40:43], s12 offen offset:1024 lds
    v_mul_f32 v39, v19, v39
    v_mfma_f32_16x16x32_bf16 a[108:111], a[156:159], v[152:155], a[108:111]
    ds_read_b64_tr_b16 a[140:141], v8 offset:8192
    ds_read_b64_tr_b16 a[142:143], v8 offset:8704
    v_mul_f32 v40, v19, v40
    v_mfma_f32_16x16x32_bf16 a[124:127], a[156:159], v[156:159], a[124:127]
    v_mul_f32 v41, v19, v41
    v_mul_f32 v42, v19, v42
    s_waitcnt lgkmcnt(8)
    v_mfma_f32_16x16x32_bf16 a[64:67], a[160:163], v[160:163], a[64:67]
    ds_read_b64_tr_b16 a[144:145], v5 offset:4096
    v_mfma_f32_16x16x32_bf16 a[80:83], a[160:163], v[164:167], a[80:83]
    ds_read_b64_tr_b16 a[146:147], v5 offset:4608
    v_mul_f32 v43, v19, v43
    v_mfma_f32_16x16x32_bf16 a[68:71], a[164:167], v[160:163], a[68:71]
    ds_read_b64_tr_b16 a[148:149], v6 offset:4096
    ds_read_b64_tr_b16 a[150:151], v6 offset:4608
    v_mul_f32 v44, v19, v44
    v_mfma_f32_16x16x32_bf16 a[84:87], a[164:167], v[164:167], a[84:87]
    v_mul_f32 v45, v19, v45
    v_mul_f32 v46, v19, v46
    v_mul_f32 v47, v19, v47
    v_mfma_f32_16x16x32_bf16 a[96:99], a[168:171], v[160:163], a[96:99]
    ds_read_b64_tr_b16 a[152:153], v7 offset:4096
    ds_read_b64_tr_b16 a[154:155], v7 offset:4608
    v_mfma_f32_16x16x32_bf16 a[112:115], a[168:171], v[164:167], a[112:115]
    buffer_load_dwordx4 v3, s[40:43], s12 offen offset:2048 lds
    v_cvt_pk_bf16_f32 v64, v32, v33
    v_mfma_f32_16x16x32_bf16 a[100:103], a[172:175], v[160:163], a[100:103]
    ds_read_b64_tr_b16 a[156:157], v8 offset:4096
    ds_read_b64_tr_b16 a[158:159], v8 offset:4608
    v_cvt_pk_bf16_f32 v65, v34, v35
    v_mfma_f32_16x16x32_bf16 a[116:119], a[172:175], v[164:167], a[116:119]
    v_cvt_pk_bf16_f32 v66, v36, v37
    v_cvt_pk_bf16_f32 v67, v38, v39
    s_waitcnt lgkmcnt(8)
    v_mfma_f32_16x16x32_bf16 a[72:75], a[128:131], v[160:163], a[72:75]
    ds_read_b64_tr_b16 a[160:161], v5 offset:12288
    v_mfma_f32_16x16x32_bf16 a[88:91], a[128:131], v[164:167], a[88:91]
    ds_read_b64_tr_b16 a[162:163], v5 offset:12800
    v_cvt_pk_bf16_f32 v68, v40, v41
    v_mfma_f32_16x16x32_bf16 a[76:79], a[132:135], v[160:163], a[76:79]
    ds_read_b64_tr_b16 a[164:165], v6 offset:12288
    ds_read_b64_tr_b16 a[166:167], v6 offset:12800
    v_cvt_pk_bf16_f32 v69, v42, v43
    v_cvt_pk_bf16_f32 v70, v44, v45
    v_cvt_pk_bf16_f32 v71, v46, v47
    v_mfma_f32_16x16x32_bf16 a[92:95], a[132:135], v[164:167], a[92:95]
    buffer_store_dwordx2 v[64:65], v17, s[16:19], s31 offen offset:2048 sc1
    v_mfma_f32_16x16x32_bf16 a[104:107], a[136:139], v[160:163], a[104:107]
    ds_read_b64_tr_b16 a[168:169], v7 offset:12288
    ds_read_b64_tr_b16 a[170:171], v7 offset:12800
    v_mfma_f32_16x16x32_bf16 a[120:123], a[136:139], v[164:167], a[120:123]
    buffer_load_dwordx4 v4, s[40:43], s12 offen offset:3072 lds
    v_mfma_f32_16x16x32_bf16 a[108:111], a[140:143], v[160:163], a[108:111]
    ds_read_b64_tr_b16 a[172:173], v8 offset:12288
    ds_read_b64_tr_b16 a[174:175], v8 offset:12800
    v_mfma_f32_16x16x32_bf16 a[124:127], a[140:143], v[164:167], a[124:127]
    buffer_store_dwordx2 v[66:67], v17, s[16:19], s31 offen offset:3072 sc1
    s_waitcnt lgkmcnt(8)
    v_mfma_f32_16x16x32_bf16 a[64:67], a[144:147], v[168:171], a[64:67]
    ds_read_b64_tr_b16 a[128:129], v9 offset:16384
    ds_read_b64_tr_b16 a[130:131], v9 offset:16896
    v_mfma_f32_16x16x32_bf16 a[80:83], a[144:147], v[172:175], a[80:83]
    buffer_store_dwordx2 v[68:69], v17, s[16:19], s30 offen offset:2048 sc1
    v_mfma_f32_16x16x32_bf16 a[68:71], a[148:151], v[168:171], a[68:71]
    ds_read_b64_tr_b16 a[132:133], v10 offset:16384
    ds_read_b64_tr_b16 a[134:135], v10 offset:16896
    s_add_u32 m0, s11, 49152
    s_sub_u32 s12, s12, s13
    s_cselect_b32 s12, s14, s12
    v_mfma_f32_16x16x32_bf16 a[84:87], a[148:151], v[172:175], a[84:87]
    buffer_store_dwordx2 v[70:71], v17, s[16:19], s30 offen offset:3072 sc1
    v_mfma_f32_16x16x32_bf16 a[96:99], a[152:155], v[168:171], a[96:99]
    ds_read_b64_tr_b16 a[136:137], v11 offset:16384
    ds_read_b64_tr_b16 a[138:139], v11 offset:16896
    v_mfma_f32_16x16x32_bf16 a[112:115], a[152:155], v[172:175], a[112:115]
    buffer_load_dwordx4 v1, s[40:43], s12 offen offset:0 lds
    v_mfma_f32_16x16x32_bf16 a[100:103], a[156:159], v[168:171], a[100:103]
    ds_read_b64_tr_b16 a[140:141], v12 offset:16384
    ds_read_b64_tr_b16 a[142:143], v12 offset:16896
    v_accvgpr_read_b32 v32, a48
    v_mfma_f32_16x16x32_bf16 a[116:119], a[156:159], v[172:175], a[116:119]
    v_accvgpr_read_b32 v33, a49
    v_accvgpr_read_b32 v34, a50
    s_waitcnt lgkmcnt(8)
    v_mfma_f32_16x16x32_bf16 a[72:75], a[160:163], v[168:171], a[72:75]
    ds_read_b64_tr_b16 a[144:145], v9 offset:24576
    ds_read_b64_tr_b16 a[146:147], v9 offset:25088
    s_add_u32 s100, s65, 8192
    v_mfma_f32_16x16x32_bf16 a[88:91], a[160:163], v[172:175], a[88:91]
    buffer_load_dwordx2 v[88:89], v18, s[16:19], s100 offen offset:0
    v_mfma_f32_16x16x32_bf16 a[76:79], a[164:167], v[168:171], a[76:79]
    ds_read_b64_tr_b16 a[148:149], v10 offset:24576
    ds_read_b64_tr_b16 a[150:151], v10 offset:25088
    v_accvgpr_read_b32 v35, a51
    v_mfma_f32_16x16x32_bf16 a[92:95], a[164:167], v[172:175], a[92:95]
    v_accvgpr_read_b32 v36, a52
    v_accvgpr_read_b32 v37, a53
    v_accvgpr_read_b32 v38, a54
    v_accvgpr_read_b32 v39, a55
    v_mfma_f32_16x16x32_bf16 a[104:107], a[168:171], v[168:171], a[104:107]
    ds_read_b64_tr_b16 a[152:153], v11 offset:24576
    ds_read_b64_tr_b16 a[154:155], v11 offset:25088
    v_mfma_f32_16x16x32_bf16 a[120:123], a[168:171], v[172:175], a[120:123]
    buffer_load_dwordx4 v2, s[40:43], s12 offen offset:1024 lds
    v_accvgpr_read_b32 v40, a56
    v_mfma_f32_16x16x32_bf16 a[108:111], a[172:175], v[168:171], a[108:111]
    ds_read_b64_tr_b16 a[156:157], v12 offset:24576
    ds_read_b64_tr_b16 a[158:159], v12 offset:25088
    v_accvgpr_read_b32 v41, a57
    v_mfma_f32_16x16x32_bf16 a[124:127], a[172:175], v[172:175], a[124:127]
    v_accvgpr_read_b32 v42, a58
    v_accvgpr_read_b32 v43, a59
    s_waitcnt lgkmcnt(8)
    v_mfma_f32_16x16x32_bf16 a[64:67], a[128:131], v[176:179], a[64:67]
    ds_read_b64_tr_b16 a[160:161], v9 offset:20480
    ds_read_b64_tr_b16 a[162:163], v9 offset:20992
    s_add_u32 s100, s65, 8192
    v_mfma_f32_16x16x32_bf16 a[80:83], a[128:131], v[180:183], a[80:83]
    buffer_load_dwordx2 v[90:91], v18, s[16:19], s100 offen offset:512
    v_mfma_f32_16x16x32_bf16 a[68:71], a[132:135], v[176:179], a[68:71]
    ds_read_b64_tr_b16 a[164:165], v10 offset:20480
    ds_read_b64_tr_b16 a[166:167], v10 offset:20992
    v_accvgpr_read_b32 v44, a60
    v_mfma_f32_16x16x32_bf16 a[84:87], a[132:135], v[180:183], a[84:87]
    v_accvgpr_read_b32 v45, a61
    v_accvgpr_read_b32 v46, a62
    v_accvgpr_read_b32 v47, a63
    v_mul_f32 v32, v24, v32
    v_mfma_f32_16x16x32_bf16 a[96:99], a[136:139], v[176:179], a[96:99]
    ds_read_b64_tr_b16 a[168:169], v11 offset:20480
    ds_read_b64_tr_b16 a[170:171], v11 offset:20992
    v_mfma_f32_16x16x32_bf16 a[112:115], a[136:139], v[180:183], a[112:115]
    buffer_load_dwordx4 v3, s[40:43], s12 offen offset:2048 lds
    v_mul_f32 v33, v24, v33
    v_mfma_f32_16x16x32_bf16 a[100:103], a[140:143], v[176:179], a[100:103]
    ds_read_b64_tr_b16 a[172:173], v12 offset:20480
    ds_read_b64_tr_b16 a[174:175], v12 offset:20992
    v_mul_f32 v34, v24, v34
    v_mfma_f32_16x16x32_bf16 a[116:119], a[140:143], v[180:183], a[116:119]
    v_mul_f32 v35, v24, v35
    v_mul_f32 v36, v24, v36
    s_waitcnt lgkmcnt(8)
    v_mfma_f32_16x16x32_bf16 a[72:75], a[144:147], v[176:179], a[72:75]
    ds_read_b64_tr_b16 a[128:129], v9 offset:28672
    ds_read_b64_tr_b16 a[130:131], v9 offset:29184
    ds_read_b64_tr_b16 a[132:133], v10 offset:28672
    s_add_u32 s100, s65, 8192
    v_mfma_f32_16x16x32_bf16 a[88:91], a[144:147], v[180:183], a[88:91]
    buffer_load_dwordx2 v[92:93], v18, s[16:19], s100 offen offset:1024
    v_mfma_f32_16x16x32_bf16 a[76:79], a[148:151], v[176:179], a[76:79]
    ds_read_b64_tr_b16 a[134:135], v10 offset:29184
    ds_read_b64_tr_b16 a[136:137], v11 offset:28672
    ds_read_b64_tr_b16 a[138:139], v11 offset:29184
    v_mfma_f32_16x16x32_bf16 a[92:95], a[148:151], v[180:183], a[92:95]
    v_mul_f32 v37, v24, v37
    v_mul_f32 v38, v24, v38
    v_mul_f32 v39, v24, v39
    v_mfma_f32_16x16x32_bf16 a[104:107], a[152:155], v[176:179], a[104:107]
    ds_read_b64_tr_b16 a[140:141], v12 offset:28672
    ds_read_b64_tr_b16 a[142:143], v12 offset:29184
    v_mfma_f32_16x16x32_bf16 a[120:123], a[152:155], v[180:183], a[120:123]
    buffer_load_dwordx4 v4, s[40:43], s12 offen offset:3072 lds
    v_mul_f32 v40, v24, v40
    v_mfma_f32_16x16x32_bf16 a[108:111], a[156:159], v[176:179], a[108:111]
    v_mfma_f32_16x16x32_bf16 a[124:127], a[156:159], v[180:183], a[124:127]
    s_waitcnt vmcnt(30)
    s_barrier
    s_waitcnt lgkmcnt(8)
    v_mfma_f32_16x16x32_bf16 a[64:67], a[160:163], v[184:187], a[64:67]
    ds_read_b64_tr_b16 a[144:145], v9 offset:32768
    ds_read_b64_tr_b16 a[146:147], v9 offset:33280
    s_add_u32 s100, s65, 8192
    v_mfma_f32_16x16x32_bf16 a[80:83], a[160:163], v[188:191], a[80:83]
    buffer_load_dwordx2 v[94:95], v18, s[16:19], s100 offen offset:1536
    v_mfma_f32_16x16x32_bf16 a[68:71], a[164:167], v[184:187], a[68:71]
    ds_read_b64_tr_b16 a[148:149], v10 offset:32768
    ds_read_b64_tr_b16 a[150:151], v10 offset:33280
    s_add_u32 m0, s11, 0
    s_sub_u32 s12, s12, s13
    s_cselect_b32 s12, s14, s12
    v_mfma_f32_16x16x32_bf16 a[84:87], a[164:167], v[188:191], a[84:87]
    v_mul_f32 v41, v24, v41
    v_mul_f32 v42, v24, v42
    v_mul_f32 v43, v24, v43
    v_mul_f32 v44, v24, v44
    v_mul_f32 v45, v24, v45
    v_mfma_f32_16x16x32_bf16 a[96:99], a[168:171], v[184:187], a[96:99]
    ds_read_b64_tr_b16 a[152:153], v11 offset:32768
    ds_read_b64_tr_b16 a[154:155], v11 offset:33280
    v_mfma_f32_16x16x32_bf16 a[112:115], a[168:171], v[188:191], a[112:115]
    buffer_load_dwordx4 v1, s[40:43], s12 offen offset:0 lds
    v_mfma_f32_16x16x32_bf16 a[100:103], a[172:175], v[184:187], a[100:103]
    ds_read_b64_tr_b16 a[156:157], v12 offset:32768
    ds_read_b64_tr_b16 a[158:159], v12 offset:33280
    v_mul_f32 v46, v24, v46
    v_mfma_f32_16x16x32_bf16 a[116:119], a[172:175], v[188:191], a[116:119]
    v_mul_f32 v47, v24, v47
    v_cvt_pk_bf16_f32 v72, v32, v33
    s_waitcnt lgkmcnt(8)
    v_mfma_f32_16x16x32_bf16 a[72:75], a[128:131], v[184:187], a[72:75]
    ds_read_b64_tr_b16 a[160:161], v9 offset:40960
    v_mfma_f32_16x16x32_bf16 a[88:91], a[128:131], v[188:191], a[88:91]
    ds_read_b64_tr_b16 a[162:163], v9 offset:41472
    v_cvt_pk_bf16_f32 v73, v34, v35
    v_mfma_f32_16x16x32_bf16 a[76:79], a[132:135], v[184:187], a[76:79]
    ds_read_b64_tr_b16 a[164:165], v10 offset:40960
    ds_read_b64_tr_b16 a[166:167], v10 offset:41472
    v_cvt_pk_bf16_f32 v74, v36, v37
    v_mfma_f32_16x16x32_bf16 a[92:95], a[132:135], v[188:191], a[92:95]
    v_cvt_pk_bf16_f32 v75, v38, v39
    v_cvt_pk_bf16_f32 v76, v40, v41
    v_cvt_pk_bf16_f32 v77, v42, v43
    v_cvt_pk_bf16_f32 v78, v44, v45
    v_mfma_f32_16x16x32_bf16 a[104:107], a[136:139], v[184:187], a[104:107]
    ds_read_b64_tr_b16 a[168:169], v11 offset:40960
    ds_read_b64_tr_b16 a[170:171], v11 offset:41472
    v_mfma_f32_16x16x32_bf16 a[120:123], a[136:139], v[188:191], a[120:123]
    buffer_load_dwordx4 v2, s[40:43], s12 offen offset:1024 lds
    v_cvt_pk_bf16_f32 v79, v46, v47
    v_mfma_f32_16x16x32_bf16 a[108:111], a[140:143], v[184:187], a[108:111]
    ds_read_b64_tr_b16 a[172:173], v12 offset:40960
    ds_read_b64_tr_b16 a[174:175], v12 offset:41472
    v_mfma_f32_16x16x32_bf16 a[124:127], a[140:143], v[188:191], a[124:127]
    buffer_store_dwordx2 v[72:73], v17, s[16:19], s31 offen offset:2176 sc1
    s_waitcnt lgkmcnt(8)
    v_mfma_f32_16x16x32_bf16 a[64:67], a[144:147], v[192:195], a[64:67]
    ds_read_b64_tr_b16 a[128:129], v9 offset:36864
    ds_read_b64_tr_b16 a[130:131], v9 offset:37376
    v_mfma_f32_16x16x32_bf16 a[80:83], a[144:147], v[196:199], a[80:83]
    buffer_store_dwordx2 v[74:75], v17, s[16:19], s31 offen offset:3200 sc1
    v_mfma_f32_16x16x32_bf16 a[68:71], a[148:151], v[192:195], a[68:71]
    ds_read_b64_tr_b16 a[132:133], v10 offset:36864
    ds_read_b64_tr_b16 a[134:135], v10 offset:37376
    v_mfma_f32_16x16x32_bf16 a[84:87], a[148:151], v[196:199], a[84:87]
    buffer_store_dwordx2 v[76:77], v17, s[16:19], s30 offen offset:2176 sc1
    v_mfma_f32_16x16x32_bf16 a[96:99], a[152:155], v[192:195], a[96:99]
    ds_read_b64_tr_b16 a[136:137], v11 offset:36864
    ds_read_b64_tr_b16 a[138:139], v11 offset:37376
    v_mfma_f32_16x16x32_bf16 a[112:115], a[152:155], v[196:199], a[112:115]
    buffer_load_dwordx4 v3, s[40:43], s12 offen offset:2048 lds
    v_mfma_f32_16x16x32_bf16 a[100:103], a[156:159], v[192:195], a[100:103]
    ds_read_b64_tr_b16 a[140:141], v12 offset:36864
    ds_read_b64_tr_b16 a[142:143], v12 offset:37376
    v_mfma_f32_16x16x32_bf16 a[116:119], a[156:159], v[196:199], a[116:119]
    buffer_store_dwordx2 v[78:79], v17, s[16:19], s30 offen offset:3200 sc1
    s_waitcnt lgkmcnt(8)
    v_mfma_f32_16x16x32_bf16 a[72:75], a[160:163], v[192:195], a[72:75]
    ds_read_b64_tr_b16 a[144:145], v9 offset:45056
    v_mfma_f32_16x16x32_bf16 a[88:91], a[160:163], v[196:199], a[88:91]
    ds_read_b64_tr_b16 a[146:147], v9 offset:45568
    v_mfma_f32_16x16x32_bf16 a[76:79], a[164:167], v[192:195], a[76:79]
    ds_read_b64_tr_b16 a[148:149], v10 offset:45056
    v_mfma_f32_16x16x32_bf16 a[92:95], a[164:167], v[196:199], a[92:95]
    ds_read_b64_tr_b16 a[150:151], v10 offset:45568
    v_mfma_f32_16x16x32_bf16 a[104:107], a[168:171], v[192:195], a[104:107]
    ds_read_b64_tr_b16 a[152:153], v11 offset:45056
    ds_read_b64_tr_b16 a[154:155], v11 offset:45568
    v_mfma_f32_16x16x32_bf16 a[120:123], a[168:171], v[196:199], a[120:123]
    buffer_load_dwordx4 v4, s[40:43], s12 offen offset:3072 lds
    v_mfma_f32_16x16x32_bf16 a[108:111], a[172:175], v[192:195], a[108:111]
    ds_read_b64_tr_b16 a[156:157], v12 offset:45056
    v_mfma_f32_16x16x32_bf16 a[124:127], a[172:175], v[196:199], a[124:127]
    ds_read_b64_tr_b16 a[158:159], v12 offset:45568
    s_waitcnt lgkmcnt(8)
    v_mfma_f32_16x16x32_bf16 a[64:67], a[128:131], v[200:203], a[64:67]
    ds_read_b64_tr_b16 a[160:161], v9 offset:49152
    v_mfma_f32_16x16x32_bf16 a[80:83], a[128:131], v[204:207], a[80:83]
    ds_read_b64_tr_b16 a[162:163], v9 offset:49664
    v_mfma_f32_16x16x32_bf16 a[68:71], a[132:135], v[200:203], a[68:71]
    ds_read_b64_tr_b16 a[164:165], v10 offset:49152
    ds_read_b64_tr_b16 a[166:167], v10 offset:49664
    v_mfma_f32_16x16x32_bf16 a[84:87], a[132:135], v[204:207], a[84:87]
    s_add_u32 m0, s11, 147456
    s_sub_u32 s12, s12, s13
    s_cselect_b32 s12, s14, s12
    v_mfma_f32_16x16x32_bf16 a[96:99], a[136:139], v[200:203], a[96:99]
    ds_read_b64_tr_b16 a[168:169], v11 offset:49152
    ds_read_b64_tr_b16 a[170:171], v11 offset:49664
    v_mfma_f32_16x16x32_bf16 a[112:115], a[136:139], v[204:207], a[112:115]
    buffer_load_dwordx4 v1, s[40:43], s12 offen offset:0 lds
    v_mfma_f32_16x16x32_bf16 a[100:103], a[140:143], v[200:203], a[100:103]
    ds_read_b64_tr_b16 a[172:173], v12 offset:49152
    v_mfma_f32_16x16x32_bf16 a[116:119], a[140:143], v[204:207], a[116:119]
    ds_read_b64_tr_b16 a[174:175], v12 offset:49664
    s_waitcnt lgkmcnt(8)
    v_mfma_f32_16x16x32_bf16 a[72:75], a[144:147], v[200:203], a[72:75]
    ds_read_b64_tr_b16 a[128:129], v9 offset:57344
    v_mfma_f32_16x16x32_bf16 a[88:91], a[144:147], v[204:207], a[88:91]
    ds_read_b64_tr_b16 a[130:131], v9 offset:57856
    v_mfma_f32_16x16x32_bf16 a[76:79], a[148:151], v[200:203], a[76:79]
    ds_read_b64_tr_b16 a[132:133], v10 offset:57344
    ds_read_b64_tr_b16 a[134:135], v10 offset:57856
    s_waitcnt vmcnt(15)
    v_cmp_ne_u64 vcc, s[60:61], v[88:89]
    v_mfma_f32_16x16x32_bf16 a[92:95], a[148:151], v[204:207], a[92:95]
    s_nop 0
    s_cmp_lg_u64 vcc, 0
    s_cbranch_scc1 fc_1_slow
fc_1_ok:
    v_mfma_f32_16x16x32_bf16 a[104:107], a[152:155], v[200:203], a[104:107]
    ds_read_b64_tr_b16 a[136:137], v11 offset:57344
    ds_read_b64_tr_b16 a[138:139], v11 offset:57856
    v_mfma_f32_16x16x32_bf16 a[120:123], a[152:155], v[204:207], a[120:123]
    buffer_load_dwordx4 v2, s[40:43], s12 offen offset:1024 lds
    v_mfma_f32_16x16x32_bf16 a[108:111], a[156:159], v[200:203], a[108:111]
    ds_read_b64_tr_b16 a[140:141], v12 offset:57344
    ds_read_b64_tr_b16 a[142:143], v12 offset:57856
    s_waitcnt vmcnt(14)
    v_cmp_ne_u64 vcc, s[60:61], v[90:91]
    v_mfma_f32_16x16x32_bf16 a[124:127], a[156:159], v[204:207], a[124:127]
    s_nop 0
    s_cmp_lg_u64 vcc, 0
    s_cbranch_scc1 fc_2_slow
fc_2_ok:
    s_waitcnt lgkmcnt(8)
    v_mfma_f32_16x16x32_bf16 a[64:67], a[160:163], v[208:211], a[64:67]
    ds_read_b64_tr_b16 a[144:145], v9 offset:53248
    v_mfma_f32_16x16x32_bf16 a[80:83], a[160:163], v[212:215], a[80:83]
    ds_read_b64_tr_b16 a[146:147], v9 offset:53760
    v_mfma_f32_16x16x32_bf16 a[68:71], a[164:167], v[208:211], a[68:71]
    ds_read_b64_tr_b16 a[148:149], v10 offset:53248
    ds_read_b64_tr_b16 a[150:151], v10 offset:53760
    s_waitcnt vmcnt(12)
    v_cmp_ne_u64 vcc, s[60:61], v[92:93]
    v_mfma_f32_16x16x32_bf16 a[84:87], a[164:167], v[212:215], a[84:87]
    s_nop 0
    s_cmp_lg_u64 vcc, 0
    s_cbranch_scc1 fc_3_slow
fc_3_ok:
    v_mfma_f32_16x16x32_bf16 a[96:99], a[168:171], v[208:211], a[96:99]
    ds_read_b64_tr_b16 a[152:153], v11 offset:53248
    ds_read_b64_tr_b16 a[154:155], v11 offset:53760
    v_mfma_f32_16x16x32_bf16 a[112:115], a[168:171], v[212:215], a[112:115]
    buffer_load_dwordx4 v3, s[40:43], s12 offen offset:2048 lds
    v_mfma_f32_16x16x32_bf16 a[100:103], a[172:175], v[208:211], a[100:103]
    ds_read_b64_tr_b16 a[156:157], v12 offset:53248
    v_mfma_f32_16x16x32_bf16 a[116:119], a[172:175], v[212:215], a[116:119]
    ds_read_b64_tr_b16 a[158:159], v12 offset:53760
    s_waitcnt lgkmcnt(8)
    v_mfma_f32_16x16x32_bf16 a[72:75], a[128:131], v[208:211], a[72:75]
    ds_read_b64_tr_b16 a[160:161], v9 offset:61440
    v_mfma_f32_16x16x32_bf16 a[88:91], a[128:131], v[212:215], a[88:91]
    ds_read_b64_tr_b16 a[162:163], v9 offset:61952
    ds_read_b64_tr_b16 a[164:165], v10 offset:61440
    v_mfma_f32_16x16x32_bf16 a[76:79], a[132:135], v[208:211], a[76:79]
    ds_read_b64_tr_b16 a[166:167], v10 offset:61952
    ds_read_b64_tr_b16 a[168:169], v11 offset:61440
    ds_read_b64_tr_b16 a[170:171], v11 offset:61952
    s_waitcnt vmcnt(11)
    v_mfma_f32_16x16x32_bf16 a[92:95], a[132:135], v[212:215], a[92:95]
    v_cmp_ne_u64 vcc, s[60:61], v[94:95]
    s_nop 0
    s_cmp_lg_u64 vcc, 0
    s_cbranch_scc1 fc_4_slow
fc_4_ok:
    v_mfma_f32_16x16x32_bf16 a[104:107], a[136:139], v[208:211], a[104:107]
    ds_read_b64_tr_b16 a[172:173], v12 offset:61440
    ds_read_b64_tr_b16 a[174:175], v12 offset:61952
    v_mfma_f32_16x16x32_bf16 a[120:123], a[136:139], v[212:215], a[120:123]
    buffer_load_dwordx4 v4, s[40:43], s12 offen offset:3072 lds
    v_mfma_f32_16x16x32_bf16 a[108:111], a[140:143], v[208:211], a[108:111]
    v_mfma_f32_16x16x32_bf16 a[124:127], a[140:143], v[212:215], a[124:127]
    s_waitcnt vmcnt(28)
    s_barrier
    s_waitcnt lgkmcnt(8)
    v_mfma_f32_16x16x32_bf16 a[64:67], a[144:147], v[216:219], a[64:67]
    ds_read_b64_tr_b16 a[128:129], v5 offset:16384
    ds_read_b64_tr_b16 a[130:131], v5 offset:16896
    s_add_u32 s21, s68, 0
    v_mfma_f32_16x16x32_bf16 a[80:83], a[144:147], v[220:223], a[80:83]
    buffer_load_dwordx4 a[176:179], v31, s[16:19], s21 offen offset:0 sc1
    v_mfma_f32_16x16x32_bf16 a[68:71], a[148:151], v[216:219], a[68:71]
    ds_read_b64_tr_b16 a[132:133], v6 offset:16384
    ds_read_b64_tr_b16 a[134:135], v6 offset:16896
    s_add_u32 m0, s11, 98304
    s_sub_u32 s12, s12, s13
    s_cselect_b32 s12, s14, s12
    s_or_b32 s100, s2, s8
    v_mfma_f32_16x16x32_bf16 a[84:87], a[148:151], v[220:223], a[84:87]
    s_cbranch_scc1 ep_5
    v_mov_b32 v88, s60
    s_mov_b32 s100, 25165568
    s_mov_b64 exec, 1
    buffer_store_dword v88, off, s[16:19], s100
    s_mov_b64 exec, -1
    ep_5:
    v_mfma_f32_16x16x32_bf16 a[96:99], a[152:155], v[216:219], a[96:99]
    ds_read_b64_tr_b16 a[136:137], v7 offset:16384
    ds_read_b64_tr_b16 a[138:139], v7 offset:16896
    v_mfma_f32_16x16x32_bf16 a[112:115], a[152:155], v[220:223], a[112:115]
    buffer_load_dwordx4 v1, s[40:43], s12 offen offset:0 lds
    v_mfma_f32_16x16x32_bf16 a[100:103], a[156:159], v[216:219], a[100:103]
    ds_read_b64_tr_b16 a[140:141], v8 offset:16384
    v_mfma_f32_16x16x32_bf16 a[116:119], a[156:159], v[220:223], a[116:119]
    ds_read_b64_tr_b16 a[142:143], v8 offset:16896
    s_waitcnt lgkmcnt(8)
    v_mfma_f32_16x16x32_bf16 a[72:75], a[160:163], v[216:219], a[72:75]
    ds_read_b64_tr_b16 a[144:145], v5 offset:24576
    ds_read_b64_tr_b16 a[146:147], v5 offset:25088
    buffer_load_dwordx4 a[180:183], v31, s[16:19], s21 offen offset:1024 sc1
    s_waitcnt vmcnt(8)
    v_mfma_f32_16x16x32_bf16 a[88:91], a[160:163], v[220:223], a[88:91]
    v_mov_b64 v[86:87], s[60:61]
    s_add_u32 s100, s62, 16384
    s_mov_b64 exec, 1
    buffer_store_dwordx2 v[86:87], off, s[16:19], s100 sc1
    s_mov_b64 exec, -1
    v_mfma_f32_16x16x32_bf16 a[76:79], a[164:167], v[216:219], a[76:79]
    ds_read_b64_tr_b16 a[148:149], v6 offset:24576
    v_mfma_f32_16x16x32_bf16 a[92:95], a[164:167], v[220:223], a[92:95]
    ds_read_b64_tr_b16 a[150:151], v6 offset:25088
    v_mfma_f32_16x16x32_bf16 a[104:107], a[168:171], v[216:219], a[104:107]
    ds_read_b64_tr_b16 a[152:153], v7 offset:24576
    ds_read_b64_tr_b16 a[154:155], v7 offset:25088
    v_mfma_f32_16x16x32_bf16 a[120:123], a[168:171], v[220:223], a[120:123]
    buffer_load_dwordx4 v2, s[40:43], s12 offen offset:1024 lds
    v_mfma_f32_16x16x32_bf16 a[108:111], a[172:175], v[216:219], a[108:111]
    ds_read_b64_tr_b16 a[156:157], v8 offset:24576
    v_mfma_f32_16x16x32_bf16 a[124:127], a[172:175], v[220:223], a[124:127]
    ds_read_b64_tr_b16 a[158:159], v8 offset:25088
    s_waitcnt lgkmcnt(8)
    v_mfma_f32_16x16x32_bf16 a[64:67], a[128:131], v[224:227], a[64:67]
    ds_read_b64_tr_b16 a[160:161], v5 offset:20480
    ds_read_b64_tr_b16 a[162:163], v5 offset:20992
    v_mfma_f32_16x16x32_bf16 a[80:83], a[128:131], v[228:231], a[80:83]
    buffer_load_dwordx4 a[184:187], v31, s[16:19], s21 offen offset:2048 sc1
    v_mfma_f32_16x16x32_bf16 a[68:71], a[132:135], v[224:227], a[68:71]
    ds_read_b64_tr_b16 a[164:165], v6 offset:20480
    v_mfma_f32_16x16x32_bf16 a[84:87], a[132:135], v[228:231], a[84:87]
    ds_read_b64_tr_b16 a[166:167], v6 offset:20992
    v_mfma_f32_16x16x32_bf16 a[96:99], a[136:139], v[224:227], a[96:99]
    ds_read_b64_tr_b16 a[168:169], v7 offset:20480
    ds_read_b64_tr_b16 a[170:171], v7 offset:20992
    v_mfma_f32_16x16x32_bf16 a[112:115], a[136:139], v[228:231], a[112:115]
    buffer_load_dwordx4 v3, s[40:43], s12 offen offset:2048 lds
    v_mfma_f32_16x16x32_bf16 a[100:103], a[140:143], v[224:227], a[100:103]
    ds_read_b64_tr_b16 a[172:173], v8 offset:20480
    v_mfma_f32_16x16x32_bf16 a[116:119], a[140:143], v[228:231], a[116:119]
    ds_read_b64_tr_b16 a[174:175], v8 offset:20992
    s_waitcnt lgkmcnt(8)
    v_mfma_f32_16x16x32_bf16 a[72:75], a[144:147], v[224:227], a[72:75]
    ds_read_b64_tr_b16 a[128:129], v5 offset:28672
    ds_read_b64_tr_b16 a[130:131], v5 offset:29184
    v_mfma_f32_16x16x32_bf16 a[88:91], a[144:147], v[228:231], a[88:91]
    buffer_load_dwordx4 a[188:191], v31, s[16:19], s21 offen offset:3072 sc1
    v_mfma_f32_16x16x32_bf16 a[76:79], a[148:151], v[224:227], a[76:79]
    ds_read_b64_tr_b16 a[132:133], v6 offset:28672
    v_mfma_f32_16x16x32_bf16 a[92:95], a[148:151], v[228:231], a[92:95]
    ds_read_b64_tr_b16 a[134:135], v6 offset:29184
    v_mfma_f32_16x16x32_bf16 a[104:107], a[152:155], v[224:227], a[104:107]
    ds_read_b64_tr_b16 a[136:137], v7 offset:28672
    ds_read_b64_tr_b16 a[138:139], v7 offset:29184
    v_mfma_f32_16x16x32_bf16 a[120:123], a[152:155], v[228:231], a[120:123]
    buffer_load_dwordx4 v4, s[40:43], s12 offen offset:3072 lds
    v_mfma_f32_16x16x32_bf16 a[108:111], a[156:159], v[224:227], a[108:111]
    ds_read_b64_tr_b16 a[140:141], v8 offset:28672
    v_mfma_f32_16x16x32_bf16 a[124:127], a[156:159], v[228:231], a[124:127]
    ds_read_b64_tr_b16 a[142:143], v8 offset:29184
    s_waitcnt lgkmcnt(8)
    v_mfma_f32_16x16x32_bf16 a[64:67], a[160:163], v[232:235], a[64:67]
    ds_read_b64_tr_b16 a[144:145], v13 offset:0
    ds_read_b64_tr_b16 a[146:147], v13 offset:512
    s_add_u32 s21, s21, 4096
    v_mfma_f32_16x16x32_bf16 a[80:83], a[160:163], v[236:239], a[80:83]
    buffer_load_dwordx4 a[192:195], v31, s[16:19], s21 offen offset:0 sc1
    v_mfma_f32_16x16x32_bf16 a[68:71], a[164:167], v[232:235], a[68:71]
    ds_read_b64_tr_b16 a[148:149], v14 offset:0
    ds_read_b64_tr_b16 a[150:151], v14 offset:512
    v_mfma_f32_16x16x32_bf16 a[84:87], a[164:167], v[236:239], a[84:87]
    s_add_u32 m0, s11, 81920
    s_sub_u32 s12, s12, s13
    s_cselect_b32 s12, s14, s12
    v_mfma_f32_16x16x32_bf16 a[96:99], a[168:171], v[232:235], a[96:99]
    ds_read_b64_tr_b16 a[152:153], v15 offset:0
    ds_read_b64_tr_b16 a[154:155], v15 offset:512
    v_mfma_f32_16x16x32_bf16 a[112:115], a[168:171], v[236:239], a[112:115]
    buffer_load_dwordx4 v1, s[40:43], s12 offen offset:0 lds
    v_mfma_f32_16x16x32_bf16 a[100:103], a[172:175], v[232:235], a[100:103]
    ds_read_b64_tr_b16 a[156:157], v16 offset:0
    v_mfma_f32_16x16x32_bf16 a[116:119], a[172:175], v[236:239], a[116:119]
    ds_read_b64_tr_b16 a[158:159], v16 offset:512
    s_waitcnt lgkmcnt(8)
    v_mfma_f32_16x16x32_bf16 a[72:75], a[128:131], v[232:235], a[72:75]
    ds_read_b64_tr_b16 a[160:161], v13 offset:8192
    ds_read_b64_tr_b16 a[162:163], v13 offset:8704
    s_add_u32 s21, s68, 5120
    v_mfma_f32_16x16x32_bf16 a[88:91], a[128:131], v[236:239], a[88:91]
    buffer_load_dwordx4 a[196:199], v31, s[16:19], s21 offen offset:0 sc1
    v_mfma_f32_16x16x32_bf16 a[76:79], a[132:135], v[232:235], a[76:79]
    ds_read_b64_tr_b16 a[164:165], v14 offset:8192
    v_mfma_f32_16x16x32_bf16 a[92:95], a[132:135], v[236:239], a[92:95]
    ds_read_b64_tr_b16 a[166:167], v14 offset:8704
    v_mfma_f32_16x16x32_bf16 a[104:107], a[136:139], v[232:235], a[104:107]
    ds_read_b64_tr_b16 a[168:169], v15 offset:8192
    ds_read_b64_tr_b16 a[170:171], v15 offset:8704
    v_mfma_f32_16x16x32_bf16 a[120:123], a[136:139], v[236:239], a[120:123]
    buffer_load_dwordx4 v2, s[40:43], s12 offen offset:1024 lds
    v_mfma_f32_16x16x32_bf16 a[108:111], a[140:143], v[232:235], a[108:111]
    ds_read_b64_tr_b16 a[172:173], v16 offset:8192
    v_mfma_f32_16x16x32_bf16 a[124:127], a[140:143], v[236:239], a[124:127]
    ds_read_b64_tr_b16 a[174:175], v16 offset:8704
    s_waitcnt lgkmcnt(8)
    v_mfma_f32_16x16x32_bf16 a[64:67], a[144:147], v[240:243], a[64:67]
    ds_read_b64_tr_b16 a[128:129], v13 offset:4096
    ds_read_b64_tr_b16 a[130:131], v13 offset:4608
    v_mfma_f32_16x16x32_bf16 a[80:83], a[144:147], v[244:247], a[80:83]
    buffer_load_dwordx4 a[200:203], v31, s[16:19], s21 offen offset:1024 sc1
    v_mfma_f32_16x16x32_bf16 a[68:71], a[148:151], v[240:243], a[68:71]
    ds_read_b64_tr_b16 a[132:133], v14 offset:4096
    v_mfma_f32_16x16x32_bf16 a[84:87], a[148:151], v[244:247], a[84:87]
    ds_read_b64_tr_b16 a[134:135], v14 offset:4608
    v_mfma_f32_16x16x32_bf16 a[96:99], a[152:155], v[240:243], a[96:99]
    ds_read_b64_tr_b16 a[136:137], v15 offset:4096
    ds_read_b64_tr_b16 a[138:139], v15 offset:4608
    v_mfma_f32_16x16x32_bf16 a[112:115], a[152:155], v[244:247], a[112:115]
    buffer_load_dwordx4 v3, s[40:43], s12 offen offset:2048 lds
    v_mfma_f32_16x16x32_bf16 a[100:103], a[156:159], v[240:243], a[100:103]
    ds_read_b64_tr_b16 a[140:141], v16 offset:4096
    v_mfma_f32_16x16x32_bf16 a[116:119], a[156:159], v[244:247], a[116:119]
    ds_read_b64_tr_b16 a[142:143], v16 offset:4608
    s_waitcnt lgkmcnt(8)
    v_mfma_f32_16x16x32_bf16 a[72:75], a[160:163], v[240:243], a[72:75]
    ds_read_b64_tr_b16 a[144:145], v13 offset:12288
    ds_read_b64_tr_b16 a[146:147], v13 offset:12800
    ds_read_b64_tr_b16 a[148:149], v14 offset:12288
    v_mfma_f32_16x16x32_bf16 a[88:91], a[160:163], v[244:247], a[88:91]
    buffer_load_dwordx4 a[204:207], v31, s[16:19], s21 offen offset:2048 sc1
    v_mfma_f32_16x16x32_bf16 a[76:79], a[164:167], v[240:243], a[76:79]
    ds_read_b64_tr_b16 a[150:151], v14 offset:12800
    v_mfma_f32_16x16x32_bf16 a[92:95], a[164:167], v[244:247], a[92:95]
    ds_read_b64_tr_b16 a[152:153], v15 offset:12288
    ds_read_b64_tr_b16 a[154:155], v15 offset:12800
    v_mfma_f32_16x16x32_bf16 a[104:107], a[168:171], v[240:243], a[104:107]
    ds_read_b64_tr_b16 a[156:157], v16 offset:12288
    ds_read_b64_tr_b16 a[158:159], v16 offset:12800
    v_mfma_f32_16x16x32_bf16 a[120:123], a[168:171], v[244:247], a[120:123]
    buffer_load_dwordx4 v4, s[40:43], s12 offen offset:3072 lds
    v_mfma_f32_16x16x32_bf16 a[108:111], a[172:175], v[240:243], a[108:111]
    v_mfma_f32_16x16x32_bf16 a[124:127], a[172:175], v[244:247], a[124:127]
    s_waitcnt vmcnt(30)
    s_barrier
    s_waitcnt lgkmcnt(8)
    v_mfma_f32_16x16x32_bf16 a[64:67], a[128:131], v[248:251], a[64:67]
    ds_read_b64_tr_b16 a[160:161], v5 offset:32768
    ds_read_b64_tr_b16 a[162:163], v5 offset:33280
    v_mfma_f32_16x16x32_bf16 a[80:83], a[128:131], v[252:255], a[80:83]
    buffer_load_dwordx4 a[208:211], v31, s[16:19], s21 offen offset:3072 sc1
    v_mfma_f32_16x16x32_bf16 a[68:71], a[132:135], v[248:251], a[68:71]
    ds_read_b64_tr_b16 a[164:165], v6 offset:32768
    ds_read_b64_tr_b16 a[166:167], v6 offset:33280
    v_mfma_f32_16x16x32_bf16 a[84:87], a[132:135], v[252:255], a[84:87]
    s_add_u32 m0, s11, 65536
    s_sub_u32 s12, s12, s13
    s_cselect_b32 s12, s14, s12
    v_mfma_f32_16x16x32_bf16 a[96:99], a[136:139], v[248:251], a[96:99]
    ds_read_b64_tr_b16 a[168:169], v7 offset:32768
    ds_read_b64_tr_b16 a[170:171], v7 offset:33280
    v_mfma_f32_16x16x32_bf16 a[112:115], a[136:139], v[252:255], a[112:115]
    buffer_load_dwordx4 v1, s[40:43], s12 offen offset:0 lds
    v_mfma_f32_16x16x32_bf16 a[100:103], a[140:143], v[248:251], a[100:103]
    ds_read_b64_tr_b16 a[172:173], v8 offset:32768
    v_mfma_f32_16x16x32_bf16 a[116:119], a[140:143], v[252:255], a[116:119]
    ds_read_b64_tr_b16 a[174:175], v8 offset:33280
    s_waitcnt lgkmcnt(8)
    v_mfma_f32_16x16x32_bf16 a[72:75], a[144:147], v[248:251], a[72:75]
    ds_read_b64_tr_b16 a[128:129], v5 offset:40960
    ds_read_b64_tr_b16 a[130:131], v5 offset:41472
    s_add_u32 s21, s21, 4096
    v_mfma_f32_16x16x32_bf16 a[88:91], a[144:147], v[252:255], a[88:91]
    buffer_load_dwordx4 a[212:215], v31, s[16:19], s21 offen offset:0 sc1
    v_mfma_f32_16x16x32_bf16 a[76:79], a[148:151], v[248:251], a[76:79]
    ds_read_b64_tr_b16 a[132:133], v6 offset:40960
    v_mfma_f32_16x16x32_bf16 a[92:95], a[148:151], v[252:255], a[92:95]
    ds_read_b64_tr_b16 a[134:135], v6 offset:41472
    v_mfma_f32_16x16x32_bf16 a[104:107], a[152:155], v[248:251], a[104:107]
    ds_read_b64_tr_b16 a[136:137], v7 offset:40960
    ds_read_b64_tr_b16 a[138:139], v7 offset:41472
    v_mfma_f32_16x16x32_bf16 a[120:123], a[152:155], v[252:255], a[120:123]
    buffer_load_dwordx4 v2, s[40:43], s12 offen offset:1024 lds
    v_mfma_f32_16x16x32_bf16 a[108:111], a[156:159], v[248:251], a[108:111]
    ds_read_b64_tr_b16 a[140:141], v8 offset:40960
    v_mfma_f32_16x16x32_bf16 a[124:127], a[156:159], v[252:255], a[124:127]
    ds_read_b64_tr_b16 a[142:143], v8 offset:41472
    buffer_load_dwordx4 v3, s[40:43], s12 offen offset:2048 lds
    buffer_load_dwordx4 v4, s[40:43], s12 offen offset:3072 lds
    s_cmp_eq_u32 s15, 0
    s_cbranch_scc1 recurrent_scan__sliding_local_dilated__swiglu_ffn__prompt_kernel_two
    s_waitcnt lgkmcnt(8)
    v_mfma_f32_16x16x32_bf16 a[0:3], a[160:163], v[96:99], 0
    ds_read_b64_tr_b16 a[144:145], v5 offset:36864
    ds_read_b64_tr_b16 a[146:147], v5 offset:37376
    s_add_u32 s21, s68, 10240
    v_mfma_f32_16x16x32_bf16 a[16:19], a[160:163], v[100:103], 0
    buffer_load_dwordx4 a[216:219], v31, s[16:19], s21 offen offset:0 sc1
    v_mfma_f32_16x16x32_bf16 a[4:7], a[164:167], v[96:99], 0
    ds_read_b64_tr_b16 a[148:149], v6 offset:36864
    v_mfma_f32_16x16x32_bf16 a[20:23], a[164:167], v[100:103], 0
    ds_read_b64_tr_b16 a[150:151], v6 offset:37376
    v_mfma_f32_16x16x32_bf16 a[32:35], a[168:171], v[96:99], 0
    ds_read_b64_tr_b16 a[152:153], v7 offset:36864
    ds_read_b64_tr_b16 a[154:155], v7 offset:37376
    v_mfma_f32_16x16x32_bf16 a[48:51], a[168:171], v[100:103], 0
    buffer_load_dwordx4 a[220:223], v31, s[16:19], s21 offen offset:1024 sc1
    v_mfma_f32_16x16x32_bf16 a[36:39], a[172:175], v[96:99], 0
    ds_read_b64_tr_b16 a[156:157], v8 offset:36864
    v_mfma_f32_16x16x32_bf16 a[52:55], a[172:175], v[100:103], 0
    ds_read_b64_tr_b16 a[158:159], v8 offset:37376
    s_waitcnt lgkmcnt(8)
    v_mfma_f32_16x16x32_bf16 a[8:11], a[128:131], v[96:99], 0
    ds_read_b64_tr_b16 a[160:161], v5 offset:45056
    ds_read_b64_tr_b16 a[162:163], v5 offset:45568
    v_mfma_f32_16x16x32_bf16 a[24:27], a[128:131], v[100:103], 0
    buffer_load_dwordx4 a[224:227], v31, s[16:19], s21 offen offset:2048 sc1
    v_accvgpr_read_b32 v32, a64
    v_accvgpr_read_b32 v33, a65
    v_mfma_f32_16x16x32_bf16 a[12:15], a[132:135], v[96:99], 0
    ds_read_b64_tr_b16 a[164:165], v6 offset:45056
    ds_read_b64_tr_b16 a[166:167], v6 offset:45568
    v_accvgpr_read_b32 v34, a66
    v_accvgpr_read_b32 v35, a67
    v_accvgpr_read_b32 v36, a68
    v_mfma_f32_16x16x32_bf16 a[28:31], a[132:135], v[100:103], 0
    v_accvgpr_read_b32 v37, a69
    v_accvgpr_read_b32 v38, a70
    v_accvgpr_read_b32 v39, a71
    v_mul_f32 v48, v22, v32
    v_mul_f32 v49, v22, v33
    v_mul_f32 v50, v22, v34
    v_mfma_f32_16x16x32_bf16 a[40:43], a[136:139], v[96:99], 0
    ds_read_b64_tr_b16 a[168:169], v7 offset:45056
    ds_read_b64_tr_b16 a[170:171], v7 offset:45568
    v_mfma_f32_16x16x32_bf16 a[56:59], a[136:139], v[100:103], 0
    buffer_load_dwordx4 a[228:231], v31, s[16:19], s21 offen offset:3072 sc1
    v_mul_f32 v51, v22, v35
    v_mul_f32 v52, v22, v36
    v_mfma_f32_16x16x32_bf16 a[44:47], a[140:143], v[96:99], 0
    ds_read_b64_tr_b16 a[172:173], v8 offset:45056
    ds_read_b64_tr_b16 a[174:175], v8 offset:45568
    v_mul_f32 v53, v22, v37
    v_mul_f32 v54, v22, v38
    v_mfma_f32_16x16x32_bf16 a[60:63], a[140:143], v[100:103], 0
    v_mul_f32 v55, v22, v39
    v_exp_f32 v48, v48
    v_accvgpr_read_b32 v40, a72
    s_waitcnt lgkmcnt(8)
    v_mfma_f32_16x16x32_bf16 a[0:3], a[144:147], v[104:107], a[0:3]
    ds_read_b64_tr_b16 a[128:129], v5 offset:49152
    ds_read_b64_tr_b16 a[130:131], v5 offset:49664
    s_add_u32 s21, s21, 4096
    v_mfma_f32_16x16x32_bf16 a[16:19], a[144:147], v[108:111], a[16:19]
    buffer_load_dwordx4 a[232:235], v31, s[16:19], s21 offen offset:0 sc1
    v_exp_f32 v49, v49
    v_mfma_f32_16x16x32_bf16 a[4:7], a[148:151], v[104:107], a[4:7]
    ds_read_b64_tr_b16 a[132:133], v6 offset:49152
    ds_read_b64_tr_b16 a[134:135], v6 offset:49664
    s_add_u32 m0, s11, 16384
    s_sub_u32 s12, s12, s13
    s_cselect_b32 s12, s14, s12
    v_accvgpr_read_b32 v41, a73
    v_mfma_f32_16x16x32_bf16 a[20:23], a[148:151], v[108:111], a[20:23]
    v_exp_f32 v50, v50
    v_accvgpr_read_b32 v42, a74
    v_exp_f32 v51, v51
    v_accvgpr_read_b32 v43, a75
    v_exp_f32 v52, v52
    v_mfma_f32_16x16x32_bf16 a[32:35], a[152:155], v[104:107], a[32:35]
    ds_read_b64_tr_b16 a[136:137], v7 offset:49152
    ds_read_b64_tr_b16 a[138:139], v7 offset:49664
    v_mfma_f32_16x16x32_bf16 a[48:51], a[152:155], v[108:111], a[48:51]
    buffer_load_dwordx4 v1, s[40:43], s12 offen offset:0 lds
    v_accvgpr_read_b32 v44, a76
    v_mfma_f32_16x16x32_bf16 a[36:39], a[156:159], v[104:107], a[36:39]
    ds_read_b64_tr_b16 a[140:141], v8 offset:49152
    ds_read_b64_tr_b16 a[142:143], v8 offset:49664
    v_exp_f32 v53, v53
    v_mfma_f32_16x16x32_bf16 a[52:55], a[156:159], v[108:111], a[52:55]
    v_accvgpr_read_b32 v45, a77
    v_exp_f32 v54, v54
    v_accvgpr_read_b32 v46, a78
    s_waitcnt lgkmcnt(8)
    v_mfma_f32_16x16x32_bf16 a[8:11], a[160:163], v[104:107], a[8:11]
    ds_read_b64_tr_b16 a[144:145], v5 offset:57344
    ds_read_b64_tr_b16 a[146:147], v5 offset:57856
    s_add_u32 s21, s68, 15360
    v_mfma_f32_16x16x32_bf16 a[24:27], a[160:163], v[108:111], a[24:27]
    buffer_load_dwordx4 a[236:239], v31, s[16:19], s21 offen offset:0 sc1
    v_exp_f32 v55, v55
    v_mfma_f32_16x16x32_bf16 a[12:15], a[164:167], v[104:107], a[12:15]
    ds_read_b64_tr_b16 a[148:149], v6 offset:57344
    ds_read_b64_tr_b16 a[150:151], v6 offset:57856
    v_accvgpr_read_b32 v47, a79
    v_fma_f32 v48, v48, v20, v20
    v_fma_f32 v49, v49, v20, v20
    v_mfma_f32_16x16x32_bf16 a[28:31], a[164:167], v[108:111], a[28:31]
    v_fma_f32 v50, v50, v20, v20
    v_fma_f32 v51, v51, v20, v20
    v_fma_f32 v52, v52, v20, v20
    v_fma_f32 v53, v53, v20, v20
    v_fma_f32 v54, v54, v20, v20
    v_mfma_f32_16x16x32_bf16 a[40:43], a[168:171], v[104:107], a[40:43]
    ds_read_b64_tr_b16 a[152:153], v7 offset:57344
    ds_read_b64_tr_b16 a[154:155], v7 offset:57856
    buffer_load_dwordx4 v2, s[40:43], s12 offen offset:1024 lds
    v_mfma_f32_16x16x32_bf16 a[56:59], a[168:171], v[108:111], a[56:59]
    v_fma_f32 v55, v55, v20, v20
    v_rcp_f32 v48, v48
    v_mfma_f32_16x16x32_bf16 a[44:47], a[172:175], v[104:107], a[44:47]
    ds_read_b64_tr_b16 a[156:157], v8 offset:57344
    ds_read_b64_tr_b16 a[158:159], v8 offset:57856
    v_mul_f32 v32, v32, v40
    v_rcp_f32 v49, v49
    v_mfma_f32_16x16x32_bf16 a[60:63], a[172:175], v[108:111], a[60:63]
    v_mul_f32 v33, v33, v41
    v_rcp_f32 v50, v50
    s_waitcnt lgkmcnt(8)
    v_mfma_f32_16x16x32_bf16 a[0:3], a[128:131], v[112:115], a[0:3]
    ds_read_b64_tr_b16 a[160:161], v5 offset:53248
    ds_read_b64_tr_b16 a[162:163], v5 offset:53760
    v_mfma_f32_16x16x32_bf16 a[16:19], a[128:131], v[116:119], a[16:19]
    buffer_load_dwordx4 a[240:243], v31, s[16:19], s21 offen offset:1024 sc1
    v_mfma_f32_16x16x32_bf16 a[4:7], a[132:135], v[112:115], a[4:7]
    ds_read_b64_tr_b16 a[164:165], v6 offset:53248
    ds_read_b64_tr_b16 a[166:167], v6 offset:53760
    v_mul_f32 v34, v34, v42
    v_rcp_f32 v51, v51
    v_mfma_f32_16x16x32_bf16 a[20:23], a[132:135], v[116:119], a[20:23]
    v_mul_f32 v35, v35, v43
    v_rcp_f32 v52, v52
    v_mul_f32 v36, v36, v44
    v_rcp_f32 v53, v53
    v_mfma_f32_16x16x32_bf16 a[32:35], a[136:139], v[112:115], a[32:35]
    ds_read_b64_tr_b16 a[168:169], v7 offset:53248
    ds_read_b64_tr_b16 a[170:171], v7 offset:53760
    buffer_load_dwordx4 v3, s[40:43], s12 offen offset:2048 lds
    v_mfma_f32_16x16x32_bf16 a[48:51], a[136:139], v[116:119], a[48:51]
    v_mul_f32 v37, v37, v45
    v_rcp_f32 v54, v54
    v_mfma_f32_16x16x32_bf16 a[36:39], a[140:143], v[112:115], a[36:39]
    ds_read_b64_tr_b16 a[172:173], v8 offset:53248
    ds_read_b64_tr_b16 a[174:175], v8 offset:53760
    v_mul_f32 v38, v38, v46
    v_mfma_f32_16x16x32_bf16 a[52:55], a[140:143], v[116:119], a[52:55]
    v_rcp_f32 v55, v55
    v_mul_f32 v39, v39, v47
    v_mul_f32 v32, v32, v48
    s_waitcnt lgkmcnt(8)
    v_mfma_f32_16x16x32_bf16 a[8:11], a[144:147], v[112:115], a[8:11]
    ds_read_b64_tr_b16 a[128:129], v5 offset:61440
    ds_read_b64_tr_b16 a[130:131], v5 offset:61952
    ds_read_b64_tr_b16 a[132:133], v6 offset:61440
    v_mfma_f32_16x16x32_bf16 a[24:27], a[144:147], v[116:119], a[24:27]
    buffer_load_dwordx4 a[244:247], v31, s[16:19], s21 offen offset:2048 sc1
    v_mfma_f32_16x16x32_bf16 a[12:15], a[148:151], v[112:115], a[12:15]
    ds_read_b64_tr_b16 a[134:135], v6 offset:61952
    ds_read_b64_tr_b16 a[136:137], v7 offset:61440
    ds_read_b64_tr_b16 a[138:139], v7 offset:61952
    v_mul_f32 v33, v33, v49
    v_mfma_f32_16x16x32_bf16 a[28:31], a[148:151], v[116:119], a[28:31]
    v_mul_f32 v34, v34, v50
    v_mul_f32 v35, v35, v51
    v_mul_f32 v36, v36, v52
    v_mul_f32 v37, v37, v53
    v_mul_f32 v38, v38, v54
    v_mfma_f32_16x16x32_bf16 a[40:43], a[152:155], v[112:115], a[40:43]
    ds_read_b64_tr_b16 a[140:141], v8 offset:61440
    ds_read_b64_tr_b16 a[142:143], v8 offset:61952
    v_mfma_f32_16x16x32_bf16 a[56:59], a[152:155], v[116:119], a[56:59]
    buffer_load_dwordx4 v4, s[40:43], s12 offen offset:3072 lds
    v_mul_f32 v39, v39, v55
    v_mfma_f32_16x16x32_bf16 a[44:47], a[156:159], v[112:115], a[44:47]
    v_mfma_f32_16x16x32_bf16 a[60:63], a[156:159], v[116:119], a[60:63]
    s_waitcnt vmcnt(35)
    s_barrier
    s_waitcnt lgkmcnt(8)
    v_mfma_f32_16x16x32_bf16 a[0:3], a[160:163], v[120:123], a[0:3]
    ds_read_b64_tr_b16 a[144:145], v5 offset:0
    ds_read_b64_tr_b16 a[146:147], v5 offset:512
    v_mfma_f32_16x16x32_bf16 a[16:19], a[160:163], v[124:127], a[16:19]
    buffer_load_dwordx4 a[248:251], v31, s[16:19], s21 offen offset:3072 sc1
    v_cvt_pk_bf16_f32 v56, v32, v33
    v_cvt_pk_bf16_f32 v57, v34, v35
    v_mfma_f32_16x16x32_bf16 a[4:7], a[164:167], v[120:123], a[4:7]
    ds_read_b64_tr_b16 a[148:149], v6 offset:0
    ds_read_b64_tr_b16 a[150:151], v6 offset:512
    s_add_u32 m0, s11, 32768
    s_sub_u32 s12, s12, s13
    s_cselect_b32 s12, s14, s12
    v_cvt_pk_bf16_f32 v58, v36, v37
    v_cvt_pk_bf16_f32 v59, v38, v39
    v_mfma_f32_16x16x32_bf16 a[20:23], a[164:167], v[124:127], a[20:23]
    buffer_store_dwordx4 v[56:59], v31, s[16:19], s39 offen offset:0 sc1
    v_accvgpr_read_b32 v64, a80
    v_accvgpr_read_b32 v65, a81
    v_accvgpr_read_b32 v66, a82
    v_accvgpr_read_b32 v67, a83
    v_mfma_f32_16x16x32_bf16 a[32:35], a[168:171], v[120:123], a[32:35]
    ds_read_b64_tr_b16 a[152:153], v7 offset:0
    ds_read_b64_tr_b16 a[154:155], v7 offset:512
    v_mfma_f32_16x16x32_bf16 a[48:51], a[168:171], v[124:127], a[48:51]
    buffer_load_dwordx4 v1, s[40:43], s12 offen offset:0 lds
    v_accvgpr_read_b32 v68, a84
    v_mfma_f32_16x16x32_bf16 a[36:39], a[172:175], v[120:123], a[36:39]
    ds_read_b64_tr_b16 a[156:157], v8 offset:0
    ds_read_b64_tr_b16 a[158:159], v8 offset:512
    v_accvgpr_read_b32 v69, a85
    v_accvgpr_read_b32 v70, a86
    v_mfma_f32_16x16x32_bf16 a[52:55], a[172:175], v[124:127], a[52:55]
    v_accvgpr_read_b32 v71, a87
    v_mul_f32 v80, v23, v64
    v_mul_f32 v81, v23, v65
    v_mul_f32 v82, v23, v66
    s_waitcnt lgkmcnt(8)
    v_mfma_f32_16x16x32_bf16 a[8:11], a[128:131], v[120:123], a[8:11]
    ds_read_b64_tr_b16 a[160:161], v5 offset:8192
    ds_read_b64_tr_b16 a[162:163], v5 offset:8704
    s_add_u32 s21, s21, 4096
    v_mfma_f32_16x16x32_bf16 a[24:27], a[128:131], v[124:127], a[24:27]
    buffer_load_dwordx4 a[252:255], v31, s[16:19], s21 offen offset:0 sc1
    v_mul_f32 v83, v23, v67
    v_mul_f32 v84, v23, v68
    v_mfma_f32_16x16x32_bf16 a[12:15], a[132:135], v[120:123], a[12:15]
    ds_read_b64_tr_b16 a[164:165], v6 offset:8192
    ds_read_b64_tr_b16 a[166:167], v6 offset:8704
    v_mul_f32 v85, v23, v69
    v_mul_f32 v86, v23, v70
    v_mul_f32 v87, v23, v71
    v_mfma_f32_16x16x32_bf16 a[28:31], a[132:135], v[124:127], a[28:31]
    v_exp_f32 v80, v80
    v_accvgpr_read_b32 v72, a88
    v_exp_f32 v81, v81
    v_accvgpr_read_b32 v73, a89
    v_mfma_f32_16x16x32_bf16 a[40:43], a[136:139], v[120:123], a[40:43]
    ds_read_b64_tr_b16 a[168:169], v7 offset:8192
    ds_read_b64_tr_b16 a[170:171], v7 offset:8704
    v_mfma_f32_16x16x32_bf16 a[56:59], a[136:139], v[124:127], a[56:59]
    buffer_load_dwordx4 v2, s[40:43], s12 offen offset:1024 lds
    v_exp_f32 v82, v82
    v_mfma_f32_16x16x32_bf16 a[44:47], a[140:143], v[120:123], a[44:47]
    ds_read_b64_tr_b16 a[172:173], v8 offset:8192
    ds_read_b64_tr_b16 a[174:175], v8 offset:8704
    v_accvgpr_read_b32 v74, a90
    v_exp_f32 v83, v83
    v_mfma_f32_16x16x32_bf16 a[60:63], a[140:143], v[124:127], a[60:63]
    v_accvgpr_read_b32 v75, a91
    v_exp_f32 v84, v84
    s_waitcnt lgkmcnt(8)
    v_mfma_f32_16x16x32_bf16 a[0:3], a[144:147], v[128:131], a[0:3]
    ds_read_b64_tr_b16 a[128:129], v5 offset:4096
    ds_read_b64_tr_b16 a[130:131], v5 offset:4608
    s_add_u32 s21, s68, 40960
    v_mfma_f32_16x16x32_bf16 a[16:19], a[144:147], v[132:135], a[16:19]
    buffer_load_dwordx4 a[64:67], v31, s[16:19], s21 offen offset:0 sc1
    v_accvgpr_read_b32 v76, a92
    v_mfma_f32_16x16x32_bf16 a[4:7], a[148:151], v[128:131], a[4:7]
    ds_read_b64_tr_b16 a[132:133], v6 offset:4096
    ds_read_b64_tr_b16 a[134:135], v6 offset:4608
    v_exp_f32 v85, v85
    v_accvgpr_read_b32 v77, a93
    v_mfma_f32_16x16x32_bf16 a[20:23], a[148:151], v[132:135], a[20:23]
    v_exp_f32 v86, v86
    v_accvgpr_read_b32 v78, a94
    v_exp_f32 v87, v87
    v_accvgpr_read_b32 v79, a95
    v_mfma_f32_16x16x32_bf16 a[32:35], a[152:155], v[128:131], a[32:35]
    ds_read_b64_tr_b16 a[136:137], v7 offset:4096
    ds_read_b64_tr_b16 a[138:139], v7 offset:4608
    v_mfma_f32_16x16x32_bf16 a[48:51], a[152:155], v[132:135], a[48:51]
    buffer_load_dwordx4 v3, s[40:43], s12 offen offset:2048 lds
    v_fma_f32 v80, v80, v21, v21
    v_mfma_f32_16x16x32_bf16 a[36:39], a[156:159], v[128:131], a[36:39]
    ds_read_b64_tr_b16 a[140:141], v8 offset:4096
    ds_read_b64_tr_b16 a[142:143], v8 offset:4608
    v_fma_f32 v81, v81, v21, v21
    v_fma_f32 v82, v82, v21, v21
    v_mfma_f32_16x16x32_bf16 a[52:55], a[156:159], v[132:135], a[52:55]
    v_fma_f32 v83, v83, v21, v21
    v_fma_f32 v84, v84, v21, v21
    v_fma_f32 v85, v85, v21, v21
    v_fma_f32 v86, v86, v21, v21
    s_waitcnt lgkmcnt(8)
    v_mfma_f32_16x16x32_bf16 a[8:11], a[160:163], v[128:131], a[8:11]
    ds_read_b64_tr_b16 a[144:145], v5 offset:12288
    ds_read_b64_tr_b16 a[146:147], v5 offset:12800
    buffer_load_dwordx4 a[68:71], v31, s[16:19], s21 offen offset:1024 sc1
    v_mfma_f32_16x16x32_bf16 a[24:27], a[160:163], v[132:135], a[24:27]
    v_fma_f32 v87, v87, v21, v21
    v_rcp_f32 v80, v80
    v_mfma_f32_16x16x32_bf16 a[12:15], a[164:167], v[128:131], a[12:15]
    ds_read_b64_tr_b16 a[148:149], v6 offset:12288
    ds_read_b64_tr_b16 a[150:151], v6 offset:12800
    s_add_u32 s100, s63, 16384
    v_mfma_f32_16x16x32_bf16 a[28:31], a[164:167], v[132:135], a[28:31]
    buffer_load_dwordx2 v[96:97], v18, s[16:19], s100 offen offset:0
    v_mfma_f32_16x16x32_bf16 a[40:43], a[168:171], v[128:131], a[40:43]
    ds_read_b64_tr_b16 a[152:153], v7 offset:12288
    ds_read_b64_tr_b16 a[154:155], v7 offset:12800
    v_mfma_f32_16x16x32_bf16 a[56:59], a[168:171], v[132:135], a[56:59]
    buffer_load_dwordx4 v4, s[40:43], s12 offen offset:3072 lds
    v_mfma_f32_16x16x32_bf16 a[44:47], a[172:175], v[128:131], a[44:47]
    ds_read_b64_tr_b16 a[156:157], v8 offset:12288
    ds_read_b64_tr_b16 a[158:159], v8 offset:12800
    v_mul_f32 v64, v64, v72
    v_rcp_f32 v81, v81
    v_mfma_f32_16x16x32_bf16 a[60:63], a[172:175], v[132:135], a[60:63]
    v_mul_f32 v65, v65, v73
    v_rcp_f32 v82, v82
    s_waitcnt lgkmcnt(8)
    v_mfma_f32_16x16x32_bf16 a[0:3], a[128:131], v[136:139], a[0:3]
    ds_read_b64_tr_b16 a[160:161], v13 offset:16384
    ds_read_b64_tr_b16 a[162:163], v13 offset:16896
    buffer_load_dwordx4 a[72:75], v31, s[16:19], s21 offen offset:2048 sc1
    v_mfma_f32_16x16x32_bf16 a[16:19], a[128:131], v[140:143], a[16:19]
    v_mul_f32 v66, v66, v74
    v_rcp_f32 v83, v83
    v_mfma_f32_16x16x32_bf16 a[4:7], a[132:135], v[136:139], a[4:7]
    ds_read_b64_tr_b16 a[164:165], v14 offset:16384
    ds_read_b64_tr_b16 a[166:167], v14 offset:16896
    s_add_u32 s100, s64, 16384
    v_mfma_f32_16x16x32_bf16 a[20:23], a[132:135], v[140:143], a[20:23]
    buffer_load_dwordx2 v[98:99], v18, s[16:19], s100 offen offset:0
    v_mfma_f32_16x16x32_bf16 a[32:35], a[136:139], v[136:139], a[32:35]
    ds_read_b64_tr_b16 a[168:169], v15 offset:16384
    ds_read_b64_tr_b16 a[170:171], v15 offset:16896
    v_mfma_f32_16x16x32_bf16 a[48:51], a[136:139], v[140:143], a[48:51]
    buffer_load_dwordx4 a[76:79], v31, s[16:19], s21 offen offset:3072 sc1
    v_mfma_f32_16x16x32_bf16 a[36:39], a[140:143], v[136:139], a[36:39]
    ds_read_b64_tr_b16 a[172:173], v16 offset:16384
    ds_read_b64_tr_b16 a[174:175], v16 offset:16896
    v_mul_f32 v67, v67, v75
    v_rcp_f32 v84, v84
    v_mfma_f32_16x16x32_bf16 a[52:55], a[140:143], v[140:143], a[52:55]
    v_mul_f32 v68, v68, v76
    v_rcp_f32 v85, v85
    s_waitcnt lgkmcnt(8)
    v_mfma_f32_16x16x32_bf16 a[8:11], a[144:147], v[136:139], a[8:11]
    ds_read_b64_tr_b16 a[128:129], v13 offset:24576
    ds_read_b64_tr_b16 a[130:131], v13 offset:25088
    s_add_u32 s21, s21, 4096
    v_mfma_f32_16x16x32_bf16 a[24:27], a[144:147], v[140:143], a[24:27]
    buffer_load_dwordx4 a[80:83], v31, s[16:19], s21 offen offset:0 sc1
    v_mul_f32 v69, v69, v77
    v_rcp_f32 v86, v86
    v_mfma_f32_16x16x32_bf16 a[12:15], a[148:151], v[136:139], a[12:15]
    ds_read_b64_tr_b16 a[132:133], v14 offset:24576
    ds_read_b64_tr_b16 a[134:135], v14 offset:25088
    v_mul_f32 v70, v70, v78
    v_rcp_f32 v87, v87
    v_mfma_f32_16x16x32_bf16 a[28:31], a[148:151], v[140:143], a[28:31]
    v_mul_f32 v71, v71, v79
    v_mul_f32 v64, v64, v80
    v_mul_f32 v65, v65, v81
    v_mul_f32 v66, v66, v82
    v_mul_f32 v67, v67, v83
    v_mfma_f32_16x16x32_bf16 a[40:43], a[152:155], v[136:139], a[40:43]
    ds_read_b64_tr_b16 a[136:137], v15 offset:24576
    ds_read_b64_tr_b16 a[138:139], v15 offset:25088
    s_add_u32 s21, s68, 20480
    v_mfma_f32_16x16x32_bf16 a[56:59], a[152:155], v[140:143], a[56:59]
    buffer_load_dwordx4 v[116:119], v31, s[16:19], s21 offen offset:0 sc1
    v_mul_f32 v68, v68, v84
    v_mfma_f32_16x16x32_bf16 a[44:47], a[156:159], v[136:139], a[44:47]
    ds_read_b64_tr_b16 a[140:141], v16 offset:24576
    ds_read_b64_tr_b16 a[142:143], v16 offset:25088
    v_mul_f32 v69, v69, v85
    v_mul_f32 v70, v70, v86
    v_mfma_f32_16x16x32_bf16 a[60:63], a[156:159], v[140:143], a[60:63]
    v_mul_f32 v71, v71, v87
    v_cvt_pk_bf16_f32 v88, v64, v65
    v_cvt_pk_bf16_f32 v89, v66, v67
    v_cvt_pk_bf16_f32 v90, v68, v69
    s_waitcnt lgkmcnt(8)
    v_mfma_f32_16x16x32_bf16 a[0:3], a[160:163], v[144:147], a[0:3]
    ds_read_b64_tr_b16 a[144:145], v13 offset:20480
    ds_read_b64_tr_b16 a[146:147], v13 offset:20992
    buffer_load_dwordx4 v[120:123], v31, s[16:19], s21 offen offset:1024 sc1
    v_mfma_f32_16x16x32_bf16 a[16:19], a[160:163], v[148:151], a[16:19]
    v_cvt_pk_bf16_f32 v91, v70, v71
    buffer_store_dwordx4 v[88:91], v31, s[16:19], s39 offen offset:1024 sc1
    v_mfma_f32_16x16x32_bf16 a[4:7], a[164:167], v[144:147], a[4:7]
    ds_read_b64_tr_b16 a[148:149], v14 offset:20480
    ds_read_b64_tr_b16 a[150:151], v14 offset:20992
    v_accvgpr_read_b32 v32, a96
    v_accvgpr_read_b32 v33, a97
    v_mfma_f32_16x16x32_bf16 a[20:23], a[164:167], v[148:151], a[20:23]
    v_accvgpr_read_b32 v34, a98
    v_accvgpr_read_b32 v35, a99
    v_accvgpr_read_b32 v36, a100
    v_accvgpr_read_b32 v37, a101
    v_accvgpr_read_b32 v38, a102
    v_mfma_f32_16x16x32_bf16 a[32:35], a[168:171], v[144:147], a[32:35]
    ds_read_b64_tr_b16 a[152:153], v15 offset:20480
    ds_read_b64_tr_b16 a[154:155], v15 offset:20992
    v_mfma_f32_16x16x32_bf16 a[48:51], a[168:171], v[148:151], a[48:51]
    buffer_load_dwordx4 v[124:127], v31, s[16:19], s21 offen offset:2048 sc1
    v_accvgpr_read_b32 v39, a103
    v_mfma_f32_16x16x32_bf16 a[36:39], a[172:175], v[144:147], a[36:39]
    ds_read_b64_tr_b16 a[156:157], v16 offset:20480
    ds_read_b64_tr_b16 a[158:159], v16 offset:20992
    v_mul_f32 v48, v22, v32
    v_mul_f32 v49, v22, v33
    v_mfma_f32_16x16x32_bf16 a[52:55], a[172:175], v[148:151], a[52:55]
    v_mul_f32 v50, v22, v34
    v_mul_f32 v51, v22, v35
    v_mul_f32 v52, v22, v36
    v_mul_f32 v53, v22, v37
    s_waitcnt lgkmcnt(8)
    v_mfma_f32_16x16x32_bf16 a[8:11], a[128:131], v[144:147], a[8:11]
    ds_read_b64_tr_b16 a[160:161], v13 offset:28672
    ds_read_b64_tr_b16 a[162:163], v13 offset:29184
    ds_read_b64_tr_b16 a[164:165], v14 offset:28672
    v_mfma_f32_16x16x32_bf16 a[24:27], a[128:131], v[148:151], a[24:27]
    buffer_load_dwordx4 v[128:131], v31, s[16:19], s21 offen offset:3072 sc1
    v_mfma_f32_16x16x32_bf16 a[12:15], a[132:135], v[144:147], a[12:15]
    ds_read_b64_tr_b16 a[166:167], v14 offset:29184
    ds_read_b64_tr_b16 a[168:169], v15 offset:28672
    ds_read_b64_tr_b16 a[170:171], v15 offset:29184
    v_mul_f32 v54, v22, v38
    v_mul_f32 v55, v22, v39
    v_mfma_f32_16x16x32_bf16 a[28:31], a[132:135], v[148:151], a[28:31]
    v_exp_f32 v48, v48
    v_accvgpr_read_b32 v40, a104
    v_exp_f32 v49, v49
    v_mfma_f32_16x16x32_bf16 a[40:43], a[136:139], v[144:147], a[40:43]
    ds_read_b64_tr_b16 a[172:173], v16 offset:28672
    ds_read_b64_tr_b16 a[174:175], v16 offset:29184
    s_add_u32 s21, s21, 4096
    v_mfma_f32_16x16x32_bf16 a[56:59], a[136:139], v[148:151], a[56:59]
    buffer_load_dwordx4 v[132:135], v31, s[16:19], s21 offen offset:0 sc1
    v_accvgpr_read_b32 v41, a105
    v_mfma_f32_16x16x32_bf16 a[44:47], a[140:143], v[144:147], a[44:47]
    v_mfma_f32_16x16x32_bf16 a[60:63], a[140:143], v[148:151], a[60:63]
    s_waitcnt vmcnt(38)
    s_barrier
    s_waitcnt lgkmcnt(8)
    v_mfma_f32_16x16x32_bf16 a[0:3], a[144:147], v[152:155], a[0:3]
    ds_read_b64_tr_b16 a[128:129], v9 offset:32768
    ds_read_b64_tr_b16 a[130:131], v9 offset:33280
    s_add_u32 s21, s68, 46080
    v_mfma_f32_16x16x32_bf16 a[16:19], a[144:147], v[156:159], a[16:19]
    buffer_load_dwordx4 a[84:87], v31, s[16:19], s21 offen offset:0 sc1
    v_exp_f32 v50, v50
    v_mfma_f32_16x16x32_bf16 a[4:7], a[148:151], v[152:155], a[4:7]
    ds_read_b64_tr_b16 a[132:133], v10 offset:32768
    ds_read_b64_tr_b16 a[134:135], v10 offset:33280
    s_add_u32 m0, s11, 49152
    s_sub_u32 s12, s12, s13
    s_cselect_b32 s12, s14, s12
    v_accvgpr_read_b32 v42, a106
    v_mfma_f32_16x16x32_bf16 a[20:23], a[148:151], v[156:159], a[20:23]
    v_exp_f32 v51, v51
    v_accvgpr_read_b32 v43, a107
    v_exp_f32 v52, v52
    v_accvgpr_read_b32 v44, a108
    v_exp_f32 v53, v53
    v_mfma_f32_16x16x32_bf16 a[32:35], a[152:155], v[152:155], a[32:35]
    ds_read_b64_tr_b16 a[136:137], v11 offset:32768
    ds_read_b64_tr_b16 a[138:139], v11 offset:33280
    v_mfma_f32_16x16x32_bf16 a[48:51], a[152:155], v[156:159], a[48:51]
    buffer_load_dwordx4 v1, s[40:43], s12 offen offset:0 lds
    v_accvgpr_read_b32 v45, a109
    v_mfma_f32_16x16x32_bf16 a[36:39], a[156:159], v[152:155], a[36:39]
    ds_read_b64_tr_b16 a[140:141], v12 offset:32768
    ds_read_b64_tr_b16 a[142:143], v12 offset:33280
    v_exp_f32 v54, v54
    v_mfma_f32_16x16x32_bf16 a[52:55], a[156:159], v[156:159], a[52:55]
    v_accvgpr_read_b32 v46, a110
    v_exp_f32 v55, v55
    v_accvgpr_read_b32 v47, a111
    s_waitcnt lgkmcnt(8)
    v_mfma_f32_16x16x32_bf16 a[8:11], a[160:163], v[152:155], a[8:11]
    ds_read_b64_tr_b16 a[144:145], v9 offset:40960
    ds_read_b64_tr_b16 a[146:147], v9 offset:41472
    v_mfma_f32_16x16x32_bf16 a[24:27], a[160:163], v[156:159], a[24:27]
    buffer_load_dwordx4 a[88:91], v31, s[16:19], s21 offen offset:1024 sc1
    v_fma_f32 v48, v48, v20, v20
    v_mfma_f32_16x16x32_bf16 a[12:15], a[164:167], v[152:155], a[12:15]
    ds_read_b64_tr_b16 a[148:149], v10 offset:40960
    ds_read_b64_tr_b16 a[150:151], v10 offset:41472
    v_fma_f32 v49, v49, v20, v20
    v_fma_f32 v50, v50, v20, v20
    v_fma_f32 v51, v51, v20, v20
    v_mfma_f32_16x16x32_bf16 a[28:31], a[164:167], v[156:159], a[28:31]
    v_fma_f32 v52, v52, v20, v20
    v_fma_f32 v53, v53, v20, v20
    v_fma_f32 v54, v54, v20, v20
    v_fma_f32 v55, v55, v20, v20
    v_rcp_f32 v48, v48
    v_mfma_f32_16x16x32_bf16 a[40:43], a[168:171], v[152:155], a[40:43]
    ds_read_b64_tr_b16 a[152:153], v11 offset:40960
    ds_read_b64_tr_b16 a[154:155], v11 offset:41472
    buffer_load_dwordx4 v2, s[40:43], s12 offen offset:1024 lds
    v_mfma_f32_16x16x32_bf16 a[56:59], a[168:171], v[156:159], a[56:59]
    v_mul_f32 v32, v32, v40
    v_rcp_f32 v49, v49
    v_mfma_f32_16x16x32_bf16 a[44:47], a[172:175], v[152:155], a[44:47]
    ds_read_b64_tr_b16 a[156:157], v12 offset:40960
    ds_read_b64_tr_b16 a[158:159], v12 offset:41472
    v_mul_f32 v33, v33, v41
    v_rcp_f32 v50, v50
    v_mfma_f32_16x16x32_bf16 a[60:63], a[172:175], v[156:159], a[60:63]
    v_mul_f32 v34, v34, v42
    v_rcp_f32 v51, v51
    s_waitcnt lgkmcnt(8)
    v_mfma_f32_16x16x32_bf16 a[0:3], a[128:131], v[160:163], a[0:3]
    ds_read_b64_tr_b16 a[160:161], v9 offset:36864
    ds_read_b64_tr_b16 a[162:163], v9 offset:37376
    v_mfma_f32_16x16x32_bf16 a[16:19], a[128:131], v[164:167], a[16:19]
    buffer_load_dwordx4 a[92:95], v31, s[16:19], s21 offen offset:2048 sc1
    v_mfma_f32_16x16x32_bf16 a[4:7], a[132:135], v[160:163], a[4:7]
    ds_read_b64_tr_b16 a[164:165], v10 offset:36864
    ds_read_b64_tr_b16 a[166:167], v10 offset:37376
    v_mul_f32 v35, v35, v43
    v_rcp_f32 v52, v52
    v_mfma_f32_16x16x32_bf16 a[20:23], a[132:135], v[164:167], a[20:23]
    v_mul_f32 v36, v36, v44
    v_rcp_f32 v53, v53
    v_mul_f32 v37, v37, v45
    v_rcp_f32 v54, v54
    v_mfma_f32_16x16x32_bf16 a[32:35], a[136:139], v[160:163], a[32:35]
    ds_read_b64_tr_b16 a[168:169], v11 offset:36864
    ds_read_b64_tr_b16 a[170:171], v11 offset:37376
    buffer_load_dwordx4 v3, s[40:43], s12 offen offset:2048 lds
    v_mfma_f32_16x16x32_bf16 a[48:51], a[136:139], v[164:167], a[48:51]
    v_mul_f32 v38, v38, v46
    v_rcp_f32 v55, v55
    v_mfma_f32_16x16x32_bf16 a[36:39], a[140:143], v[160:163], a[36:39]
    ds_read_b64_tr_b16 a[172:173], v12 offset:36864
    ds_read_b64_tr_b16 a[174:175], v12 offset:37376
    v_mul_f32 v39, v39, v47
    v_mul_f32 v32, v32, v48
    v_mfma_f32_16x16x32_bf16 a[52:55], a[140:143], v[164:167], a[52:55]
    v_mul_f32 v33, v33, v49
    v_mul_f32 v34, v34, v50
    v_mul_f32 v35, v35, v51
    s_waitcnt lgkmcnt(8)
    v_mfma_f32_16x16x32_bf16 a[8:11], a[144:147], v[160:163], a[8:11]
    ds_read_b64_tr_b16 a[128:129], v9 offset:45056
    ds_read_b64_tr_b16 a[130:131], v9 offset:45568
    v_mfma_f32_16x16x32_bf16 a[24:27], a[144:147], v[164:167], a[24:27]
    buffer_load_dwordx4 a[96:99], v31, s[16:19], s21 offen offset:3072 sc1
    v_mul_f32 v36, v36, v52
    v_mfma_f32_16x16x32_bf16 a[12:15], a[148:151], v[160:163], a[12:15]
    ds_read_b64_tr_b16 a[132:133], v10 offset:45056
    ds_read_b64_tr_b16 a[134:135], v10 offset:45568
    s_waitcnt vmcnt(18)
    v_cmp_ne_u64 vcc, s[60:61], v[96:97]
    v_mfma_f32_16x16x32_bf16 a[28:31], a[148:151], v[164:167], a[28:31]
    s_nop 0
    s_cmp_lg_u64 vcc, 0
    s_cbranch_scc1 fc_6_slow
fc_6_ok:
    v_mfma_f32_16x16x32_bf16 a[40:43], a[152:155], v[160:163], a[40:43]
    ds_read_b64_tr_b16 a[136:137], v11 offset:45056
    ds_read_b64_tr_b16 a[138:139], v11 offset:45568
    v_mfma_f32_16x16x32_bf16 a[56:59], a[152:155], v[164:167], a[56:59]
    buffer_load_dwordx4 v4, s[40:43], s12 offen offset:3072 lds
    v_mul_f32 v37, v37, v53
    v_mul_f32 v38, v38, v54
    v_mfma_f32_16x16x32_bf16 a[44:47], a[156:159], v[160:163], a[44:47]
    ds_read_b64_tr_b16 a[140:141], v12 offset:45056
    ds_read_b64_tr_b16 a[142:143], v12 offset:45568
    v_mul_f32 v39, v39, v55
    v_cvt_pk_bf16_f32 v60, v32, v33
    v_cvt_pk_bf16_f32 v61, v34, v35
    v_cvt_pk_bf16_f32 v62, v36, v37
    v_cvt_pk_bf16_f32 v63, v38, v39
    v_mfma_f32_16x16x32_bf16 a[60:63], a[156:159], v[164:167], a[60:63]
    s_add_u32 s39, s39, 4096
    buffer_store_dwordx4 v[60:63], v31, s[16:19], s39 offen offset:0 sc1
    s_waitcnt lgkmcnt(8)
    v_mfma_f32_16x16x32_bf16 a[0:3], a[160:163], v[168:171], a[0:3]
    ds_read_b64_tr_b16 a[144:145], v9 offset:16384
    ds_read_b64_tr_b16 a[146:147], v9 offset:16896
    s_add_u32 s21, s21, 4096
    v_mfma_f32_16x16x32_bf16 a[16:19], a[160:163], v[172:175], a[16:19]
    buffer_load_dwordx4 a[100:103], v31, s[16:19], s21 offen offset:0 sc1
    v_mfma_f32_16x16x32_bf16 a[4:7], a[164:167], v[168:171], a[4:7]
    ds_read_b64_tr_b16 a[148:149], v10 offset:16384
    ds_read_b64_tr_b16 a[150:151], v10 offset:16896
    s_waitcnt vmcnt(18)
    v_cmp_ne_u64 vcc, s[60:61], v[98:99]
    v_mfma_f32_16x16x32_bf16 a[20:23], a[164:167], v[172:175], a[20:23]
    s_nop 0
    s_cmp_lg_u64 vcc, 0
    s_cbranch_scc1 fc_7_slow
fc_7_ok:
    v_mfma_f32_16x16x32_bf16 a[32:35], a[168:171], v[168:171], a[32:35]
    ds_read_b64_tr_b16 a[152:153], v11 offset:16384
    ds_read_b64_tr_b16 a[154:155], v11 offset:16896
    v_mfma_f32_16x16x32_bf16 a[48:51], a[168:171], v[172:175], a[48:51]
    buffer_load_dwordx2 v[96:97], v28, s[16:19], s74 offen offset:0 sc1
    v_accvgpr_read_b32 v64, a112
    v_accvgpr_read_b32 v65, a113
    v_mfma_f32_16x16x32_bf16 a[36:39], a[172:175], v[168:171], a[36:39]
    ds_read_b64_tr_b16 a[156:157], v12 offset:16384
    ds_read_b64_tr_b16 a[158:159], v12 offset:16896
    v_accvgpr_read_b32 v66, a114
    v_accvgpr_read_b32 v67, a115
    v_mfma_f32_16x16x32_bf16 a[52:55], a[172:175], v[172:175], a[52:55]
    v_accvgpr_read_b32 v68, a116
    v_accvgpr_read_b32 v69, a117
    v_accvgpr_read_b32 v70, a118
    v_accvgpr_read_b32 v71, a119
    s_waitcnt lgkmcnt(8)
    v_mfma_f32_16x16x32_bf16 a[8:11], a[128:131], v[168:171], a[8:11]
    ds_read_b64_tr_b16 a[160:161], v9 offset:24576
    ds_read_b64_tr_b16 a[162:163], v9 offset:25088
    s_add_u32 s21, s68, 25600
    v_mfma_f32_16x16x32_bf16 a[24:27], a[128:131], v[172:175], a[24:27]
    buffer_load_dwordx4 v[136:139], v31, s[16:19], s21 offen offset:0 sc1
    v_mul_f32 v80, v23, v64
    v_mfma_f32_16x16x32_bf16 a[12:15], a[132:135], v[168:171], a[12:15]
    ds_read_b64_tr_b16 a[164:165], v10 offset:24576
    ds_read_b64_tr_b16 a[166:167], v10 offset:25088
    v_mul_f32 v81, v23, v65
    v_mul_f32 v82, v23, v66
    v_mul_f32 v83, v23, v67
    v_mfma_f32_16x16x32_bf16 a[28:31], a[132:135], v[172:175], a[28:31]
    v_mul_f32 v84, v23, v68
    v_mul_f32 v85, v23, v69
    v_mul_f32 v86, v23, v70
    v_mul_f32 v87, v23, v71
    v_exp_f32 v80, v80
    v_mfma_f32_16x16x32_bf16 a[40:43], a[136:139], v[168:171], a[40:43]
    ds_read_b64_tr_b16 a[168:169], v11 offset:24576
    ds_read_b64_tr_b16 a[170:171], v11 offset:25088
    buffer_load_dwordx4 v[140:143], v31, s[16:19], s21 offen offset:1024 sc1
    v_mfma_f32_16x16x32_bf16 a[56:59], a[136:139], v[172:175], a[56:59]
    v_accvgpr_read_b32 v72, a120
    v_exp_f32 v81, v81
    v_mfma_f32_16x16x32_bf16 a[44:47], a[140:143], v[168:171], a[44:47]
    ds_read_b64_tr_b16 a[172:173], v12 offset:24576
    ds_read_b64_tr_b16 a[174:175], v12 offset:25088
    v_accvgpr_read_b32 v73, a121
    v_exp_f32 v82, v82
    v_mfma_f32_16x16x32_bf16 a[60:63], a[140:143], v[172:175], a[60:63]
    v_accvgpr_read_b32 v74, a122
    v_exp_f32 v83, v83
    s_waitcnt lgkmcnt(8)
    v_mfma_f32_16x16x32_bf16 a[0:3], a[144:147], v[176:179], a[0:3]
    ds_read_b64_tr_b16 a[128:129], v9 offset:20480
    ds_read_b64_tr_b16 a[130:131], v9 offset:20992
    v_mfma_f32_16x16x32_bf16 a[16:19], a[144:147], v[180:183], a[16:19]
    buffer_load_dwordx2 v[98:99], v28, s[16:19], s74 offen offset:256 sc1
    v_mfma_f32_16x16x32_bf16 a[4:7], a[148:151], v[176:179], a[4:7]
    ds_read_b64_tr_b16 a[132:133], v10 offset:20480
    ds_read_b64_tr_b16 a[134:135], v10 offset:20992
    v_accvgpr_read_b32 v75, a123
    v_exp_f32 v84, v84
    v_mfma_f32_16x16x32_bf16 a[20:23], a[148:151], v[180:183], a[20:23]
    v_accvgpr_read_b32 v76, a124
    v_exp_f32 v85, v85
    v_accvgpr_read_b32 v77, a125
    v_exp_f32 v86, v86
    v_mfma_f32_16x16x32_bf16 a[32:35], a[152:155], v[176:179], a[32:35]
    ds_read_b64_tr_b16 a[136:137], v11 offset:20480
    ds_read_b64_tr_b16 a[138:139], v11 offset:20992
    buffer_load_dwordx4 v[144:147], v31, s[16:19], s21 offen offset:2048 sc1
    v_mfma_f32_16x16x32_bf16 a[48:51], a[152:155], v[180:183], a[48:51]
    v_accvgpr_read_b32 v78, a126
    v_exp_f32 v87, v87
    v_mfma_f32_16x16x32_bf16 a[36:39], a[156:159], v[176:179], a[36:39]
    ds_read_b64_tr_b16 a[140:141], v12 offset:20480
    ds_read_b64_tr_b16 a[142:143], v12 offset:20992
    v_accvgpr_read_b32 v79, a127
    v_fma_f32 v80, v80, v21, v21
    v_mfma_f32_16x16x32_bf16 a[52:55], a[156:159], v[180:183], a[52:55]
    v_fma_f32 v81, v81, v21, v21
    v_fma_f32 v82, v82, v21, v21
    v_fma_f32 v83, v83, v21, v21
    s_waitcnt lgkmcnt(8)
    v_mfma_f32_16x16x32_bf16 a[8:11], a[160:163], v[176:179], a[8:11]
    ds_read_b64_tr_b16 a[144:145], v9 offset:28672
    ds_read_b64_tr_b16 a[146:147], v9 offset:29184
    ds_read_b64_tr_b16 a[148:149], v10 offset:28672
    v_mfma_f32_16x16x32_bf16 a[24:27], a[160:163], v[180:183], a[24:27]
    buffer_load_dwordx4 v[148:151], v31, s[16:19], s21 offen offset:3072 sc1
    v_mfma_f32_16x16x32_bf16 a[12:15], a[164:167], v[176:179], a[12:15]
    ds_read_b64_tr_b16 a[150:151], v10 offset:29184
    ds_read_b64_tr_b16 a[152:153], v11 offset:28672
    ds_read_b64_tr_b16 a[154:155], v11 offset:29184
    v_fma_f32 v84, v84, v21, v21
    v_mfma_f32_16x16x32_bf16 a[28:31], a[164:167], v[180:183], a[28:31]
    v_fma_f32 v85, v85, v21, v21
    v_fma_f32 v86, v86, v21, v21
    v_fma_f32 v87, v87, v21, v21
    v_rcp_f32 v80, v80
    v_mfma_f32_16x16x32_bf16 a[40:43], a[168:171], v[176:179], a[40:43]
    ds_read_b64_tr_b16 a[156:157], v12 offset:28672
    ds_read_b64_tr_b16 a[158:159], v12 offset:29184
    v_mfma_f32_16x16x32_bf16 a[56:59], a[168:171], v[180:183], a[56:59]
    buffer_load_dwordx2 v[100:101], v28, s[16:19], s74 offen offset:512 sc1
    v_mul_f32 v64, v64, v72
    v_mfma_f32_16x16x32_bf16 a[44:47], a[172:175], v[176:179], a[44:47]
    v_mfma_f32_16x16x32_bf16 a[60:63], a[172:175], v[180:183], a[60:63]
    s_waitcnt vmcnt(37)
    s_barrier
    s_waitcnt lgkmcnt(8)
    v_mfma_f32_16x16x32_bf16 a[0:3], a[128:131], v[184:187], a[0:3]
    ds_read_b64_tr_b16 a[160:161], v9 offset:0
    ds_read_b64_tr_b16 a[162:163], v9 offset:512
    s_add_u32 s21, s21, 4096
    v_mfma_f32_16x16x32_bf16 a[16:19], a[128:131], v[188:191], a[16:19]
    buffer_load_dwordx4 v[152:155], v31, s[16:19], s21 offen offset:0 sc1
    v_rcp_f32 v81, v81
    v_mfma_f32_16x16x32_bf16 a[4:7], a[132:135], v[184:187], a[4:7]
    ds_read_b64_tr_b16 a[164:165], v10 offset:0
    ds_read_b64_tr_b16 a[166:167], v10 offset:512
    v_mul_f32 v65, v65, v73
    v_rcp_f32 v82, v82
    v_mfma_f32_16x16x32_bf16 a[20:23], a[132:135], v[188:191], a[20:23]
    v_mul_f32 v66, v66, v74
    v_rcp_f32 v83, v83
    v_mul_f32 v67, v67, v75
    v_rcp_f32 v84, v84
    v_mfma_f32_16x16x32_bf16 a[32:35], a[136:139], v[184:187], a[32:35]
    ds_read_b64_tr_b16 a[168:169], v11 offset:0
    ds_read_b64_tr_b16 a[170:171], v11 offset:512
    s_add_u32 s21, s68, 30720
    v_mfma_f32_16x16x32_bf16 a[48:51], a[136:139], v[188:191], a[48:51]
    buffer_load_dwordx4 v[156:159], v31, s[16:19], s21 offen offset:0 sc1
    v_mul_f32 v68, v68, v76
    v_mfma_f32_16x16x32_bf16 a[36:39], a[140:143], v[184:187], a[36:39]
    ds_read_b64_tr_b16 a[172:173], v12 offset:0
    ds_read_b64_tr_b16 a[174:175], v12 offset:512
    v_rcp_f32 v85, v85
    v_mfma_f32_16x16x32_bf16 a[52:55], a[140:143], v[188:191], a[52:55]
    v_mul_f32 v69, v69, v77
    v_rcp_f32 v86, v86
    v_mul_f32 v70, v70, v78
    s_waitcnt lgkmcnt(8)
    v_mfma_f32_16x16x32_bf16 a[8:11], a[144:147], v[184:187], a[8:11]
    ds_read_b64_tr_b16 a[128:129], v9 offset:8192
    ds_read_b64_tr_b16 a[130:131], v9 offset:8704
    v_mfma_f32_16x16x32_bf16 a[24:27], a[144:147], v[188:191], a[24:27]
    buffer_load_dwordx2 v[102:103], v28, s[16:19], s74 offen offset:768 sc1
    v_rcp_f32 v87, v87
    v_mfma_f32_16x16x32_bf16 a[12:15], a[148:151], v[184:187], a[12:15]
    ds_read_b64_tr_b16 a[132:133], v10 offset:8192
    ds_read_b64_tr_b16 a[134:135], v10 offset:8704
    v_mul_f32 v71, v71, v79
    v_mul_f32 v64, v64, v80
    v_mul_f32 v65, v65, v81
    v_mfma_f32_16x16x32_bf16 a[28:31], a[148:151], v[188:191], a[28:31]
    v_mul_f32 v66, v66, v82
    v_mul_f32 v67, v67, v83
    v_mul_f32 v68, v68, v84
    v_mul_f32 v69, v69, v85
    v_mul_f32 v70, v70, v86
    v_mul_f32 v71, v71, v87
    v_mfma_f32_16x16x32_bf16 a[40:43], a[152:155], v[184:187], a[40:43]
    ds_read_b64_tr_b16 a[136:137], v11 offset:8192
    ds_read_b64_tr_b16 a[138:139], v11 offset:8704
    v_mfma_f32_16x16x32_bf16 a[56:59], a[152:155], v[188:191], a[56:59]
    buffer_load_dwordx4 v[160:163], v31, s[16:19], s21 offen offset:1024 sc1
    v_cvt_pk_bf16_f32 v92, v64, v65
    v_mfma_f32_16x16x32_bf16 a[44:47], a[156:159], v[184:187], a[44:47]
    ds_read_b64_tr_b16 a[140:141], v12 offset:8192
    ds_read_b64_tr_b16 a[142:143], v12 offset:8704
    v_cvt_pk_bf16_f32 v93, v66, v67
    v_cvt_pk_bf16_f32 v94, v68, v69
    v_cvt_pk_bf16_f32 v95, v70, v71
    v_mfma_f32_16x16x32_bf16 a[60:63], a[156:159], v[188:191], a[60:63]
    buffer_store_dwordx4 v[92:95], v31, s[16:19], s39 offen offset:1024 sc1
    s_waitcnt lgkmcnt(8)
    v_mfma_f32_16x16x32_bf16 a[0:3], a[160:163], v[192:195], a[0:3]
    ds_read_b64_tr_b16 a[144:145], v9 offset:4096
    ds_read_b64_tr_b16 a[146:147], v9 offset:4608
    v_mfma_f32_16x16x32_bf16 a[16:19], a[160:163], v[196:199], a[16:19]
    buffer_load_dwordx4 v[164:167], v31, s[16:19], s21 offen offset:2048 sc1
    v_mfma_f32_16x16x32_bf16 a[4:7], a[164:167], v[192:195], a[4:7]
    ds_read_b64_tr_b16 a[148:149], v10 offset:4096
    v_mfma_f32_16x16x32_bf16 a[20:23], a[164:167], v[196:199], a[20:23]
    ds_read_b64_tr_b16 a[150:151], v10 offset:4608
    v_mfma_f32_16x16x32_bf16 a[32:35], a[168:171], v[192:195], a[32:35]
    ds_read_b64_tr_b16 a[152:153], v11 offset:4096
    ds_read_b64_tr_b16 a[154:155], v11 offset:4608
    v_mfma_f32_16x16x32_bf16 a[48:51], a[168:171], v[196:199], a[48:51]
    buffer_load_dwordx2 v[104:105], v28, s[16:19], s74 offen offset:1024 sc1
    v_mfma_f32_16x16x32_bf16 a[36:39], a[172:175], v[192:195], a[36:39]
    ds_read_b64_tr_b16 a[156:157], v12 offset:4096
    v_mfma_f32_16x16x32_bf16 a[52:55], a[172:175], v[196:199], a[52:55]
    ds_read_b64_tr_b16 a[158:159], v12 offset:4608
    s_waitcnt lgkmcnt(8)
    v_mfma_f32_16x16x32_bf16 a[8:11], a[128:131], v[192:195], a[8:11]
    ds_read_b64_tr_b16 a[160:161], v9 offset:12288
    ds_read_b64_tr_b16 a[162:163], v9 offset:12800
    v_mfma_f32_16x16x32_bf16 a[24:27], a[128:131], v[196:199], a[24:27]
    buffer_load_dwordx4 v[168:171], v31, s[16:19], s21 offen offset:3072 sc1
    v_mfma_f32_16x16x32_bf16 a[12:15], a[132:135], v[192:195], a[12:15]
    ds_read_b64_tr_b16 a[164:165], v10 offset:12288
    v_mfma_f32_16x16x32_bf16 a[28:31], a[132:135], v[196:199], a[28:31]
    ds_read_b64_tr_b16 a[166:167], v10 offset:12800
    v_mfma_f32_16x16x32_bf16 a[40:43], a[136:139], v[192:195], a[40:43]
    ds_read_b64_tr_b16 a[168:169], v11 offset:12288
    ds_read_b64_tr_b16 a[170:171], v11 offset:12800
    s_add_u32 s21, s21, 4096
    v_mfma_f32_16x16x32_bf16 a[56:59], a[136:139], v[196:199], a[56:59]
    buffer_load_dwordx4 v[172:175], v31, s[16:19], s21 offen offset:0 sc1
    v_mfma_f32_16x16x32_bf16 a[44:47], a[140:143], v[192:195], a[44:47]
    ds_read_b64_tr_b16 a[172:173], v12 offset:12288
    v_mfma_f32_16x16x32_bf16 a[60:63], a[140:143], v[196:199], a[60:63]
    ds_read_b64_tr_b16 a[174:175], v12 offset:12800
    s_waitcnt lgkmcnt(8)
    v_mfma_f32_16x16x32_bf16 a[0:3], a[144:147], v[200:203], a[0:3]
    ds_read_b64_tr_b16 a[128:129], v5 offset:16384
    ds_read_b64_tr_b16 a[130:131], v5 offset:16896
    s_add_u32 m0, s11, 114688
    s_add_u32 s98, s74, 40960
    v_mfma_f32_16x16x32_bf16 a[16:19], a[144:147], v[204:207], a[16:19]
    s_mov_b32 exec_hi, 0xff
    buffer_load_dwordx4 v29, s[16:19], s98 offen offset:0 sc1 lds
    s_mov_b32 exec_hi, -1
    v_mfma_f32_16x16x32_bf16 a[4:7], a[148:151], v[200:203], a[4:7]
    ds_read_b64_tr_b16 a[132:133], v6 offset:16384
    v_mfma_f32_16x16x32_bf16 a[20:23], a[148:151], v[204:207], a[20:23]
    ds_read_b64_tr_b16 a[134:135], v6 offset:16896
    v_mfma_f32_16x16x32_bf16 a[32:35], a[152:155], v[200:203], a[32:35]
    ds_read_b64_tr_b16 a[136:137], v7 offset:16384
    ds_read_b64_tr_b16 a[138:139], v7 offset:16896
    s_add_u32 s21, s68, 51200
    v_mfma_f32_16x16x32_bf16 a[48:51], a[152:155], v[204:207], a[48:51]
    buffer_load_dwordx4 a[104:107], v31, s[16:19], s21 offen offset:0 sc1
    v_mfma_f32_16x16x32_bf16 a[36:39], a[156:159], v[200:203], a[36:39]
    ds_read_b64_tr_b16 a[140:141], v8 offset:16384
    v_mfma_f32_16x16x32_bf16 a[52:55], a[156:159], v[204:207], a[52:55]
    ds_read_b64_tr_b16 a[142:143], v8 offset:16896
    s_waitcnt lgkmcnt(8)
    v_mfma_f32_16x16x32_bf16 a[8:11], a[160:163], v[200:203], a[8:11]
    ds_read_b64_tr_b16 a[144:145], v5 offset:24576
    ds_read_b64_tr_b16 a[146:147], v5 offset:25088
    v_mfma_f32_16x16x32_bf16 a[24:27], a[160:163], v[204:207], a[24:27]
    buffer_load_dwordx4 a[108:111], v31, s[16:19], s21 offen offset:1024 sc1
    v_mfma_f32_16x16x32_bf16 a[12:15], a[164:167], v[200:203], a[12:15]
    ds_read_b64_tr_b16 a[148:149], v6 offset:24576
    v_mfma_f32_16x16x32_bf16 a[28:31], a[164:167], v[204:207], a[28:31]
    ds_read_b64_tr_b16 a[150:151], v6 offset:25088
    v_mfma_f32_16x16x32_bf16 a[40:43], a[168:171], v[200:203], a[40:43]
    ds_read_b64_tr_b16 a[152:153], v7 offset:24576
    ds_read_b64_tr_b16 a[154:155], v7 offset:25088
    s_add_u32 m0, s11, 115072
    v_mfma_f32_16x16x32_bf16 a[56:59], a[168:171], v[204:207], a[56:59]
    s_mov_b32 exec_hi, 0xff
    buffer_load_dwordx4 v29, s[16:19], s98 offen offset:256 sc1 lds
    s_mov_b32 exec_hi, -1
    v_mfma_f32_16x16x32_bf16 a[44:47], a[172:175], v[200:203], a[44:47]
    ds_read_b64_tr_b16 a[156:157], v8 offset:24576
    v_mfma_f32_16x16x32_bf16 a[60:63], a[172:175], v[204:207], a[60:63]
    ds_read_b64_tr_b16 a[158:159], v8 offset:25088
    s_waitcnt lgkmcnt(8)
    v_mfma_f32_16x16x32_bf16 a[0:3], a[128:131], v[208:211], a[0:3]
    ds_read_b64_tr_b16 a[160:161], v5 offset:20480
    ds_read_b64_tr_b16 a[162:163], v5 offset:20992
    v_mfma_f32_16x16x32_bf16 a[16:19], a[128:131], v[212:215], a[16:19]
    buffer_load_dwordx4 a[112:115], v31, s[16:19], s21 offen offset:2048 sc1
    v_mfma_f32_16x16x32_bf16 a[4:7], a[132:135], v[208:211], a[4:7]
    ds_read_b64_tr_b16 a[164:165], v6 offset:20480
    v_mfma_f32_16x16x32_bf16 a[20:23], a[132:135], v[212:215], a[20:23]
    ds_read_b64_tr_b16 a[166:167], v6 offset:20992
    v_mfma_f32_16x16x32_bf16 a[32:35], a[136:139], v[208:211], a[32:35]
    ds_read_b64_tr_b16 a[168:169], v7 offset:20480
    ds_read_b64_tr_b16 a[170:171], v7 offset:20992
    v_mfma_f32_16x16x32_bf16 a[48:51], a[136:139], v[212:215], a[48:51]
    buffer_load_dwordx4 a[116:119], v31, s[16:19], s21 offen offset:3072 sc1
    v_mfma_f32_16x16x32_bf16 a[36:39], a[140:143], v[208:211], a[36:39]
    ds_read_b64_tr_b16 a[172:173], v8 offset:20480
    v_mfma_f32_16x16x32_bf16 a[52:55], a[140:143], v[212:215], a[52:55]
    ds_read_b64_tr_b16 a[174:175], v8 offset:20992
    s_waitcnt lgkmcnt(8)
    v_mfma_f32_16x16x32_bf16 a[8:11], a[144:147], v[208:211], a[8:11]
    ds_read_b64_tr_b16 a[128:129], v5 offset:28672
    ds_read_b64_tr_b16 a[130:131], v5 offset:29184
    ds_read_b64_tr_b16 a[132:133], v6 offset:28672
    s_add_u32 m0, s11, 115456
    v_mfma_f32_16x16x32_bf16 a[24:27], a[144:147], v[212:215], a[24:27]
    s_mov_b32 exec_hi, 0xff
    buffer_load_dwordx4 v29, s[16:19], s98 offen offset:512 sc1 lds
    s_mov_b32 exec_hi, -1
    v_mfma_f32_16x16x32_bf16 a[12:15], a[148:151], v[208:211], a[12:15]
    ds_read_b64_tr_b16 a[134:135], v6 offset:29184
    v_mfma_f32_16x16x32_bf16 a[28:31], a[148:151], v[212:215], a[28:31]
    ds_read_b64_tr_b16 a[136:137], v7 offset:28672
    ds_read_b64_tr_b16 a[138:139], v7 offset:29184
    v_mfma_f32_16x16x32_bf16 a[40:43], a[152:155], v[208:211], a[40:43]
    ds_read_b64_tr_b16 a[140:141], v8 offset:28672
    ds_read_b64_tr_b16 a[142:143], v8 offset:29184
    s_add_u32 s21, s21, 4096
    v_mfma_f32_16x16x32_bf16 a[56:59], a[152:155], v[212:215], a[56:59]
    buffer_load_dwordx4 a[120:123], v31, s[16:19], s21 offen offset:0 sc1
    v_mfma_f32_16x16x32_bf16 a[44:47], a[156:159], v[208:211], a[44:47]
    v_mfma_f32_16x16x32_bf16 a[60:63], a[156:159], v[212:215], a[60:63]
    s_waitcnt vmcnt(26)
    s_barrier
    s_waitcnt lgkmcnt(8)
    v_mfma_f32_16x16x32_bf16 a[0:3], a[160:163], v[216:219], a[0:3]
    ds_read_b64_tr_b16 a[144:145], v5 offset:32768
    ds_read_b64_tr_b16 a[146:147], v5 offset:33280
    s_add_u32 s21, s68, 35840
    v_mfma_f32_16x16x32_bf16 a[16:19], a[160:163], v[220:223], a[16:19]
    buffer_load_dwordx4 v[176:179], v31, s[16:19], s21 offen offset:0 sc1
    v_mfma_f32_16x16x32_bf16 a[4:7], a[164:167], v[216:219], a[4:7]
    ds_read_b64_tr_b16 a[148:149], v6 offset:32768
    v_mfma_f32_16x16x32_bf16 a[20:23], a[164:167], v[220:223], a[20:23]
    ds_read_b64_tr_b16 a[150:151], v6 offset:33280
    v_mfma_f32_16x16x32_bf16 a[32:35], a[168:171], v[216:219], a[32:35]
    ds_read_b64_tr_b16 a[152:153], v7 offset:32768
    ds_read_b64_tr_b16 a[154:155], v7 offset:33280
    s_add_u32 m0, s11, 115840
    v_mfma_f32_16x16x32_bf16 a[48:51], a[168:171], v[220:223], a[48:51]
    s_mov_b32 exec_hi, 0xff
    buffer_load_dwordx4 v29, s[16:19], s98 offen offset:768 sc1 lds
    s_mov_b32 exec_hi, -1
    v_mfma_f32_16x16x32_bf16 a[36:39], a[172:175], v[216:219], a[36:39]
    ds_read_b64_tr_b16 a[156:157], v8 offset:32768
    v_mfma_f32_16x16x32_bf16 a[52:55], a[172:175], v[220:223], a[52:55]
    ds_read_b64_tr_b16 a[158:159], v8 offset:33280
    s_waitcnt lgkmcnt(8)
    v_mfma_f32_16x16x32_bf16 a[8:11], a[128:131], v[216:219], a[8:11]
    ds_read_b64_tr_b16 a[160:161], v5 offset:40960
    ds_read_b64_tr_b16 a[162:163], v5 offset:41472
    v_mfma_f32_16x16x32_bf16 a[24:27], a[128:131], v[220:223], a[24:27]
    buffer_load_dwordx4 v[180:183], v31, s[16:19], s21 offen offset:1024 sc1
    v_mfma_f32_16x16x32_bf16 a[12:15], a[132:135], v[216:219], a[12:15]
    ds_read_b64_tr_b16 a[164:165], v6 offset:40960
    v_mfma_f32_16x16x32_bf16 a[28:31], a[132:135], v[220:223], a[28:31]
    ds_read_b64_tr_b16 a[166:167], v6 offset:41472
    v_mfma_f32_16x16x32_bf16 a[40:43], a[136:139], v[216:219], a[40:43]
    ds_read_b64_tr_b16 a[168:169], v7 offset:40960
    ds_read_b64_tr_b16 a[170:171], v7 offset:41472
    buffer_load_dwordx4 v[184:187], v31, s[16:19], s21 offen offset:2048 sc1
    s_waitcnt vmcnt(16)
    v_mfma_f32_16x16x32_bf16 a[56:59], a[136:139], v[220:223], a[56:59]
    v_mov_b64 v[62:63], s[60:61]
    s_add_u32 s100, s62, 24576
    s_mov_b64 exec, 1
    buffer_store_dwordx2 v[62:63], off, s[16:19], s100 sc1
    s_mov_b64 exec, -1
    v_mfma_f32_16x16x32_bf16 a[44:47], a[140:143], v[216:219], a[44:47]
    ds_read_b64_tr_b16 a[172:173], v8 offset:40960
    v_mfma_f32_16x16x32_bf16 a[60:63], a[140:143], v[220:223], a[60:63]
    ds_read_b64_tr_b16 a[174:175], v8 offset:41472
    s_waitcnt lgkmcnt(8)
    v_mfma_f32_16x16x32_bf16 a[0:3], a[144:147], v[224:227], a[0:3]
    ds_read_b64_tr_b16 a[128:129], v5 offset:36864
    ds_read_b64_tr_b16 a[130:131], v5 offset:37376
    s_add_u32 m0, s11, 116224
    v_mfma_f32_16x16x32_bf16 a[16:19], a[144:147], v[228:231], a[16:19]
    s_mov_b32 exec_hi, 0xff
    buffer_load_dwordx4 v29, s[16:19], s98 offen offset:1024 sc1 lds
    s_mov_b32 exec_hi, -1
    v_mfma_f32_16x16x32_bf16 a[4:7], a[148:151], v[224:227], a[4:7]
    ds_read_b64_tr_b16 a[132:133], v6 offset:36864
    v_mfma_f32_16x16x32_bf16 a[20:23], a[148:151], v[228:231], a[20:23]
    ds_read_b64_tr_b16 a[134:135], v6 offset:37376
    v_mfma_f32_16x16x32_bf16 a[32:35], a[152:155], v[224:227], a[32:35]
    ds_read_b64_tr_b16 a[136:137], v7 offset:36864
    ds_read_b64_tr_b16 a[138:139], v7 offset:37376
    v_mfma_f32_16x16x32_bf16 a[48:51], a[152:155], v[228:231], a[48:51]
    buffer_load_dwordx4 v[188:191], v31, s[16:19], s21 offen offset:3072 sc1
    v_mfma_f32_16x16x32_bf16 a[36:39], a[156:159], v[224:227], a[36:39]
    ds_read_b64_tr_b16 a[140:141], v8 offset:36864
    v_mfma_f32_16x16x32_bf16 a[52:55], a[156:159], v[228:231], a[52:55]
    ds_read_b64_tr_b16 a[142:143], v8 offset:37376
    s_waitcnt lgkmcnt(8)
    v_mfma_f32_16x16x32_bf16 a[8:11], a[160:163], v[224:227], a[8:11]
    ds_read_b64_tr_b16 a[144:145], v5 offset:45056
    ds_read_b64_tr_b16 a[146:147], v5 offset:45568
    s_add_u32 s21, s21, 4096
    v_mfma_f32_16x16x32_bf16 a[24:27], a[160:163], v[228:231], a[24:27]
    buffer_load_dwordx4 v[192:195], v31, s[16:19], s21 offen offset:0 sc1
    v_mfma_f32_16x16x32_bf16 a[12:15], a[164:167], v[224:227], a[12:15]
    ds_read_b64_tr_b16 a[148:149], v6 offset:45056
    v_mfma_f32_16x16x32_bf16 a[28:31], a[164:167], v[228:231], a[28:31]
    ds_read_b64_tr_b16 a[150:151], v6 offset:45568
    v_mfma_f32_16x16x32_bf16 a[40:43], a[168:171], v[224:227], a[40:43]
    ds_read_b64_tr_b16 a[152:153], v7 offset:45056
    ds_read_b64_tr_b16 a[154:155], v7 offset:45568
    s_add_u32 m0, s11, 131072
    s_add_u32 s98, s74, 81920
    v_mfma_f32_16x16x32_bf16 a[56:59], a[168:171], v[228:231], a[56:59]
    s_mov_b32 exec_hi, 0xff
    buffer_load_dwordx4 v29, s[16:19], s98 offen offset:0 sc1 lds
    s_mov_b32 exec_hi, -1
    v_mfma_f32_16x16x32_bf16 a[44:47], a[172:175], v[224:227], a[44:47]
    ds_read_b64_tr_b16 a[156:157], v8 offset:45056
    v_mfma_f32_16x16x32_bf16 a[60:63], a[172:175], v[228:231], a[60:63]
    ds_read_b64_tr_b16 a[158:159], v8 offset:45568
    s_waitcnt lgkmcnt(8)
    v_mfma_f32_16x16x32_bf16 a[0:3], a[128:131], v[232:235], a[0:3]
    ds_read_b64_tr_b16 a[160:161], v5 offset:49152
    ds_read_b64_tr_b16 a[162:163], v5 offset:49664
    s_add_u32 m0, s11, 0
    s_add_u32 s99, s71, 0
    v_mfma_f32_16x16x32_bf16 a[16:19], a[128:131], v[236:239], a[16:19]
    buffer_load_dwordx4 v31, s[16:19], s99 offen offset:0 sc1 lds
    v_mfma_f32_16x16x32_bf16 a[4:7], a[132:135], v[232:235], a[4:7]
    ds_read_b64_tr_b16 a[164:165], v6 offset:49152
    v_mfma_f32_16x16x32_bf16 a[20:23], a[132:135], v[236:239], a[20:23]
    ds_read_b64_tr_b16 a[166:167], v6 offset:49664
    v_mfma_f32_16x16x32_bf16 a[32:35], a[136:139], v[232:235], a[32:35]
    ds_read_b64_tr_b16 a[168:169], v7 offset:49152
    ds_read_b64_tr_b16 a[170:171], v7 offset:49664
    v_mfma_f32_16x16x32_bf16 a[48:51], a[136:139], v[236:239], a[48:51]
    buffer_load_dwordx4 v31, s[16:19], s99 offen offset:1024 sc1 lds
    v_mfma_f32_16x16x32_bf16 a[36:39], a[140:143], v[232:235], a[36:39]
    ds_read_b64_tr_b16 a[172:173], v8 offset:49152
    v_mfma_f32_16x16x32_bf16 a[52:55], a[140:143], v[236:239], a[52:55]
    ds_read_b64_tr_b16 a[174:175], v8 offset:49664
    s_waitcnt lgkmcnt(8)
    v_mfma_f32_16x16x32_bf16 a[8:11], a[144:147], v[232:235], a[8:11]
    ds_read_b64_tr_b16 a[128:129], v5 offset:57344
    ds_read_b64_tr_b16 a[130:131], v5 offset:57856
    s_add_u32 m0, s11, 131456
    v_mfma_f32_16x16x32_bf16 a[24:27], a[144:147], v[236:239], a[24:27]
    s_mov_b32 exec_hi, 0xff
    buffer_load_dwordx4 v29, s[16:19], s98 offen offset:256 sc1 lds
    s_mov_b32 exec_hi, -1
    v_mfma_f32_16x16x32_bf16 a[12:15], a[148:151], v[232:235], a[12:15]
    ds_read_b64_tr_b16 a[132:133], v6 offset:57344
    v_mfma_f32_16x16x32_bf16 a[28:31], a[148:151], v[236:239], a[28:31]
    ds_read_b64_tr_b16 a[134:135], v6 offset:57856
    v_mfma_f32_16x16x32_bf16 a[40:43], a[152:155], v[232:235], a[40:43]
    ds_read_b64_tr_b16 a[136:137], v7 offset:57344
    ds_read_b64_tr_b16 a[138:139], v7 offset:57856
    s_add_u32 m0, s11, 0
    s_add_u32 s99, s71, 0
    v_mfma_f32_16x16x32_bf16 a[56:59], a[152:155], v[236:239], a[56:59]
    buffer_load_dwordx4 v31, s[16:19], s99 offen offset:2048 sc1 lds
    v_mfma_f32_16x16x32_bf16 a[44:47], a[156:159], v[232:235], a[44:47]
    ds_read_b64_tr_b16 a[140:141], v8 offset:57344
    v_mfma_f32_16x16x32_bf16 a[60:63], a[156:159], v[236:239], a[60:63]
    ds_read_b64_tr_b16 a[142:143], v8 offset:57856
    s_waitcnt lgkmcnt(8)
    v_mfma_f32_16x16x32_bf16 a[0:3], a[160:163], v[240:243], a[0:3]
    ds_read_b64_tr_b16 a[144:145], v5 offset:53248
    ds_read_b64_tr_b16 a[146:147], v5 offset:53760
    v_mfma_f32_16x16x32_bf16 a[16:19], a[160:163], v[244:247], a[16:19]
    buffer_load_dwordx4 v31, s[16:19], s99 offen offset:3072 sc1 lds
    v_mfma_f32_16x16x32_bf16 a[4:7], a[164:167], v[240:243], a[4:7]
    ds_read_b64_tr_b16 a[148:149], v6 offset:53248
    v_mfma_f32_16x16x32_bf16 a[20:23], a[164:167], v[244:247], a[20:23]
    ds_read_b64_tr_b16 a[150:151], v6 offset:53760
    v_mfma_f32_16x16x32_bf16 a[32:35], a[168:171], v[240:243], a[32:35]
    ds_read_b64_tr_b16 a[152:153], v7 offset:53248
    ds_read_b64_tr_b16 a[154:155], v7 offset:53760
    s_add_u32 m0, s11, 131840
    v_mfma_f32_16x16x32_bf16 a[48:51], a[168:171], v[244:247], a[48:51]
    s_mov_b32 exec_hi, 0xff
    buffer_load_dwordx4 v29, s[16:19], s98 offen offset:512 sc1 lds
    s_mov_b32 exec_hi, -1
    v_mfma_f32_16x16x32_bf16 a[36:39], a[172:175], v[240:243], a[36:39]
    ds_read_b64_tr_b16 a[156:157], v8 offset:53248
    v_mfma_f32_16x16x32_bf16 a[52:55], a[172:175], v[244:247], a[52:55]
    ds_read_b64_tr_b16 a[158:159], v8 offset:53760
    s_waitcnt lgkmcnt(8)
    v_mfma_f32_16x16x32_bf16 a[8:11], a[128:131], v[240:243], a[8:11]
    ds_read_b64_tr_b16 a[160:161], v5 offset:61440
    ds_read_b64_tr_b16 a[162:163], v5 offset:61952
    s_add_u32 m0, s11, 65536
    s_add_u32 s99, s71, 65536
    v_mfma_f32_16x16x32_bf16 a[24:27], a[128:131], v[244:247], a[24:27]
    buffer_load_dwordx4 v31, s[16:19], s99 offen offset:0 sc1 lds
    v_mfma_f32_16x16x32_bf16 a[12:15], a[132:135], v[240:243], a[12:15]
    ds_read_b64_tr_b16 a[164:165], v6 offset:61440
    v_mfma_f32_16x16x32_bf16 a[28:31], a[132:135], v[244:247], a[28:31]
    ds_read_b64_tr_b16 a[166:167], v6 offset:61952
    v_mfma_f32_16x16x32_bf16 a[40:43], a[136:139], v[240:243], a[40:43]
    ds_read_b64_tr_b16 a[168:169], v7 offset:61440
    ds_read_b64_tr_b16 a[170:171], v7 offset:61952
    v_mfma_f32_16x16x32_bf16 a[56:59], a[136:139], v[244:247], a[56:59]
    buffer_load_dwordx4 v31, s[16:19], s99 offen offset:1024 sc1 lds
    v_mfma_f32_16x16x32_bf16 a[44:47], a[140:143], v[240:243], a[44:47]
    ds_read_b64_tr_b16 a[172:173], v8 offset:61440
    v_mfma_f32_16x16x32_bf16 a[60:63], a[140:143], v[244:247], a[60:63]
    ds_read_b64_tr_b16 a[174:175], v8 offset:61952
    s_waitcnt lgkmcnt(8)
    v_mfma_f32_16x16x32_bf16 a[0:3], a[144:147], v[248:251], a[0:3]
    s_add_u32 m0, s11, 132224
    v_mfma_f32_16x16x32_bf16 a[16:19], a[144:147], v[252:255], a[16:19]
    s_mov_b32 exec_hi, 0xff
    buffer_load_dwordx4 v29, s[16:19], s98 offen offset:768 sc1 lds
    s_mov_b32 exec_hi, -1
    v_mfma_f32_16x16x32_bf16 a[4:7], a[148:151], v[248:251], a[4:7]
    v_mfma_f32_16x16x32_bf16 a[20:23], a[148:151], v[252:255], a[20:23]
    v_mfma_f32_16x16x32_bf16 a[32:35], a[152:155], v[248:251], a[32:35]
    s_add_u32 m0, s11, 65536
    s_add_u32 s99, s71, 65536
    v_mfma_f32_16x16x32_bf16 a[48:51], a[152:155], v[252:255], a[48:51]
    buffer_load_dwordx4 v31, s[16:19], s99 offen offset:2048 sc1 lds
    v_mfma_f32_16x16x32_bf16 a[36:39], a[156:159], v[248:251], a[36:39]
    v_mfma_f32_16x16x32_bf16 a[52:55], a[156:159], v[252:255], a[52:55]
    s_waitcnt lgkmcnt(0)
    v_mfma_f32_16x16x32_bf16 a[8:11], a[160:163], v[248:251], a[8:11]
    v_mfma_f32_16x16x32_bf16 a[24:27], a[160:163], v[252:255], a[24:27]
    buffer_load_dwordx4 v31, s[16:19], s99 offen offset:3072 sc1 lds
    v_mfma_f32_16x16x32_bf16 a[12:15], a[164:167], v[248:251], a[12:15]
    v_mfma_f32_16x16x32_bf16 a[28:31], a[164:167], v[252:255], a[28:31]
    v_mfma_f32_16x16x32_bf16 a[40:43], a[168:171], v[248:251], a[40:43]
    s_add_u32 m0, s11, 132608
    v_mfma_f32_16x16x32_bf16 a[56:59], a[168:171], v[252:255], a[56:59]
    s_mov_b32 exec_hi, 0xff
    buffer_load_dwordx4 v29, s[16:19], s98 offen offset:1024 sc1 lds
    s_mov_b32 exec_hi, -1
    v_mfma_f32_16x16x32_bf16 a[44:47], a[172:175], v[248:251], a[44:47]
    v_mfma_f32_16x16x32_bf16 a[60:63], a[172:175], v[252:255], a[60:63]
    s_nop 7
    v_accvgpr_read_b32 v32, a0
    v_accvgpr_read_b32 v33, a1
    v_accvgpr_read_b32 v34, a2
    v_accvgpr_read_b32 v35, a3
    v_accvgpr_read_b32 v36, a4
    v_accvgpr_read_b32 v37, a5
    v_accvgpr_read_b32 v38, a6
    v_accvgpr_read_b32 v39, a7
    v_pk_mul_f32 v[48:49], v[22:23], v[32:33] op_sel:[0,0] op_sel_hi:[0,1]
    v_pk_mul_f32 v[50:51], v[22:23], v[34:35] op_sel:[0,0] op_sel_hi:[0,1]
    v_pk_mul_f32 v[52:53], v[22:23], v[36:37] op_sel:[0,0] op_sel_hi:[0,1]
    v_pk_mul_f32 v[54:55], v[22:23], v[38:39] op_sel:[0,0] op_sel_hi:[0,1]
    v_exp_f32 v48, v48
    v_accvgpr_read_b32 v40, a8
    v_exp_f32 v49, v49
    s_add_u32 s21, s68, 56320
    buffer_load_dwordx4 a[128:131], v31, s[16:19], s21 offen offset:0 sc1
    v_accvgpr_read_b32 v41, a9
    v_exp_f32 v50, v50
    v_accvgpr_read_b32 v42, a10
    v_exp_f32 v51, v51
    v_accvgpr_read_b32 v43, a11
    v_exp_f32 v52, v52
    v_accvgpr_read_b32 v44, a12
    v_exp_f32 v53, v53
    v_accvgpr_read_b32 v45, a13
    v_exp_f32 v54, v54
    v_accvgpr_read_b32 v46, a14
    v_exp_f32 v55, v55
    v_accvgpr_read_b32 v47, a15
    v_pk_fma_f32 v[48:49], v[48:49], v[20:21], v[20:21] op_sel:[0,0,0] op_sel_hi:[1,0,0]
    buffer_load_dwordx4 a[132:135], v31, s[16:19], s21 offen offset:1024 sc1
    v_pk_fma_f32 v[50:51], v[50:51], v[20:21], v[20:21] op_sel:[0,0,0] op_sel_hi:[1,0,0]
    v_pk_fma_f32 v[52:53], v[52:53], v[20:21], v[20:21] op_sel:[0,0,0] op_sel_hi:[1,0,0]
    v_pk_fma_f32 v[54:55], v[54:55], v[20:21], v[20:21] op_sel:[0,0,0] op_sel_hi:[1,0,0]
    v_rcp_f32 v48, v48
    v_rcp_f32 v49, v49
    v_rcp_f32 v50, v50
    v_rcp_f32 v51, v51
    v_rcp_f32 v52, v52
    v_rcp_f32 v53, v53
    v_rcp_f32 v54, v54
    v_rcp_f32 v55, v55
    v_pk_mul_f32 v[32:33], v[32:33], v[40:41]
    v_pk_mul_f32 v[34:35], v[34:35], v[42:43]
    v_pk_mul_f32 v[36:37], v[36:37], v[44:45]
    buffer_load_dwordx4 a[136:139], v31, s[16:19], s21 offen offset:2048 sc1
    v_pk_mul_f32 v[38:39], v[38:39], v[46:47]
    v_pk_mul_f32 v[32:33], v[32:33], v[48:49]
    v_pk_mul_f32 v[34:35], v[34:35], v[50:51]
    v_pk_mul_f32 v[36:37], v[36:37], v[52:53]
    v_pk_mul_f32 v[38:39], v[38:39], v[54:55]
    v_cvt_pk_bf16_f32 v56, v32, v33
    v_cvt_pk_bf16_f32 v57, v34, v35
    v_cvt_pk_bf16_f32 v58, v36, v37
    v_cvt_pk_bf16_f32 v59, v38, v39
    buffer_store_dwordx4 v[56:59], v31, s[16:19], s47 offen offset:0 sc1
    v_accvgpr_read_b32 v64, a16
    v_accvgpr_read_b32 v65, a17
    v_accvgpr_read_b32 v66, a18
    v_accvgpr_read_b32 v67, a19
    buffer_load_dwordx4 a[140:143], v31, s[16:19], s21 offen offset:3072 sc1
    v_accvgpr_read_b32 v68, a20
    v_accvgpr_read_b32 v69, a21
    v_accvgpr_read_b32 v70, a22
    v_accvgpr_read_b32 v71, a23
    v_pk_mul_f32 v[80:81], v[22:23], v[64:65] op_sel:[1,0] op_sel_hi:[1,1]
    v_pk_mul_f32 v[82:83], v[22:23], v[66:67] op_sel:[1,0] op_sel_hi:[1,1]
    v_pk_mul_f32 v[84:85], v[22:23], v[68:69] op_sel:[1,0] op_sel_hi:[1,1]
    v_pk_mul_f32 v[86:87], v[22:23], v[70:71] op_sel:[1,0] op_sel_hi:[1,1]
    v_exp_f32 v80, v80
    v_accvgpr_read_b32 v72, a24
    v_exp_f32 v81, v81
    v_accvgpr_read_b32 v73, a25
    v_exp_f32 v82, v82
    v_accvgpr_read_b32 v74, a26
    s_add_u32 s21, s21, 4096
    buffer_load_dwordx4 a[144:147], v31, s[16:19], s21 offen offset:0 sc1
    v_exp_f32 v83, v83
    v_accvgpr_read_b32 v75, a27
    v_exp_f32 v84, v84
    v_accvgpr_read_b32 v76, a28
    v_exp_f32 v85, v85
    v_accvgpr_read_b32 v77, a29
    v_exp_f32 v86, v86
    v_accvgpr_read_b32 v78, a30
    v_exp_f32 v87, v87
    v_accvgpr_read_b32 v79, a31
    v_pk_fma_f32 v[80:81], v[80:81], v[20:21], v[20:21] op_sel:[0,1,1] op_sel_hi:[1,1,1]
    v_pk_fma_f32 v[82:83], v[82:83], v[20:21], v[20:21] op_sel:[0,1,1] op_sel_hi:[1,1,1]
    v_pk_fma_f32 v[84:85], v[84:85], v[20:21], v[20:21] op_sel:[0,1,1] op_sel_hi:[1,1,1]
    v_pk_fma_f32 v[86:87], v[86:87], v[20:21], v[20:21] op_sel:[0,1,1] op_sel_hi:[1,1,1]
    v_rcp_f32 v80, v80
    s_add_u32 s21, s69, 61440
    buffer_load_dwordx4 a[148:151], v31, s[16:19], s21 offen offset:0 sc1
    v_rcp_f32 v81, v81
    v_rcp_f32 v82, v82
    v_rcp_f32 v83, v83
    v_rcp_f32 v84, v84
    v_rcp_f32 v85, v85
    v_rcp_f32 v86, v86
    v_rcp_f32 v87, v87
    v_pk_mul_f32 v[64:65], v[64:65], v[72:73]
    v_pk_mul_f32 v[66:67], v[66:67], v[74:75]
    v_pk_mul_f32 v[68:69], v[68:69], v[76:77]
    v_pk_mul_f32 v[70:71], v[70:71], v[78:79]
    v_pk_mul_f32 v[64:65], v[64:65], v[80:81]
    v_pk_mul_f32 v[66:67], v[66:67], v[82:83]
    v_pk_mul_f32 v[68:69], v[68:69], v[84:85]
    buffer_load_dwordx4 a[152:155], v31, s[16:19], s21 offen offset:1024 sc1
    v_pk_mul_f32 v[70:71], v[70:71], v[86:87]
    v_cvt_pk_bf16_f32 v88, v64, v65
    v_cvt_pk_bf16_f32 v89, v66, v67
    v_cvt_pk_bf16_f32 v90, v68, v69
    v_cvt_pk_bf16_f32 v91, v70, v71
    buffer_store_dwordx4 v[88:91], v31, s[16:19], s47 offen offset:1024 sc1
    v_accvgpr_read_b32 v32, a32
    v_accvgpr_read_b32 v33, a33
    v_accvgpr_read_b32 v34, a34
    v_accvgpr_read_b32 v35, a35
    v_accvgpr_read_b32 v36, a36
    v_accvgpr_read_b32 v37, a37
    v_accvgpr_read_b32 v38, a38
    v_accvgpr_read_b32 v39, a39
    buffer_load_dwordx4 a[156:159], v31, s[16:19], s21 offen offset:2048 sc1
    v_pk_mul_f32 v[48:49], v[22:23], v[32:33] op_sel:[0,0] op_sel_hi:[0,1]
    v_pk_mul_f32 v[50:51], v[22:23], v[34:35] op_sel:[0,0] op_sel_hi:[0,1]
    v_pk_mul_f32 v[52:53], v[22:23], v[36:37] op_sel:[0,0] op_sel_hi:[0,1]
    v_pk_mul_f32 v[54:55], v[22:23], v[38:39] op_sel:[0,0] op_sel_hi:[0,1]
    v_exp_f32 v48, v48
    v_accvgpr_read_b32 v40, a40
    v_exp_f32 v49, v49
    v_accvgpr_read_b32 v41, a41
    v_exp_f32 v50, v50
    v_accvgpr_read_b32 v42, a42
    v_exp_f32 v51, v51
    v_accvgpr_read_b32 v43, a43
    v_exp_f32 v52, v52
    v_accvgpr_read_b32 v44, a44
    buffer_load_dwordx4 a[160:163], v31, s[16:19], s21 offen offset:3072 sc1
    v_exp_f32 v53, v53
    v_accvgpr_read_b32 v45, a45
    v_exp_f32 v54, v54
    v_accvgpr_read_b32 v46, a46
    v_exp_f32 v55, v55
    v_accvgpr_read_b32 v47, a47
    v_pk_fma_f32 v[48:49], v[48:49], v[20:21], v[20:21] op_sel:[0,0,0] op_sel_hi:[1,0,0]
    v_pk_fma_f32 v[50:51], v[50:51], v[20:21], v[20:21] op_sel:[0,0,0] op_sel_hi:[1,0,0]
    v_pk_fma_f32 v[52:53], v[52:53], v[20:21], v[20:21] op_sel:[0,0,0] op_sel_hi:[1,0,0]
    v_pk_fma_f32 v[54:55], v[54:55], v[20:21], v[20:21] op_sel:[0,0,0] op_sel_hi:[1,0,0]
    v_rcp_f32 v48, v48
    v_rcp_f32 v49, v49
    v_rcp_f32 v50, v50
    v_rcp_f32 v51, v51
    s_add_u32 s21, s21, 4096
    buffer_load_dwordx4 a[164:167], v31, s[16:19], s21 offen offset:0 sc1
    v_rcp_f32 v52, v52
    v_rcp_f32 v53, v53
    v_rcp_f32 v54, v54
    v_rcp_f32 v55, v55
    v_pk_mul_f32 v[32:33], v[32:33], v[40:41]
    v_pk_mul_f32 v[34:35], v[34:35], v[42:43]
    v_pk_mul_f32 v[36:37], v[36:37], v[44:45]
    v_pk_mul_f32 v[38:39], v[38:39], v[46:47]
    v_pk_mul_f32 v[32:33], v[32:33], v[48:49]
    v_pk_mul_f32 v[34:35], v[34:35], v[50:51]
    v_pk_mul_f32 v[36:37], v[36:37], v[52:53]
    v_pk_mul_f32 v[38:39], v[38:39], v[54:55]
    v_cvt_pk_bf16_f32 v56, v32, v33
    v_cvt_pk_bf16_f32 v57, v34, v35
    v_cvt_pk_bf16_f32 v58, v36, v37
    s_add_u32 m0, s11, 81920
    s_add_u32 s99, s71, 81920
    buffer_load_dwordx4 v31, s[16:19], s99 offen offset:0 sc1 lds
    v_cvt_pk_bf16_f32 v59, v38, v39
    s_add_u32 s47, s47, 4096
    buffer_store_dwordx4 v[56:59], v31, s[16:19], s47 offen offset:0 sc1
    v_accvgpr_read_b32 v64, a48
    v_accvgpr_read_b32 v65, a49
    v_accvgpr_read_b32 v66, a50
    v_accvgpr_read_b32 v67, a51
    v_accvgpr_read_b32 v68, a52
    v_accvgpr_read_b32 v69, a53
    v_accvgpr_read_b32 v70, a54
    v_accvgpr_read_b32 v71, a55
    v_pk_mul_f32 v[80:81], v[22:23], v[64:65] op_sel:[1,0] op_sel_hi:[1,1]
    v_pk_mul_f32 v[82:83], v[22:23], v[66:67] op_sel:[1,0] op_sel_hi:[1,1]
    v_pk_mul_f32 v[84:85], v[22:23], v[68:69] op_sel:[1,0] op_sel_hi:[1,1]
    buffer_load_dwordx4 v31, s[16:19], s99 offen offset:1024 sc1 lds
    v_pk_mul_f32 v[86:87], v[22:23], v[70:71] op_sel:[1,0] op_sel_hi:[1,1]
    v_exp_f32 v80, v80
    v_accvgpr_read_b32 v72, a56
    v_exp_f32 v81, v81
    v_accvgpr_read_b32 v73, a57
    v_exp_f32 v82, v82
    v_accvgpr_read_b32 v74, a58
    v_exp_f32 v83, v83
    v_accvgpr_read_b32 v75, a59
    v_exp_f32 v84, v84
    v_accvgpr_read_b32 v76, a60
    v_exp_f32 v85, v85
    v_accvgpr_read_b32 v77, a61
    v_exp_f32 v86, v86
    buffer_load_dwordx4 v31, s[16:19], s99 offen offset:2048 sc1 lds
    v_accvgpr_read_b32 v78, a62
    v_exp_f32 v87, v87
    v_accvgpr_read_b32 v79, a63
    v_pk_fma_f32 v[80:81], v[80:81], v[20:21], v[20:21] op_sel:[0,1,1] op_sel_hi:[1,1,1]
    v_pk_fma_f32 v[82:83], v[82:83], v[20:21], v[20:21] op_sel:[0,1,1] op_sel_hi:[1,1,1]
    v_pk_fma_f32 v[84:85], v[84:85], v[20:21], v[20:21] op_sel:[0,1,1] op_sel_hi:[1,1,1]
    v_pk_fma_f32 v[86:87], v[86:87], v[20:21], v[20:21] op_sel:[0,1,1] op_sel_hi:[1,1,1]
    v_rcp_f32 v80, v80
    v_rcp_f32 v81, v81
    v_rcp_f32 v82, v82
    v_rcp_f32 v83, v83
    v_rcp_f32 v84, v84
    v_rcp_f32 v85, v85
    v_rcp_f32 v86, v86
    buffer_load_dwordx4 v31, s[16:19], s99 offen offset:3072 sc1 lds
    v_rcp_f32 v87, v87
    v_pk_mul_f32 v[64:65], v[64:65], v[72:73]
    v_pk_mul_f32 v[66:67], v[66:67], v[74:75]
    v_pk_mul_f32 v[68:69], v[68:69], v[76:77]
    v_pk_mul_f32 v[70:71], v[70:71], v[78:79]
    v_pk_mul_f32 v[64:65], v[64:65], v[80:81]
    v_pk_mul_f32 v[66:67], v[66:67], v[82:83]
    v_pk_mul_f32 v[68:69], v[68:69], v[84:85]
    v_pk_mul_f32 v[70:71], v[70:71], v[86:87]
    v_cvt_pk_bf16_f32 v88, v64, v65
    v_cvt_pk_bf16_f32 v89, v66, v67
    v_cvt_pk_bf16_f32 v90, v68, v69
    v_cvt_pk_bf16_f32 v91, v70, v71
    buffer_store_dwordx4 v[88:91], v31, s[16:19], s47 offen offset:1024 sc1
    s_lshr_b32 s99, s11, 2
    s_add_u32 m0, s99, 98304
    s_sub_u32 s99, s71, s11
    s_add_u32 s99, s99, m0
    buffer_load_dwordx4 v31, s[16:19], s99 offen offset:0 sc1 lds
recurrent_scan__sliding_local_dilated__swiglu_ffn__prompt_kernel_join:
    s_add_u32 s100, s63, 24576
    buffer_load_dwordx2 v[22:23], v18, s[16:19], s100 offen offset:0
    s_lshr_b32 s92, s11, 2
    v_add_u32 v16, s92, v31
    v_add_u32 v17, 1024, v16
    v_and_b32 v17, 4095, v17
    v_add_u32 v19, 1024, v17
    v_and_b32 v19, 4095, v19
    v_add_u32 v24, 1024, v19
    v_and_b32 v24, 4095, v24
    s_barrier
    s_add_u32 s92, s11, 114688
    v_add_u32 v1, s92, v18
    v_add_u32 v2, 1920, v1
    s_mov_b32 s93, 0x3ea52b5c
    s_waitcnt vmcnt(20)
    ds_read2_b64 v[196:199], v1 offset0:16 offset1:14
    ds_read2_b64 v[200:203], v1 offset0:96 offset1:94
    ds_read2_b64 v[204:207], v1 offset0:176 offset1:174
    ds_read2_b64 v[208:211], v2 offset0:16 offset1:14
    ds_read2_b64 v[212:215], v2 offset0:96 offset1:94
    s_waitcnt lgkmcnt(0)
    v_dot2_f32_bf16 v4, v96, v196, 0
    v_dot2_f32_bf16 v5, v96, v198, 0
    ds_read2_b64 v[106:109], v1 offset0:12 offset1:10
    ds_read2_b64 v[110:113], v1 offset0:92 offset1:90
    ds_read2_b64 v[252:255], v1 offset0:172 offset1:170
    v_add_u32 v114, 0, v0
    v_mul_u32_u24 v115, 6554, v114
    v_lshrrev_b32 v115, 16, v115
    v_mul_u32_u24 v115, 1120, v115
    v_lshl_add_u32 v115, v114, 4, v115
    v_add_u32 v114, s75, v115
    v_accvgpr_write_b32 a60, v114
    s_mul_i32 s94, s8, 2560
    s_add_u32 m0, s94, 102400
    s_nop 0
    global_load_lds_dwordx4 v114, s[4:5]
    ds_read2_b64 v[12:15], v2 offset0:12 offset1:10
    ds_read2_b64 v[26:29], v2 offset0:92 offset1:90
    v_dot2c_f32_bf16 v4, v97, v197
    v_dot2c_f32_bf16 v5, v97, v199
    v_dot2c_f32_bf16 v4, v98, v200
    v_dot2c_f32_bf16 v5, v98, v202
    v_dot2c_f32_bf16 v4, v99, v201
    v_dot2c_f32_bf16 v5, v99, v203
    v_dot2c_f32_bf16 v4, v100, v204
    v_dot2c_f32_bf16 v5, v100, v206
    v_dot2c_f32_bf16 v4, v101, v205
    v_add_u32 v114, 64, v0
    v_mul_u32_u24 v115, 6554, v114
    v_lshrrev_b32 v115, 16, v115
    v_mul_u32_u24 v115, 1120, v115
    v_lshl_add_u32 v115, v114, 4, v115
    v_add_u32 v114, s75, v115
    v_accvgpr_write_b32 a61, v114
    s_mul_i32 s94, s8, 2560
    s_add_u32 m0, s94, 103424
    s_nop 0
    global_load_lds_dwordx4 v114, s[4:5]
    v_dot2c_f32_bf16 v5, v101, v207
    v_dot2c_f32_bf16 v4, v102, v208
    v_dot2c_f32_bf16 v5, v102, v210
    v_dot2c_f32_bf16 v4, v103, v209
    v_dot2c_f32_bf16 v5, v103, v211
    v_dot2c_f32_bf16 v4, v104, v212
    v_dot2c_f32_bf16 v5, v104, v214
    v_dot2c_f32_bf16 v4, v105, v213
    v_dot2c_f32_bf16 v5, v105, v215
    s_waitcnt lgkmcnt(0)
    v_add_u32 v114, 128, v0
    v_mul_u32_u24 v115, 6554, v114
    v_lshrrev_b32 v115, 16, v115
    v_mul_u32_u24 v115, 1120, v115
    v_lshl_add_u32 v115, v114, 4, v115
    v_add_u32 v114, s75, v115
    v_accvgpr_write_b32 a62, v114
    s_mul_i32 s94, s8, 2560
    s_add_u32 m0, s94, 104448
    s_mov_b32 exec_hi, 0
    global_load_lds_dwordx4 v114, s[4:5]
    s_mov_b32 exec_hi, -1
    v_dot2_f32_bf16 v6, v96, v106, 0
    v_dot2_f32_bf16 v7, v96, v108, 0
    ds_read2_b64 v[196:199], v1 offset0:8 offset1:6
    ds_read2_b64 v[200:203], v1 offset0:88 offset1:86
    ds_read2_b64 v[204:207], v1 offset0:168 offset1:166
    ds_read2_b64 v[208:211], v2 offset0:8 offset1:6
    ds_read2_b64 v[212:215], v2 offset0:88 offset1:86
    v_dot2c_f32_bf16 v6, v97, v107
    v_dot2c_f32_bf16 v7, v97, v109
    v_dot2c_f32_bf16 v6, v98, v110
    v_dot2c_f32_bf16 v7, v98, v112
    s_add_u32 m0, s11, 16384
    s_add_u32 s99, s71, 16384
    buffer_load_dwordx4 v31, s[16:19], s99 offen offset:0 sc1 lds
    v_dot2c_f32_bf16 v6, v99, v111
    v_dot2c_f32_bf16 v7, v99, v113
    v_dot2c_f32_bf16 v6, v100, v252
    v_dot2c_f32_bf16 v7, v100, v254
    v_dot2c_f32_bf16 v6, v101, v253
    v_dot2c_f32_bf16 v7, v101, v255
    v_dot2c_f32_bf16 v6, v102, v12
    v_dot2c_f32_bf16 v7, v102, v14
    v_dot2c_f32_bf16 v6, v103, v13
    v_dot2c_f32_bf16 v7, v103, v15
    buffer_load_dwordx4 v31, s[16:19], s99 offen offset:1024 sc1 lds
    v_dot2c_f32_bf16 v6, v104, v26
    v_dot2c_f32_bf16 v7, v104, v28
    v_dot2c_f32_bf16 v6, v105, v27
    v_dot2c_f32_bf16 v7, v105, v29
    s_waitcnt lgkmcnt(0)
    v_dot2_f32_bf16 v8, v96, v196, 0
    v_dot2_f32_bf16 v9, v96, v198, 0
    ds_read2_b64 v[106:109], v1 offset0:4 offset1:2
    ds_read2_b64 v[110:113], v1 offset0:84 offset1:82
    ds_read2_b64 v[252:255], v1 offset0:164 offset1:162
    ds_read2_b64 v[12:15], v2 offset0:4 offset1:2
    buffer_load_dwordx4 v31, s[16:19], s99 offen offset:2048 sc1 lds
    ds_read2_b64 v[26:29], v2 offset0:84 offset1:82
    v_dot2c_f32_bf16 v8, v97, v197
    v_dot2c_f32_bf16 v9, v97, v199
    v_dot2c_f32_bf16 v8, v98, v200
    v_dot2c_f32_bf16 v9, v98, v202
    v_dot2c_f32_bf16 v8, v99, v201
    v_dot2c_f32_bf16 v9, v99, v203
    v_dot2c_f32_bf16 v8, v100, v204
    v_dot2c_f32_bf16 v9, v100, v206
    v_dot2c_f32_bf16 v8, v101, v205
    buffer_load_dwordx4 v31, s[16:19], s99 offen offset:3072 sc1 lds
    v_dot2c_f32_bf16 v9, v101, v207
    v_dot2c_f32_bf16 v8, v102, v208
    v_dot2c_f32_bf16 v9, v102, v210
    v_dot2c_f32_bf16 v8, v103, v209
    v_dot2c_f32_bf16 v9, v103, v211
    v_dot2c_f32_bf16 v8, v104, v212
    v_dot2c_f32_bf16 v9, v104, v214
    v_dot2c_f32_bf16 v8, v105, v213
    v_dot2c_f32_bf16 v9, v105, v215
    s_waitcnt lgkmcnt(0)
    v_dot2_f32_bf16 v10, v96, v106, 0
    s_add_u32 m0, s11, 32768
    s_add_u32 s99, s71, 32768
    buffer_load_dwordx4 v31, s[16:19], s99 offen offset:0 sc1 lds
    v_dot2_f32_bf16 v11, v96, v108, 0
    v_add_u32 v1, 16384, v1
    v_add_u32 v2, 16384, v2
    ds_read2_b64 v[196:199], v1 offset0:16 offset1:14
    ds_read2_b64 v[200:203], v1 offset0:96 offset1:94
    ds_read2_b64 v[204:207], v1 offset0:176 offset1:174
    ds_read2_b64 v[208:211], v2 offset0:16 offset1:14
    ds_read2_b64 v[212:215], v2 offset0:96 offset1:94
    v_dot2c_f32_bf16 v10, v97, v107
    v_dot2c_f32_bf16 v11, v97, v109
    buffer_load_dwordx4 v31, s[16:19], s99 offen offset:1024 sc1 lds
    v_dot2c_f32_bf16 v10, v98, v110
    v_dot2c_f32_bf16 v11, v98, v112
    v_dot2c_f32_bf16 v10, v99, v111
    v_dot2c_f32_bf16 v11, v99, v113
    v_dot2c_f32_bf16 v10, v100, v252
    v_dot2c_f32_bf16 v11, v100, v254
    v_dot2c_f32_bf16 v10, v101, v253
    v_dot2c_f32_bf16 v11, v101, v255
    v_dot2c_f32_bf16 v10, v102, v12
    v_dot2c_f32_bf16 v11, v102, v14
    v_dot2c_f32_bf16 v10, v103, v13
    buffer_load_dwordx4 v31, s[16:19], s99 offen offset:2048 sc1 lds
    v_dot2c_f32_bf16 v11, v103, v15
    v_dot2c_f32_bf16 v10, v104, v26
    v_dot2c_f32_bf16 v11, v104, v28
    v_dot2c_f32_bf16 v10, v105, v27
    v_dot2c_f32_bf16 v11, v105, v29
    s_cmp_lg_u32 s9, 0
    s_cbranch_scc1 am_8
    v_mov_b32 v236, 0xce6e6b28
    v_cmp_gt_u32 vcc, 2, v0
    s_nop 1
    v_cndmask_b32 v5, v5, v236, vcc
    v_cmp_gt_u32 vcc, 4, v0
    s_nop 1
    v_cndmask_b32 v6, v6, v236, vcc
    v_cmp_gt_u32 vcc, 6, v0
    s_nop 1
    v_cndmask_b32 v7, v7, v236, vcc
    v_cmp_gt_u32 vcc, 8, v0
    s_nop 1
    v_cndmask_b32 v8, v8, v236, vcc
    v_cmp_gt_u32 vcc, 10, v0
    s_nop 1
    v_cndmask_b32 v9, v9, v236, vcc
    v_cmp_gt_u32 vcc, 12, v0
    s_nop 1
    v_cndmask_b32 v10, v10, v236, vcc
    v_cmp_gt_u32 vcc, 14, v0
    s_nop 1
    v_cndmask_b32 v11, v11, v236, vcc
    am_8:
    v_max3_f32 v236, v4, v5, v6
    v_max3_f32 v236, v236, v7, v8
    v_max3_f32 v236, v236, v9, v10
    v_max_f32 v236, v236, v11
    buffer_load_dwordx4 v31, s[16:19], s99 offen offset:3072 sc1 lds
    v_mul_f32 v236, s93, v236
    v_fma_f32 v4, v4, s93, -v236
    v_fma_f32 v5, v5, s93, -v236
    v_fma_f32 v6, v6, s93, -v236
    v_fma_f32 v7, v7, s93, -v236
    v_fma_f32 v8, v8, s93, -v236
    v_fma_f32 v9, v9, s93, -v236
    v_fma_f32 v10, v10, s93, -v236
    v_fma_f32 v11, v11, s93, -v236
    v_exp_f32 v4, v4
    v_exp_f32 v5, v5
    s_add_u32 m0, s11, 49152
    s_add_u32 s99, s71, 49152
    buffer_load_dwordx4 v31, s[16:19], s99 offen offset:0 sc1 lds
    v_exp_f32 v6, v6
    v_exp_f32 v7, v7
    v_exp_f32 v8, v8
    v_exp_f32 v9, v9
    v_exp_f32 v10, v10
    v_exp_f32 v11, v11
    v_pk_add_f32 v[236:237], v[4:5], v[6:7]
    v_pk_add_f32 v[238:239], v[8:9], v[10:11]
    v_pk_add_f32 v[236:237], v[236:237], v[238:239]
    v_add_f32 v236, v236, v237
    s_waitcnt vmcnt(14)
    v_mov_b64 v[20:21], s[60:61]
    s_add_u32 s100, s62, 32768
    s_mov_b64 exec, 1
    buffer_store_dwordx2 v[20:21], off, s[16:19], s100 sc1
    s_mov_b64 exec, -1
    v_rcp_f32 v236, v236
    s_nop 0
    v_pk_mul_f32 v[4:5], v[4:5], v[236:237] op_sel_hi:[1,0]
    v_pk_mul_f32 v[6:7], v[6:7], v[236:237] op_sel_hi:[1,0]
    v_pk_mul_f32 v[8:9], v[8:9], v[236:237] op_sel_hi:[1,0]
    v_pk_mul_f32 v[10:11], v[10:11], v[236:237] op_sel_hi:[1,0]
    v_cvt_pk_bf16_f32 v236, v4, 0
    v_cvt_pk_bf16_f32 v237, 0, v4
    v_cvt_pk_bf16_f32 v238, v5, 0
    v_cvt_pk_bf16_f32 v239, 0, v5
    v_cvt_pk_bf16_f32 v240, v6, 0
    v_cvt_pk_bf16_f32 v241, 0, v6
    buffer_load_dwordx4 v31, s[16:19], s99 offen offset:1024 sc1 lds
    v_cvt_pk_bf16_f32 v242, v7, 0
    v_cvt_pk_bf16_f32 v243, 0, v7
    v_cvt_pk_bf16_f32 v244, v8, 0
    v_cvt_pk_bf16_f32 v245, 0, v8
    v_cvt_pk_bf16_f32 v246, v9, 0
    v_cvt_pk_bf16_f32 v247, 0, v9
    v_cvt_pk_bf16_f32 v248, v10, 0
    v_cvt_pk_bf16_f32 v249, 0, v10
    v_cvt_pk_bf16_f32 v250, v11, 0
    v_cvt_pk_bf16_f32 v251, 0, v11
    buffer_load_dwordx4 v31, s[16:19], s99 offen offset:2048 sc1 lds
    s_waitcnt lgkmcnt(0)
    ds_read2_b64 v[106:109], v1 offset0:12 offset1:10
    ds_read2_b64 v[110:113], v1 offset0:92 offset1:90
    ds_read2_b64 v[252:255], v1 offset0:172 offset1:170
    ds_read2_b64 v[12:15], v2 offset0:12 offset1:10
    ds_read2_b64 v[26:29], v2 offset0:92 offset1:90
    v_dot2_f32_bf16 v216, v196, v236, 0
    v_dot2_f32_bf16 v217, v196, v237, 0
    v_dot2_f32_bf16 v218, v197, v236, 0
    v_dot2_f32_bf16 v219, v197, v237, 0
    v_dot2_f32_bf16 v220, v200, v236, 0
    buffer_load_dwordx4 v31, s[16:19], s99 offen offset:3072 sc1 lds
    v_dot2_f32_bf16 v221, v200, v237, 0
    v_dot2_f32_bf16 v222, v201, v236, 0
    v_dot2_f32_bf16 v223, v201, v237, 0
    v_dot2_f32_bf16 v224, v204, v236, 0
    v_dot2_f32_bf16 v225, v204, v237, 0
    v_dot2_f32_bf16 v226, v205, v236, 0
    v_dot2_f32_bf16 v227, v205, v237, 0
    v_dot2_f32_bf16 v228, v208, v236, 0
    v_dot2_f32_bf16 v229, v208, v237, 0
    v_dot2_f32_bf16 v230, v209, v236, 0
    s_waitcnt vmcnt(16)
    v_cmp_ne_u64 vcc, s[60:61], v[22:23]
    s_nop 0
    s_cmp_lg_u64 vcc, 0
    s_cbranch_scc1 fc_9_slow
fc_9_ok:
    v_dot2_f32_bf16 v231, v209, v237, 0
    v_dot2_f32_bf16 v232, v212, v236, 0
    v_dot2_f32_bf16 v233, v212, v237, 0
    v_dot2_f32_bf16 v234, v213, v236, 0
    v_dot2_f32_bf16 v235, v213, v237, 0
    v_dot2c_f32_bf16 v216, v198, v238
    v_dot2c_f32_bf16 v217, v198, v239
    v_dot2c_f32_bf16 v218, v199, v238
    v_dot2c_f32_bf16 v219, v199, v239
    v_dot2c_f32_bf16 v220, v202, v238
    v_dot2c_f32_bf16 v221, v202, v239
    s_add_u32 s20, s66, 0
    buffer_load_dwordx4 v[32:35], v16, s[16:19], s20 offen sc1
    v_dot2c_f32_bf16 v222, v203, v238
    v_dot2c_f32_bf16 v223, v203, v239
    v_dot2c_f32_bf16 v224, v206, v238
    v_dot2c_f32_bf16 v225, v206, v239
    v_dot2c_f32_bf16 v226, v207, v238
    v_dot2c_f32_bf16 v227, v207, v239
    v_dot2c_f32_bf16 v228, v210, v238
    v_dot2c_f32_bf16 v229, v210, v239
    v_dot2c_f32_bf16 v230, v211, v238
    v_dot2c_f32_bf16 v231, v211, v239
    buffer_load_dwordx4 v[36:39], v17, s[16:19], s20 offen sc1
    v_dot2c_f32_bf16 v232, v214, v238
    v_dot2c_f32_bf16 v233, v214, v239
    v_dot2c_f32_bf16 v234, v215, v238
    v_dot2c_f32_bf16 v235, v215, v239
    s_waitcnt lgkmcnt(0)
    ds_read2_b64 v[196:199], v1 offset0:8 offset1:6
    ds_read2_b64 v[200:203], v1 offset0:88 offset1:86
    ds_read2_b64 v[204:207], v1 offset0:168 offset1:166
    ds_read2_b64 v[208:211], v2 offset0:8 offset1:6
    ds_read2_b64 v[212:215], v2 offset0:88 offset1:86
    v_dot2c_f32_bf16 v216, v106, v240
    buffer_load_dwordx4 v[40:43], v19, s[16:19], s20 offen sc1
    v_dot2c_f32_bf16 v217, v106, v241
    v_dot2c_f32_bf16 v218, v107, v240
    v_dot2c_f32_bf16 v219, v107, v241
    v_dot2c_f32_bf16 v220, v110, v240
    v_dot2c_f32_bf16 v221, v110, v241
    v_dot2c_f32_bf16 v222, v111, v240
    v_dot2c_f32_bf16 v223, v111, v241
    v_dot2c_f32_bf16 v224, v252, v240
    v_dot2c_f32_bf16 v225, v252, v241
    v_dot2c_f32_bf16 v226, v253, v240
    buffer_load_dwordx4 v[44:47], v24, s[16:19], s20 offen sc1
    v_dot2c_f32_bf16 v227, v253, v241
    v_dot2c_f32_bf16 v228, v12, v240
    v_dot2c_f32_bf16 v229, v12, v241
    v_dot2c_f32_bf16 v230, v13, v240
    v_dot2c_f32_bf16 v231, v13, v241
    v_dot2c_f32_bf16 v232, v26, v240
    v_dot2c_f32_bf16 v233, v26, v241
    v_dot2c_f32_bf16 v234, v27, v240
    v_dot2c_f32_bf16 v235, v27, v241
    v_dot2c_f32_bf16 v216, v108, v242
    v_dot2c_f32_bf16 v217, v108, v243
    s_add_u32 s20, s66, 4096
    buffer_load_dwordx4 v[48:51], v16, s[16:19], s20 offen sc1
    v_dot2c_f32_bf16 v218, v109, v242
    v_dot2c_f32_bf16 v219, v109, v243
    v_dot2c_f32_bf16 v220, v112, v242
    v_dot2c_f32_bf16 v221, v112, v243
    v_dot2c_f32_bf16 v222, v113, v242
    v_dot2c_f32_bf16 v223, v113, v243
    v_dot2c_f32_bf16 v224, v254, v242
    v_dot2c_f32_bf16 v225, v254, v243
    v_dot2c_f32_bf16 v226, v255, v242
    v_dot2c_f32_bf16 v227, v255, v243
    buffer_load_dwordx4 v[52:55], v17, s[16:19], s20 offen sc1
    v_dot2c_f32_bf16 v228, v14, v242
    v_dot2c_f32_bf16 v229, v14, v243
    v_dot2c_f32_bf16 v230, v15, v242
    v_dot2c_f32_bf16 v231, v15, v243
    v_dot2c_f32_bf16 v232, v28, v242
    v_dot2c_f32_bf16 v233, v28, v243
    v_dot2c_f32_bf16 v234, v29, v242
    v_dot2c_f32_bf16 v235, v29, v243
    s_waitcnt lgkmcnt(0)
    ds_read2_b64 v[106:109], v1 offset0:4 offset1:2
    ds_read2_b64 v[110:113], v1 offset0:84 offset1:82
    buffer_load_dwordx4 v[56:59], v19, s[16:19], s20 offen sc1
    ds_read2_b64 v[252:255], v1 offset0:164 offset1:162
    ds_read2_b64 v[12:15], v2 offset0:4 offset1:2
    ds_read2_b64 v[26:29], v2 offset0:84 offset1:82
    v_dot2c_f32_bf16 v216, v196, v244
    v_dot2c_f32_bf16 v217, v196, v245
    v_dot2c_f32_bf16 v218, v197, v244
    v_dot2c_f32_bf16 v219, v197, v245
    v_dot2c_f32_bf16 v220, v200, v244
    v_dot2c_f32_bf16 v221, v200, v245
    v_dot2c_f32_bf16 v222, v201, v244
    buffer_load_dwordx4 v[60:63], v24, s[16:19], s20 offen sc1
    v_dot2c_f32_bf16 v223, v201, v245
    v_dot2c_f32_bf16 v224, v204, v244
    v_dot2c_f32_bf16 v225, v204, v245
    v_dot2c_f32_bf16 v226, v205, v244
    v_dot2c_f32_bf16 v227, v205, v245
    v_dot2c_f32_bf16 v228, v208, v244
    v_dot2c_f32_bf16 v229, v208, v245
    v_dot2c_f32_bf16 v230, v209, v244
    v_dot2c_f32_bf16 v231, v209, v245
    v_dot2c_f32_bf16 v232, v212, v244
    v_dot2c_f32_bf16 v233, v212, v245
    s_add_u32 s20, s66, 8192
    buffer_load_dwordx4 v[64:67], v16, s[16:19], s20 offen sc1
    v_dot2c_f32_bf16 v234, v213, v244
    v_dot2c_f32_bf16 v235, v213, v245
    v_dot2c_f32_bf16 v216, v198, v246
    v_dot2c_f32_bf16 v217, v198, v247
    v_dot2c_f32_bf16 v218, v199, v246
    v_dot2c_f32_bf16 v219, v199, v247
    v_dot2c_f32_bf16 v220, v202, v246
    v_dot2c_f32_bf16 v221, v202, v247
    v_dot2c_f32_bf16 v222, v203, v246
    v_dot2c_f32_bf16 v223, v203, v247
    buffer_load_dwordx4 v[68:71], v17, s[16:19], s20 offen sc1
    v_dot2c_f32_bf16 v224, v206, v246
    v_dot2c_f32_bf16 v225, v206, v247
    v_dot2c_f32_bf16 v226, v207, v246
    v_dot2c_f32_bf16 v227, v207, v247
    v_dot2c_f32_bf16 v228, v210, v246
    v_dot2c_f32_bf16 v229, v210, v247
    v_dot2c_f32_bf16 v230, v211, v246
    v_dot2c_f32_bf16 v231, v211, v247
    v_dot2c_f32_bf16 v232, v214, v246
    v_dot2c_f32_bf16 v233, v214, v247
    v_dot2c_f32_bf16 v234, v215, v246
    buffer_load_dwordx4 v[72:75], v19, s[16:19], s20 offen sc1
    v_dot2c_f32_bf16 v235, v215, v247
    s_waitcnt lgkmcnt(0)
    v_dot2c_f32_bf16 v216, v106, v248
    v_dot2c_f32_bf16 v217, v106, v249
    v_dot2c_f32_bf16 v218, v107, v248
    v_dot2c_f32_bf16 v219, v107, v249
    v_dot2c_f32_bf16 v220, v110, v248
    v_dot2c_f32_bf16 v221, v110, v249
    v_dot2c_f32_bf16 v222, v111, v248
    v_dot2c_f32_bf16 v223, v111, v249
    buffer_load_dwordx4 v[76:79], v24, s[16:19], s20 offen sc1
    v_dot2c_f32_bf16 v224, v252, v248
    v_dot2c_f32_bf16 v225, v252, v249
    v_dot2c_f32_bf16 v226, v253, v248
    v_dot2c_f32_bf16 v227, v253, v249
    v_dot2c_f32_bf16 v228, v12, v248
    v_dot2c_f32_bf16 v229, v12, v249
    v_dot2c_f32_bf16 v230, v13, v248
    v_dot2c_f32_bf16 v231, v13, v249
    v_dot2c_f32_bf16 v232, v26, v248
    v_dot2c_f32_bf16 v233, v26, v249
    v_dot2c_f32_bf16 v234, v27, v248
    s_add_u32 s20, s66, 12288
    buffer_load_dwordx4 v[80:83], v16, s[16:19], s20 offen sc1
    v_dot2c_f32_bf16 v235, v27, v249
    v_dot2c_f32_bf16 v216, v108, v250
    v_dot2c_f32_bf16 v217, v108, v251
    v_dot2c_f32_bf16 v218, v109, v250
    v_dot2c_f32_bf16 v219, v109, v251
    v_dot2c_f32_bf16 v220, v112, v250
    v_dot2c_f32_bf16 v221, v112, v251
    v_dot2c_f32_bf16 v222, v113, v250
    v_dot2c_f32_bf16 v223, v113, v251
    v_dot2c_f32_bf16 v224, v254, v250
    buffer_load_dwordx4 v[84:87], v17, s[16:19], s20 offen sc1
    v_dot2c_f32_bf16 v225, v254, v251
    v_dot2c_f32_bf16 v226, v255, v250
    v_dot2c_f32_bf16 v227, v255, v251
    v_dot2c_f32_bf16 v228, v14, v250
    v_dot2c_f32_bf16 v229, v14, v251
    v_dot2c_f32_bf16 v230, v15, v250
    v_dot2c_f32_bf16 v231, v15, v251
    v_dot2c_f32_bf16 v232, v28, v250
    v_dot2c_f32_bf16 v233, v28, v251
    v_dot2c_f32_bf16 v234, v29, v250
    v_dot2c_f32_bf16 v235, v29, v251
    buffer_load_dwordx4 v[88:91], v19, s[16:19], s20 offen sc1
    s_mul_i32 s92, s8, 2560
    s_add_u32 s92, s92, 147456
    v_add_u32 v1, s92, v18
    s_mul_i32 s92, s8, 3
    s_and_b32 s92, s92, 13
    s_min_u32 s92, s92, 5
    s_lshl_b32 s92, s92, 9
    s_add_u32 s92, s92, 147456
    v_add_u32 v2, s92, v18
    v_lshrrev_b32 v3, 4, v0
    v_mul_u32_u24 v3, 20224, v3
    v_add_u32 v3, v3, v31
    v_cvt_pk_bf16_f32 v96, v216, v217
    v_cvt_pk_bf16_f32 v97, v218, v219
    ds_write_b64 v1, v[96:97] offset:0
    v_cvt_pk_bf16_f32 v98, v220, v221
    v_cvt_pk_bf16_f32 v99, v222, v223
    buffer_load_dwordx4 v[92:95], v24, s[16:19], s20 offen sc1
    ds_write_b64 v1, v[98:99] offset:512
    v_cvt_pk_bf16_f32 v100, v224, v225
    v_cvt_pk_bf16_f32 v101, v226, v227
    ds_write_b64 v1, v[100:101] offset:1024
    v_cvt_pk_bf16_f32 v102, v228, v229
    v_cvt_pk_bf16_f32 v103, v230, v231
    ds_write_b64 v1, v[102:103] offset:1536
    v_cvt_pk_bf16_f32 v104, v232, v233
    v_cvt_pk_bf16_f32 v105, v234, v235
    ds_write_b64 v1, v[104:105] offset:2048
    s_waitcnt vmcnt(16)
    s_waitcnt lgkmcnt(0)
    s_barrier
    ds_read2st64_b64 v[4:7], v2 offset0:0 offset1:2
    ds_read2st64_b64 v[8:11], v2 offset0:8 offset1:10
    ds_read2st64_b64 v[12:15], v2 offset0:16 offset1:18
    s_waitcnt vmcnt(12)
    v_mfma_f32_16x16x32_bf16 v[236:239], a[176:179], v[32:35], 0
    v_mfma_f32_16x16x32_bf16 v[240:243], a[180:183], v[32:35], 0
    v_mfma_f32_16x16x32_bf16 v[244:247], a[184:187], v[32:35], 0
    v_mfma_f32_16x16x32_bf16 v[248:251], a[188:191], v[32:35], 0
    s_waitcnt lgkmcnt(2)
    buffer_store_dwordx4 v[4:7], v3, s[16:19], s72 offen offset:0 sc1
    v_mfma_f32_16x16x32_bf16 v[252:255], a[192:195], v[32:35], 0
    v_mfma_f32_16x16x32_bf16 a[0:3], a[176:179], v[36:39], 0
    v_mfma_f32_16x16x32_bf16 a[4:7], a[180:183], v[36:39], 0
    v_mfma_f32_16x16x32_bf16 a[8:11], a[184:187], v[36:39], 0
    s_waitcnt lgkmcnt(1)
    buffer_store_dwordx4 v[8:11], v3, s[16:19], s72 offen offset:1024 sc1
    v_mfma_f32_16x16x32_bf16 a[12:15], a[188:191], v[36:39], 0
    v_mfma_f32_16x16x32_bf16 a[16:19], a[192:195], v[36:39], 0
    v_mfma_f32_16x16x32_bf16 a[20:23], a[176:179], v[40:43], 0
    v_mfma_f32_16x16x32_bf16 a[24:27], a[180:183], v[40:43], 0
    s_waitcnt lgkmcnt(0)
    buffer_store_dwordx4 v[12:15], v3, s[16:19], s73 offen offset:2048 sc1
    v_mfma_f32_16x16x32_bf16 a[28:31], a[184:187], v[40:43], 0
    v_mfma_f32_16x16x32_bf16 a[32:35], a[188:191], v[40:43], 0
    v_mfma_f32_16x16x32_bf16 a[36:39], a[192:195], v[40:43], 0
    v_mfma_f32_16x16x32_bf16 a[40:43], a[176:179], v[44:47], 0
    s_add_u32 s20, s66, 16384
    buffer_load_dwordx4 v[196:199], v16, s[16:19], s20 offen sc1
    v_mfma_f32_16x16x32_bf16 a[44:47], a[180:183], v[44:47], 0
    v_mfma_f32_16x16x32_bf16 a[48:51], a[184:187], v[44:47], 0
    v_mfma_f32_16x16x32_bf16 a[52:55], a[188:191], v[44:47], 0
    v_mfma_f32_16x16x32_bf16 a[56:59], a[192:195], v[44:47], 0
    buffer_load_dwordx4 v[200:203], v17, s[16:19], s20 offen sc1
    s_waitcnt vmcnt(13)
    v_mfma_f32_16x16x32_bf16 v[236:239], a[196:199], v[48:51], v[236:239]
    v_mfma_f32_16x16x32_bf16 v[240:243], a[200:203], v[48:51], v[240:243]
    v_mfma_f32_16x16x32_bf16 v[244:247], a[204:207], v[48:51], v[244:247]
    v_mfma_f32_16x16x32_bf16 v[248:251], a[208:211], v[48:51], v[248:251]
    buffer_load_dwordx4 v[204:207], v19, s[16:19], s20 offen sc1
    v_mfma_f32_16x16x32_bf16 v[252:255], a[212:215], v[48:51], v[252:255]
    v_mfma_f32_16x16x32_bf16 a[0:3], a[196:199], v[52:55], a[0:3]
    v_mfma_f32_16x16x32_bf16 a[4:7], a[200:203], v[52:55], a[4:7]
    v_mfma_f32_16x16x32_bf16 a[8:11], a[204:207], v[52:55], a[8:11]
    buffer_load_dwordx4 v[208:211], v24, s[16:19], s20 offen sc1
    v_mfma_f32_16x16x32_bf16 a[12:15], a[208:211], v[52:55], a[12:15]
    v_mfma_f32_16x16x32_bf16 a[16:19], a[212:215], v[52:55], a[16:19]
    v_mfma_f32_16x16x32_bf16 a[20:23], a[196:199], v[56:59], a[20:23]
    v_mfma_f32_16x16x32_bf16 a[24:27], a[200:203], v[56:59], a[24:27]
    s_add_u32 s20, s66, 20480
    buffer_load_dwordx4 v[216:219], v16, s[16:19], s20 offen sc1
    v_mfma_f32_16x16x32_bf16 a[28:31], a[204:207], v[56:59], a[28:31]
    v_mfma_f32_16x16x32_bf16 a[32:35], a[208:211], v[56:59], a[32:35]
    v_mfma_f32_16x16x32_bf16 a[36:39], a[212:215], v[56:59], a[36:39]
    v_mfma_f32_16x16x32_bf16 a[40:43], a[196:199], v[60:63], a[40:43]
    buffer_load_dwordx4 v[220:223], v17, s[16:19], s20 offen sc1
    v_mfma_f32_16x16x32_bf16 a[44:47], a[200:203], v[60:63], a[44:47]
    v_mfma_f32_16x16x32_bf16 a[48:51], a[204:207], v[60:63], a[48:51]
    v_mfma_f32_16x16x32_bf16 a[52:55], a[208:211], v[60:63], a[52:55]
    v_mfma_f32_16x16x32_bf16 a[56:59], a[212:215], v[60:63], a[56:59]
    buffer_load_dwordx4 v[224:227], v19, s[16:19], s20 offen sc1
    s_waitcnt vmcnt(14)
    v_mfma_f32_16x16x32_bf16 v[236:239], a[216:219], v[64:67], v[236:239]
    v_mfma_f32_16x16x32_bf16 v[240:243], a[220:223], v[64:67], v[240:243]
    s_add_u32 s100, s63, 32768
    buffer_load_dwordx2 v[22:23], v18, s[16:19], s100 offen offset:0
    v_mfma_f32_16x16x32_bf16 v[244:247], a[224:227], v[64:67], v[244:247]
    v_mfma_f32_16x16x32_bf16 v[248:251], a[228:231], v[64:67], v[248:251]
    v_and_b32 v1, 15, v0
    v_mfma_f32_16x16x32_bf16 v[252:255], a[232:235], v[64:67], v[252:255]
    v_mfma_f32_16x16x32_bf16 a[0:3], a[216:219], v[68:71], a[0:3]
    v_mul_u32_u24 v2, 160, v1
    v_mfma_f32_16x16x32_bf16 a[4:7], a[220:223], v[68:71], a[4:7]
    v_mfma_f32_16x16x32_bf16 a[8:11], a[224:227], v[68:71], a[8:11]
    v_lshrrev_b32 v1, 4, v0
    v_mfma_f32_16x16x32_bf16 a[12:15], a[228:231], v[68:71], a[12:15]
    v_mfma_f32_16x16x32_bf16 a[16:19], a[232:235], v[68:71], a[16:19]
    v_lshl_add_u32 v2, v1, 3, v2
    v_mfma_f32_16x16x32_bf16 a[20:23], a[216:219], v[72:75], a[20:23]
    s_add_u32 s94, s94, 102400
    v_mfma_f32_16x16x32_bf16 a[24:27], a[220:223], v[72:75], a[24:27]
    v_mfma_f32_16x16x32_bf16 a[28:31], a[224:227], v[72:75], a[28:31]
    v_add_u32 v1, s94, v2
    v_mfma_f32_16x16x32_bf16 a[32:35], a[228:231], v[72:75], a[32:35]
    v_mfma_f32_16x16x32_bf16 a[36:39], a[232:235], v[72:75], a[36:39]
    buffer_load_dwordx4 v[228:231], v24, s[16:19], s20 offen sc1
    v_mfma_f32_16x16x32_bf16 a[40:43], a[216:219], v[76:79], a[40:43]
    v_mfma_f32_16x16x32_bf16 a[44:47], a[220:223], v[76:79], a[44:47]
    s_add_u32 s20, s66, 24576
    buffer_load_dwordx4 v[32:35], v16, s[16:19], s20 offen sc1
    v_mfma_f32_16x16x32_bf16 a[48:51], a[224:227], v[76:79], a[48:51]
    v_mfma_f32_16x16x32_bf16 a[52:55], a[228:231], v[76:79], a[52:55]
    buffer_load_dwordx4 v[36:39], v17, s[16:19], s20 offen sc1
    v_mfma_f32_16x16x32_bf16 a[56:59], a[232:235], v[76:79], a[56:59]
    buffer_load_dwordx4 v[40:43], v19, s[16:19], s20 offen sc1
    s_waitcnt vmcnt(15)
    v_mfma_f32_16x16x32_bf16 v[236:239], a[236:239], v[80:83], v[236:239]
    v_mfma_f32_16x16x32_bf16 v[240:243], a[240:243], v[80:83], v[240:243]
    v_mfma_f32_16x16x32_bf16 v[244:247], a[244:247], v[80:83], v[244:247]
    s_waitcnt vmcnt(12)
    ds_read_b64 v[4:5], v1 offset:0
    ds_read_b64 v[6:7], v1 offset:32
    ds_read_b64 v[8:9], v1 offset:64
    ds_read_b64 v[10:11], v1 offset:96
    ds_read_b64 v[12:13], v1 offset:128
    v_mfma_f32_16x16x32_bf16 v[248:251], a[248:251], v[80:83], v[248:251]
    v_mfma_f32_16x16x32_bf16 v[252:255], a[252:255], v[80:83], v[252:255]
    v_mfma_f32_16x16x32_bf16 a[0:3], a[236:239], v[84:87], a[0:3]
    buffer_load_dwordx4 v[44:47], v24, s[16:19], s20 offen sc1
    v_mfma_f32_16x16x32_bf16 a[4:7], a[240:243], v[84:87], a[4:7]
    v_mfma_f32_16x16x32_bf16 a[8:11], a[244:247], v[84:87], a[8:11]
    v_mfma_f32_16x16x32_bf16 a[12:15], a[248:251], v[84:87], a[12:15]
    s_add_u32 s20, s66, 28672
    buffer_load_dwordx4 v[48:51], v16, s[16:19], s20 offen sc1
    v_mfma_f32_16x16x32_bf16 a[16:19], a[252:255], v[84:87], a[16:19]
    v_mfma_f32_16x16x32_bf16 a[20:23], a[236:239], v[88:91], a[20:23]
    v_mfma_f32_16x16x32_bf16 a[24:27], a[240:243], v[88:91], a[24:27]
    buffer_load_dwordx4 v[52:55], v17, s[16:19], s20 offen sc1
    v_mfma_f32_16x16x32_bf16 a[28:31], a[244:247], v[88:91], a[28:31]
    v_mfma_f32_16x16x32_bf16 a[32:35], a[248:251], v[88:91], a[32:35]
    v_mfma_f32_16x16x32_bf16 a[36:39], a[252:255], v[88:91], a[36:39]
    buffer_load_dwordx4 v[56:59], v19, s[16:19], s20 offen sc1
    v_mfma_f32_16x16x32_bf16 a[40:43], a[236:239], v[92:95], a[40:43]
    v_mfma_f32_16x16x32_bf16 a[44:47], a[240:243], v[92:95], a[44:47]
    v_mfma_f32_16x16x32_bf16 a[48:51], a[244:247], v[92:95], a[48:51]
    v_mov_b32 v14, v2
    v_mfma_f32_16x16x32_bf16 a[52:55], a[248:251], v[92:95], a[52:55]
    v_mfma_f32_16x16x32_bf16 a[56:59], a[252:255], v[92:95], a[56:59]
    s_waitcnt lgkmcnt(0)
    v_mov_b64 v[20:21], s[60:61]
    s_add_u32 s100, s62, 40960
    s_mov_b64 exec, 1
    buffer_store_dwordx2 v[20:21], off, s[16:19], s100 sc1
    s_mov_b64 exec, -1
    s_waitcnt vmcnt(13)
    s_waitcnt vmcnt(9)
    v_cmp_ne_u64 vcc, s[60:61], v[22:23]
    s_nop 0
    s_cmp_lg_u64 vcc, 0
    s_cbranch_scc1 fc_10_slow
fc_10_ok:
    v_mfma_f32_16x16x32_bf16 v[236:239], v[116:119], v[196:199], v[236:239]
    v_mfma_f32_16x16x32_bf16 v[240:243], v[120:123], v[196:199], v[240:243]
    v_mfma_f32_16x16x32_bf16 v[244:247], v[124:127], v[196:199], v[244:247]
    buffer_load_dwordx4 v[60:63], v24, s[16:19], s20 offen sc1
    v_mfma_f32_16x16x32_bf16 v[248:251], v[128:131], v[196:199], v[248:251]
    v_mfma_f32_16x16x32_bf16 v[252:255], v[132:135], v[196:199], v[252:255]
    s_add_u32 s20, s66, 32768
    buffer_load_dwordx4 v[64:67], v16, s[16:19], s20 offen sc1
    v_mfma_f32_16x16x32_bf16 a[0:3], v[116:119], v[200:203], a[0:3]
    v_mfma_f32_16x16x32_bf16 a[4:7], v[120:123], v[200:203], a[4:7]
    v_mfma_f32_16x16x32_bf16 a[8:11], v[124:127], v[200:203], a[8:11]
    buffer_load_dwordx4 v[68:71], v17, s[16:19], s20 offen sc1
    v_mfma_f32_16x16x32_bf16 a[12:15], v[128:131], v[200:203], a[12:15]
    v_mfma_f32_16x16x32_bf16 a[16:19], v[132:135], v[200:203], a[16:19]
    buffer_load_dwordx4 v[72:75], v19, s[16:19], s20 offen sc1
    v_mfma_f32_16x16x32_bf16 a[20:23], v[116:119], v[204:207], a[20:23]
    v_mfma_f32_16x16x32_bf16 a[24:27], v[120:123], v[204:207], a[24:27]
    v_mfma_f32_16x16x32_bf16 a[28:31], v[124:127], v[204:207], a[28:31]
    buffer_load_dwordx4 v[76:79], v24, s[16:19], s20 offen sc1
    v_mfma_f32_16x16x32_bf16 a[32:35], v[128:131], v[204:207], a[32:35]
    v_mfma_f32_16x16x32_bf16 a[36:39], v[132:135], v[204:207], a[36:39]
    v_accvgpr_read_b32 v1, a60
    v_mfma_f32_16x16x32_bf16 a[40:43], v[116:119], v[208:211], a[40:43]
    v_mfma_f32_16x16x32_bf16 a[44:47], v[120:123], v[208:211], a[44:47]
    v_mfma_f32_16x16x32_bf16 a[48:51], v[124:127], v[208:211], a[48:51]
    v_accvgpr_read_b32 v2, a61
    v_mfma_f32_16x16x32_bf16 a[52:55], v[128:131], v[208:211], a[52:55]
    v_mfma_f32_16x16x32_bf16 a[56:59], v[132:135], v[208:211], a[56:59]
    v_accvgpr_read_b32 v29, a62
    s_waitcnt vmcnt(13)
    v_mfma_f32_16x16x32_bf16 v[236:239], v[136:139], v[216:219], v[236:239]
    v_mfma_f32_16x16x32_bf16 v[240:243], v[140:143], v[216:219], v[240:243]
    v_mfma_f32_16x16x32_bf16 v[244:247], v[144:147], v[216:219], v[244:247]
    s_add_u32 s20, s66, 36864
    buffer_load_dwordx4 v[80:83], v16, s[16:19], s20 offen sc1
    v_mfma_f32_16x16x32_bf16 v[248:251], v[148:151], v[216:219], v[248:251]
    v_mfma_f32_16x16x32_bf16 v[252:255], v[152:155], v[216:219], v[252:255]
    buffer_load_dwordx4 v[84:87], v17, s[16:19], s20 offen sc1
    v_mfma_f32_16x16x32_bf16 a[0:3], v[136:139], v[220:223], a[0:3]
    v_mfma_f32_16x16x32_bf16 a[4:7], v[140:143], v[220:223], a[4:7]
    v_mfma_f32_16x16x32_bf16 a[8:11], v[144:147], v[220:223], a[8:11]
    buffer_load_dwordx4 v[88:91], v19, s[16:19], s20 offen sc1
    v_mfma_f32_16x16x32_bf16 a[12:15], v[148:151], v[220:223], a[12:15]
    v_mfma_f32_16x16x32_bf16 a[16:19], v[152:155], v[220:223], a[16:19]
    buffer_load_dwordx4 v[92:95], v24, s[16:19], s20 offen sc1
    v_mfma_f32_16x16x32_bf16 a[20:23], v[136:139], v[224:227], a[20:23]
    v_mfma_f32_16x16x32_bf16 a[24:27], v[140:143], v[224:227], a[24:27]
    v_mfma_f32_16x16x32_bf16 a[28:31], v[144:147], v[224:227], a[28:31]
    s_add_u32 s20, s66, 40960
    buffer_load_dwordx4 v[196:199], v16, s[16:19], s20 offen sc1
    v_mfma_f32_16x16x32_bf16 a[32:35], v[148:151], v[224:227], a[32:35]
    v_mfma_f32_16x16x32_bf16 a[36:39], v[152:155], v[224:227], a[36:39]
    v_add_u32 v15, 61440, v31
    v_mfma_f32_16x16x32_bf16 a[40:43], v[136:139], v[228:231], a[40:43]
    v_mfma_f32_16x16x32_bf16 a[44:47], v[140:143], v[228:231], a[44:47]
    v_mfma_f32_16x16x32_bf16 a[48:51], v[144:147], v[228:231], a[48:51]
    s_mov_b32 s92, 0xbfb8aa3b
    v_mfma_f32_16x16x32_bf16 a[52:55], v[148:151], v[228:231], a[52:55]
    v_mfma_f32_16x16x32_bf16 a[56:59], v[152:155], v[228:231], a[56:59]
    s_mov_b32 s93, 0xffff0000
    s_waitcnt vmcnt(14)
    v_mfma_f32_16x16x32_bf16 v[236:239], v[156:159], v[32:35], v[236:239]
    buffer_load_dwordx4 v[200:203], v17, s[16:19], s20 offen sc1
    v_mfma_f32_16x16x32_bf16 v[240:243], v[160:163], v[32:35], v[240:243]
    buffer_load_dwordx4 v[204:207], v19, s[16:19], s20 offen sc1
    v_mfma_f32_16x16x32_bf16 v[244:247], v[164:167], v[32:35], v[244:247]
    buffer_load_dwordx4 v[208:211], v24, s[16:19], s20 offen sc1
    v_mfma_f32_16x16x32_bf16 v[248:251], v[168:171], v[32:35], v[248:251]
    s_add_u32 s21, s69, 66560
    buffer_load_dwordx4 v[96:99], v31, s[16:19], s21 offen offset:0 sc1
    v_mfma_f32_16x16x32_bf16 v[252:255], v[172:175], v[32:35], v[252:255]
    buffer_load_dwordx4 v[100:103], v31, s[16:19], s21 offen offset:1024 sc1
    v_mfma_f32_16x16x32_bf16 a[0:3], v[156:159], v[36:39], a[0:3]
    v_lshrrev_b32 v3, 10, v16
    v_mfma_f32_16x16x32_bf16 a[4:7], v[160:163], v[36:39], a[4:7]
    v_mul_u32_u24 v3, 15360, v3
    v_mfma_f32_16x16x32_bf16 a[8:11], v[164:167], v[36:39], a[8:11]
    v_add_u32 v3, 102400, v3
    v_mfma_f32_16x16x32_bf16 a[12:15], v[168:171], v[36:39], a[12:15]
    v_add_u32 v28, v3, v31
    v_mfma_f32_16x16x32_bf16 a[16:19], v[172:175], v[36:39], a[16:19]
    v_lshrrev_b32 v3, 10, v17
    v_mfma_f32_16x16x32_bf16 a[20:23], v[156:159], v[40:43], a[20:23]
    v_mul_u32_u24 v3, 15360, v3
    v_mfma_f32_16x16x32_bf16 a[24:27], v[160:163], v[40:43], a[24:27]
    v_add_u32 v3, 102400, v3
    v_mfma_f32_16x16x32_bf16 a[28:31], v[164:167], v[40:43], a[28:31]
    v_add_u32 v25, v3, v31
    v_mfma_f32_16x16x32_bf16 a[32:35], v[168:171], v[40:43], a[32:35]
    v_lshrrev_b32 v3, 10, v19
    v_mfma_f32_16x16x32_bf16 a[36:39], v[172:175], v[40:43], a[36:39]
    v_mul_u32_u24 v3, 15360, v3
    v_mfma_f32_16x16x32_bf16 a[40:43], v[156:159], v[44:47], a[40:43]
    v_add_u32 v3, 107520, v3
    v_mfma_f32_16x16x32_bf16 a[44:47], v[160:163], v[44:47], a[44:47]
    v_add_u32 v26, v3, v31
    v_mfma_f32_16x16x32_bf16 a[48:51], v[164:167], v[44:47], a[48:51]
    v_lshrrev_b32 v3, 10, v24
    v_mfma_f32_16x16x32_bf16 a[52:55], v[168:171], v[44:47], a[52:55]
    v_mul_u32_u24 v3, 15360, v3
    v_mfma_f32_16x16x32_bf16 a[56:59], v[172:175], v[44:47], a[56:59]
    v_add_u32 v3, 112640, v3
    v_add_u32 v27, v3, v31
    s_waitcnt vmcnt(14)
    v_mfma_f32_16x16x32_bf16 v[236:239], v[176:179], v[48:51], v[236:239]
    v_mfma_f32_16x16x32_bf16 v[240:243], v[180:183], v[48:51], v[240:243]
    v_mfma_f32_16x16x32_bf16 v[244:247], v[184:187], v[48:51], v[244:247]
    v_mfma_f32_16x16x32_bf16 v[248:251], v[188:191], v[48:51], v[248:251]
    s_add_u32 s20, s66, 45056
    buffer_load_dwordx4 v[32:35], v16, s[16:19], s20 offen sc1
    v_mfma_f32_16x16x32_bf16 v[252:255], v[192:195], v[48:51], v[252:255]
    v_mfma_f32_16x16x32_bf16 a[0:3], v[176:179], v[52:55], a[0:3]
    v_mfma_f32_16x16x32_bf16 a[4:7], v[180:183], v[52:55], a[4:7]
    v_mfma_f32_16x16x32_bf16 a[8:11], v[184:187], v[52:55], a[8:11]
    buffer_load_dwordx4 v[36:39], v17, s[16:19], s20 offen sc1
    v_mfma_f32_16x16x32_bf16 a[12:15], v[188:191], v[52:55], a[12:15]
    v_mfma_f32_16x16x32_bf16 a[16:19], v[192:195], v[52:55], a[16:19]
    v_mfma_f32_16x16x32_bf16 a[20:23], v[176:179], v[56:59], a[20:23]
    v_mfma_f32_16x16x32_bf16 a[24:27], v[180:183], v[56:59], a[24:27]
    buffer_load_dwordx4 v[40:43], v19, s[16:19], s20 offen sc1
    v_mfma_f32_16x16x32_bf16 a[28:31], v[184:187], v[56:59], a[28:31]
    v_mfma_f32_16x16x32_bf16 a[32:35], v[188:191], v[56:59], a[32:35]
    v_mfma_f32_16x16x32_bf16 a[36:39], v[192:195], v[56:59], a[36:39]
    v_mfma_f32_16x16x32_bf16 a[40:43], v[176:179], v[60:63], a[40:43]
    buffer_load_dwordx4 v[44:47], v24, s[16:19], s20 offen sc1
    v_mfma_f32_16x16x32_bf16 a[44:47], v[180:183], v[60:63], a[44:47]
    v_mfma_f32_16x16x32_bf16 a[48:51], v[184:187], v[60:63], a[48:51]
    v_mfma_f32_16x16x32_bf16 a[52:55], v[188:191], v[60:63], a[52:55]
    v_mfma_f32_16x16x32_bf16 a[56:59], v[192:195], v[60:63], a[56:59]
    buffer_load_dwordx4 v[104:107], v31, s[16:19], s21 offen offset:2048 sc1
    s_waitcnt vmcnt(15)
    v_mfma_f32_16x16x32_bf16 v[236:239], a[64:67], v[64:67], v[236:239]
    v_mfma_f32_16x16x32_bf16 v[240:243], a[68:71], v[64:67], v[240:243]
    v_mfma_f32_16x16x32_bf16 v[244:247], a[72:75], v[64:67], v[244:247]
    v_mfma_f32_16x16x32_bf16 v[248:251], a[76:79], v[64:67], v[248:251]
    s_add_u32 s100, s63, 40960
    buffer_load_dwordx2 v[22:23], v18, s[16:19], s100 offen offset:0
    v_mfma_f32_16x16x32_bf16 v[252:255], a[80:83], v[64:67], v[252:255]
    v_mfma_f32_16x16x32_bf16 a[0:3], a[64:67], v[68:71], a[0:3]
    v_mfma_f32_16x16x32_bf16 a[4:7], a[68:71], v[68:71], a[4:7]
    v_mfma_f32_16x16x32_bf16 a[8:11], a[72:75], v[68:71], a[8:11]
    s_add_u32 s20, s67, 49152
    buffer_load_dwordx4 v[48:51], v16, s[16:19], s20 offen sc1
    v_mfma_f32_16x16x32_bf16 a[12:15], a[76:79], v[68:71], a[12:15]
    v_mfma_f32_16x16x32_bf16 a[16:19], a[80:83], v[68:71], a[16:19]
    v_mfma_f32_16x16x32_bf16 a[20:23], a[64:67], v[72:75], a[20:23]
    v_mfma_f32_16x16x32_bf16 a[24:27], a[68:71], v[72:75], a[24:27]
    buffer_load_dwordx4 v[52:55], v17, s[16:19], s20 offen sc1
    v_mfma_f32_16x16x32_bf16 a[28:31], a[72:75], v[72:75], a[28:31]
    v_mfma_f32_16x16x32_bf16 a[32:35], a[76:79], v[72:75], a[32:35]
    v_mfma_f32_16x16x32_bf16 a[36:39], a[80:83], v[72:75], a[36:39]
    v_mfma_f32_16x16x32_bf16 a[40:43], a[64:67], v[76:79], a[40:43]
    buffer_load_dwordx4 v[56:59], v19, s[16:19], s20 offen sc1
    v_mfma_f32_16x16x32_bf16 a[44:47], a[68:71], v[76:79], a[44:47]
    v_mfma_f32_16x16x32_bf16 a[48:51], a[72:75], v[76:79], a[48:51]
    v_mfma_f32_16x16x32_bf16 a[52:55], a[76:79], v[76:79], a[52:55]
    v_mfma_f32_16x16x32_bf16 a[56:59], a[80:83], v[76:79], a[56:59]
    buffer_load_dwordx4 v[60:63], v24, s[16:19], s20 offen sc1
    s_waitcnt vmcnt(16)
    v_mfma_f32_16x16x32_bf16 v[236:239], a[84:87], v[80:83], v[236:239]
    v_mfma_f32_16x16x32_bf16 v[240:243], a[88:91], v[80:83], v[240:243]
    v_mfma_f32_16x16x32_bf16 v[244:247], a[92:95], v[80:83], v[244:247]
    v_mfma_f32_16x16x32_bf16 v[248:251], a[96:99], v[80:83], v[248:251]
    s_add_u32 s20, s67, 53248
    buffer_load_dwordx4 v[64:67], v16, s[16:19], s20 offen sc1
    v_mfma_f32_16x16x32_bf16 v[252:255], a[100:103], v[80:83], v[252:255]
    v_mfma_f32_16x16x32_bf16 a[0:3], a[84:87], v[84:87], a[0:3]
    v_mfma_f32_16x16x32_bf16 a[4:7], a[88:91], v[84:87], a[4:7]
    v_mfma_f32_16x16x32_bf16 a[8:11], a[92:95], v[84:87], a[8:11]
    buffer_load_dwordx4 v[68:71], v17, s[16:19], s20 offen sc1
    v_mfma_f32_16x16x32_bf16 a[12:15], a[96:99], v[84:87], a[12:15]
    v_mfma_f32_16x16x32_bf16 a[16:19], a[100:103], v[84:87], a[16:19]
    v_mfma_f32_16x16x32_bf16 a[20:23], a[84:87], v[88:91], a[20:23]
    v_mfma_f32_16x16x32_bf16 a[24:27], a[88:91], v[88:91], a[24:27]
    buffer_load_dwordx4 v[72:75], v19, s[16:19], s20 offen sc1
    v_mfma_f32_16x16x32_bf16 a[28:31], a[92:95], v[88:91], a[28:31]
    v_mfma_f32_16x16x32_bf16 a[32:35], a[96:99], v[88:91], a[32:35]
    v_mfma_f32_16x16x32_bf16 a[36:39], a[100:103], v[88:91], a[36:39]
    v_mfma_f32_16x16x32_bf16 a[40:43], a[84:87], v[92:95], a[40:43]
    buffer_load_dwordx4 v[76:79], v24, s[16:19], s20 offen sc1
    v_mfma_f32_16x16x32_bf16 a[44:47], a[88:91], v[92:95], a[44:47]
    v_mfma_f32_16x16x32_bf16 a[48:51], a[92:95], v[92:95], a[48:51]
    v_mfma_f32_16x16x32_bf16 a[52:55], a[96:99], v[92:95], a[52:55]
    v_mfma_f32_16x16x32_bf16 a[56:59], a[100:103], v[92:95], a[56:59]
    buffer_load_dwordx4 v[108:111], v31, s[16:19], s21 offen offset:3072 sc1
    s_waitcnt vmcnt(17)
    s_waitcnt vmcnt(9)
    v_cmp_ne_u64 vcc, s[60:61], v[22:23]
    s_nop 0
    s_or_b32 s100, vcc_lo, vcc_hi
    s_and_b32 s100, s100, s10
    s_cbranch_scc1 fc_11_slow
fc_11_ok:
    v_mfma_f32_16x16x32_bf16 v[236:239], a[104:107], v[196:199], v[236:239]
    v_mfma_f32_16x16x32_bf16 v[240:243], a[108:111], v[196:199], v[240:243]
    v_mfma_f32_16x16x32_bf16 v[244:247], a[112:115], v[196:199], v[244:247]
    v_mfma_f32_16x16x32_bf16 v[248:251], a[116:119], v[196:199], v[248:251]
    s_add_u32 s21, s21, 4096
    buffer_load_dwordx4 v[112:115], v31, s[16:19], s21 offen offset:0 sc1
    v_mfma_f32_16x16x32_bf16 v[252:255], a[120:123], v[196:199], v[252:255]
    v_mfma_f32_16x16x32_bf16 a[0:3], a[104:107], v[200:203], a[0:3]
    v_mfma_f32_16x16x32_bf16 a[4:7], a[108:111], v[200:203], a[4:7]
    v_mfma_f32_16x16x32_bf16 a[8:11], a[112:115], v[200:203], a[8:11]
    s_add_u32 s21, s70, 0
    buffer_load_dwordx4 a[176:179], v31, s[16:19], s21 offen offset:0 sc1
    v_mfma_f32_16x16x32_bf16 a[12:15], a[116:119], v[200:203], a[12:15]
    v_mfma_f32_16x16x32_bf16 a[16:19], a[120:123], v[200:203], a[16:19]
    v_mfma_f32_16x16x32_bf16 a[20:23], a[104:107], v[204:207], a[20:23]
    v_mfma_f32_16x16x32_bf16 a[24:27], a[108:111], v[204:207], a[24:27]
    buffer_load_dwordx4 a[180:183], v31, s[16:19], s21 offen offset:1024 sc1
    v_mfma_f32_16x16x32_bf16 a[28:31], a[112:115], v[204:207], a[28:31]
    v_mfma_f32_16x16x32_bf16 a[32:35], a[116:119], v[204:207], a[32:35]
    v_mfma_f32_16x16x32_bf16 a[36:39], a[120:123], v[204:207], a[36:39]
    v_mfma_f32_16x16x32_bf16 a[40:43], a[104:107], v[208:211], a[40:43]
    buffer_load_dwordx4 a[184:187], v31, s[16:19], s21 offen offset:2048 sc1
    v_mfma_f32_16x16x32_bf16 a[44:47], a[108:111], v[208:211], a[44:47]
    v_mfma_f32_16x16x32_bf16 a[48:51], a[112:115], v[208:211], a[48:51]
    v_mfma_f32_16x16x32_bf16 a[52:55], a[116:119], v[208:211], a[52:55]
    v_mfma_f32_16x16x32_bf16 a[56:59], a[120:123], v[208:211], a[56:59]
    buffer_load_dwordx4 a[188:191], v31, s[16:19], s21 offen offset:3072 sc1
    s_waitcnt vmcnt(16)
    v_mfma_f32_16x16x32_bf16 a[0:3], a[128:131], v[36:39], a[0:3]
    v_mfma_f32_16x16x32_bf16 a[4:7], a[132:135], v[36:39], a[4:7]
    s_add_u32 s21, s70, 4096
    buffer_load_dwordx4 a[192:195], v31, s[16:19], s21 offen offset:0 sc1
    v_mfma_f32_16x16x32_bf16 a[8:11], a[136:139], v[36:39], a[8:11]
    ds_read_b128 v[116:119], v31 offset:0
    v_mfma_f32_16x16x32_bf16 a[12:15], a[140:143], v[36:39], a[12:15]
    ds_read_b128 v[120:123], v31 offset:1024
    v_mfma_f32_16x16x32_bf16 a[16:19], a[144:147], v[36:39], a[16:19]
    ds_read_b128 v[124:127], v31 offset:2048
    s_waitcnt vmcnt(11)
    v_mfma_f32_16x16x32_bf16 a[0:3], a[148:151], v[52:55], a[0:3]
    buffer_load_dwordx4 a[196:199], v31, s[16:19], s21 offen offset:1024 sc1
    v_mfma_f32_16x16x32_bf16 a[4:7], a[152:155], v[52:55], a[4:7]
    ds_read_b128 v[128:131], v31 offset:3072
    v_mfma_f32_16x16x32_bf16 a[8:11], a[156:159], v[52:55], a[8:11]
    ds_read_b128 v[132:135], v31 offset:4096
    v_mfma_f32_16x16x32_bf16 a[12:15], a[160:163], v[52:55], a[12:15]
    ds_read_b128 v[136:139], v31 offset:5120
    v_mfma_f32_16x16x32_bf16 a[16:19], a[164:167], v[52:55], a[16:19]
    ds_read_b128 v[140:143], v31 offset:6144
    s_waitcnt vmcnt(6)
    v_mfma_f32_16x16x32_bf16 a[0:3], v[96:99], v[68:71], a[0:3]
    buffer_load_dwordx4 a[200:203], v31, s[16:19], s21 offen offset:2048 sc1
    v_mfma_f32_16x16x32_bf16 a[4:7], v[100:103], v[68:71], a[4:7]
    ds_read_b128 v[144:147], v31 offset:7168
    v_mfma_f32_16x16x32_bf16 a[8:11], v[104:107], v[68:71], a[8:11]
    ds_read_b128 v[148:151], v31 offset:8192
    v_mfma_f32_16x16x32_bf16 a[12:15], v[108:111], v[68:71], a[12:15]
    ds_read_b128 v[152:155], v31 offset:9216
    v_mfma_f32_16x16x32_bf16 a[16:19], v[112:115], v[68:71], a[16:19]
    ds_read_b128 v[156:159], v31 offset:10240
    v_mfma_f32_16x16x32_bf16 a[20:23], a[128:131], v[40:43], a[20:23]
    buffer_load_dwordx4 a[204:207], v31, s[16:19], s21 offen offset:3072 sc1
    v_mfma_f32_16x16x32_bf16 a[24:27], a[132:135], v[40:43], a[24:27]
    ds_read_b128 v[160:163], v31 offset:11264
    v_mfma_f32_16x16x32_bf16 a[28:31], a[136:139], v[40:43], a[28:31]
    ds_read_b128 v[164:167], v31 offset:12288
    v_mfma_f32_16x16x32_bf16 a[32:35], a[140:143], v[40:43], a[32:35]
    ds_write_b128 v25, a[0:3] offset:0
    v_mfma_f32_16x16x32_bf16 a[36:39], a[144:147], v[40:43], a[36:39]
    ds_read_b128 v[168:171], v31 offset:13312
    ds_read_b128 v[172:175], v31 offset:14336
    v_mfma_f32_16x16x32_bf16 a[20:23], a[148:151], v[56:59], a[20:23]
    v_mfma_f32_16x16x32_bf16 a[24:27], a[152:155], v[56:59], a[24:27]
    ds_write_b128 v25, a[4:7] offset:1024
    v_mfma_f32_16x16x32_bf16 a[28:31], a[156:159], v[56:59], a[28:31]
    s_add_u32 s21, s70, 8192
    buffer_load_dwordx4 a[208:211], v31, s[16:19], s21 offen offset:0 sc1
    ds_read_b128 v[176:179], v31 offset:15360
    v_mfma_f32_16x16x32_bf16 a[32:35], a[160:163], v[56:59], a[32:35]
    ds_write_b128 v25, a[8:11] offset:2048
    v_mfma_f32_16x16x32_bf16 a[36:39], a[164:167], v[56:59], a[36:39]
    ds_read_b128 v[180:183], v31 offset:16384
    ds_read_b128 v[184:187], v31 offset:17408
    v_mfma_f32_16x16x32_bf16 a[20:23], v[96:99], v[72:75], a[20:23]
    ds_write_b128 v25, a[12:15] offset:3072
    v_mfma_f32_16x16x32_bf16 a[24:27], v[100:103], v[72:75], a[24:27]
    buffer_load_dwordx4 a[212:215], v31, s[16:19], s21 offen offset:1024 sc1
    ds_read_b128 v[188:191], v31 offset:18432
    v_mfma_f32_16x16x32_bf16 a[28:31], v[104:107], v[72:75], a[28:31]
    ds_write_b128 v25, a[16:19] offset:4096
    v_mfma_f32_16x16x32_bf16 a[32:35], v[108:111], v[72:75], a[32:35]
    ds_read_b128 v[192:195], v31 offset:19456
    ds_read_b128 v[196:199], v31 offset:20480
    v_mfma_f32_16x16x32_bf16 a[36:39], v[112:115], v[72:75], a[36:39]
    ds_read_b128 v[200:203], v31 offset:21504
    v_mfma_f32_16x16x32_bf16 a[40:43], a[128:131], v[44:47], a[40:43]
    buffer_load_dwordx4 a[216:219], v31, s[16:19], s21 offen offset:2048 sc1
    v_mfma_f32_16x16x32_bf16 a[44:47], a[132:135], v[44:47], a[44:47]
    ds_read_b128 v[204:207], v31 offset:22528
    v_mfma_f32_16x16x32_bf16 a[48:51], a[136:139], v[44:47], a[48:51]
    ds_read_b128 v[208:211], v31 offset:23552
    v_mfma_f32_16x16x32_bf16 a[52:55], a[140:143], v[44:47], a[52:55]
    ds_write_b128 v26, a[20:23] offset:0
    v_mfma_f32_16x16x32_bf16 a[56:59], a[144:147], v[44:47], a[56:59]
    ds_read_b128 v[212:215], v31 offset:24576
    v_lshlrev_b32 v216, 16, v4
    v_mfma_f32_16x16x32_bf16 a[40:43], a[148:151], v[60:63], a[40:43]
    buffer_load_dwordx4 a[220:223], v31, s[16:19], s21 offen offset:3072 sc1
    v_mfma_f32_16x16x32_bf16 a[44:47], a[152:155], v[60:63], a[44:47]
    ds_write_b128 v26, a[24:27] offset:1024
    v_mfma_f32_16x16x32_bf16 a[48:51], a[156:159], v[60:63], a[48:51]
    v_and_b32 v217, s93, v4
    v_lshlrev_b32 v218, 16, v5
    v_mfma_f32_16x16x32_bf16 a[52:55], a[160:163], v[60:63], a[52:55]
    ds_write_b128 v26, a[28:31] offset:2048
    v_mfma_f32_16x16x32_bf16 a[56:59], a[164:167], v[60:63], a[56:59]
    v_and_b32 v219, s93, v5
    v_lshlrev_b32 v220, 16, v6
    v_mfma_f32_16x16x32_bf16 a[40:43], v[96:99], v[76:79], a[40:43]
    ds_write_b128 v26, a[32:35] offset:3072
    v_mfma_f32_16x16x32_bf16 a[44:47], v[100:103], v[76:79], a[44:47]
    s_add_u32 s21, s70, 12288
    buffer_load_dwordx4 a[224:227], v31, s[16:19], s21 offen offset:0 sc1
    v_mfma_f32_16x16x32_bf16 a[48:51], v[104:107], v[76:79], a[48:51]
    ds_write_b128 v26, a[36:39] offset:4096
    v_mfma_f32_16x16x32_bf16 a[52:55], v[108:111], v[76:79], a[52:55]
    v_and_b32 v221, s93, v6
    v_lshlrev_b32 v222, 16, v7
    v_mfma_f32_16x16x32_bf16 a[56:59], v[112:115], v[76:79], a[56:59]
    v_and_b32 v223, s93, v7
    v_mfma_f32_16x16x32_bf16 v[236:239], a[128:131], v[32:35], v[236:239]
    buffer_load_dwordx4 a[228:231], v31, s[16:19], s21 offen offset:1024 sc1
    v_mfma_f32_16x16x32_bf16 v[240:243], a[132:135], v[32:35], v[240:243]
    v_lshlrev_b32 v224, 16, v8
    v_mfma_f32_16x16x32_bf16 v[244:247], a[136:139], v[32:35], v[244:247]
    v_and_b32 v225, s93, v8
    v_mfma_f32_16x16x32_bf16 v[248:251], a[140:143], v[32:35], v[248:251]
    ds_write_b128 v27, a[40:43] offset:0
    v_mfma_f32_16x16x32_bf16 v[252:255], a[144:147], v[32:35], v[252:255]
    v_lshlrev_b32 v226, 16, v9
    v_and_b32 v227, s93, v9
    v_mfma_f32_16x16x32_bf16 v[236:239], a[148:151], v[48:51], v[236:239]
    buffer_load_dwordx4 a[232:235], v31, s[16:19], s21 offen offset:2048 sc1
    v_mfma_f32_16x16x32_bf16 v[240:243], a[152:155], v[48:51], v[240:243]
    ds_write_b128 v27, a[44:47] offset:1024
    v_mfma_f32_16x16x32_bf16 v[244:247], a[156:159], v[48:51], v[244:247]
    v_lshlrev_b32 v228, 16, v10
    v_and_b32 v229, s93, v10
    v_mfma_f32_16x16x32_bf16 v[248:251], a[160:163], v[48:51], v[248:251]
    ds_write_b128 v27, a[48:51] offset:2048
    v_mfma_f32_16x16x32_bf16 v[252:255], a[164:167], v[48:51], v[252:255]
    v_lshlrev_b32 v230, 16, v11
    v_and_b32 v231, s93, v11
    v_mfma_f32_16x16x32_bf16 v[236:239], v[96:99], v[64:67], v[236:239]
    ds_write_b128 v27, a[52:55] offset:3072
    v_mfma_f32_16x16x32_bf16 v[240:243], v[100:103], v[64:67], v[240:243]
    buffer_load_dwordx4 a[236:239], v31, s[16:19], s21 offen offset:3072 sc1
    v_lshlrev_b32 v232, 16, v12
    v_mfma_f32_16x16x32_bf16 v[244:247], v[104:107], v[64:67], v[244:247]
    ds_write_b128 v27, a[56:59] offset:4096
    v_mfma_f32_16x16x32_bf16 v[248:251], v[108:111], v[64:67], v[248:251]
    v_and_b32 v233, s93, v12
    v_lshlrev_b32 v234, 16, v13
    v_mfma_f32_16x16x32_bf16 v[252:255], v[112:115], v[64:67], v[252:255]
    v_and_b32 v235, s93, v13
    s_waitcnt vmcnt(12)
    s_waitcnt lgkmcnt(15)
    v_mfma_f32_16x16x32_bf16 v[92:95], v[116:119], a[176:179], 0
    ds_read_b128 v[96:99], v31 offset:25600
    s_add_u32 s21, s70, 16384
    buffer_load_dwordx4 a[240:243], v31, s[16:19], s21 offen offset:0 sc1
    v_mfma_f32_16x16x32_bf16 v[4:7], v[120:123], a[176:179], 0
    ds_read_b128 v[100:103], v31 offset:26624
    buffer_load_dwordx4 a[244:247], v31, s[16:19], s21 offen offset:1024 sc1
    v_mfma_f32_16x16x32_bf16 v[8:11], v[124:127], a[176:179], 0
    ds_read_b128 v[104:107], v31 offset:27648
    s_waitcnt lgkmcnt(3)
    s_barrier
    v_mfma_f32_16x16x32_bf16 v[16:19], v[128:131], a[176:179], 0
    ds_read_b128 v[108:111], v31 offset:28672
    ds_read_b128 v[32:35], v28 offset:0
    ds_read_b128 v[36:39], v28 offset:1024
    v_mfma_f32_16x16x32_bf16 v[20:23], v[132:135], a[176:179], 0
    ds_read_b128 v[112:115], v31 offset:29696
    ds_read_b128 v[40:43], v28 offset:2048
    v_mfma_f32_16x16x32_bf16 v[92:95], v[136:139], a[180:183], v[92:95]
    ds_read_b128 v[116:119], v31 offset:30720
    ds_read_b128 v[44:47], v28 offset:3072
    v_mfma_f32_16x16x32_bf16 v[4:7], v[140:143], a[180:183], v[4:7]
    ds_read_b128 v[120:123], v31 offset:31744
    ds_read_b128 v[48:51], v28 offset:4096
    ds_read_b128 v[52:55], v28 offset:5120
    v_mfma_f32_16x16x32_bf16 v[8:11], v[144:147], a[180:183], v[8:11]
    ds_read_b128 v[124:127], v31 offset:32768
    ds_read_b128 v[56:59], v28 offset:6144
    v_mfma_f32_16x16x32_bf16 v[16:19], v[148:151], a[180:183], v[16:19]
    ds_read_b128 v[128:131], v31 offset:33792
    ds_read_b128 v[60:63], v28 offset:7168
    v_mfma_f32_16x16x32_bf16 v[20:23], v[152:155], a[180:183], v[20:23]
    ds_read_b128 v[132:135], v31 offset:34816
    ds_read_b128 v[64:67], v28 offset:8192
    ds_read_b128 v[68:71], v28 offset:9216
    v_mfma_f32_16x16x32_bf16 v[92:95], v[156:159], a[184:187], v[92:95]
    ds_read_b128 v[136:139], v31 offset:35840
    ds_read_b128 v[72:75], v28 offset:10240
    v_mfma_f32_16x16x32_bf16 v[4:7], v[160:163], a[184:187], v[4:7]
    ds_read_b128 v[140:143], v31 offset:36864
    ds_read_b128 v[76:79], v28 offset:11264
    v_mfma_f32_16x16x32_bf16 v[8:11], v[164:167], a[184:187], v[8:11]
    ds_read_b128 v[144:147], v31 offset:37888
    ds_read_b128 v[80:83], v28 offset:12288
    v_mfma_f32_16x16x32_bf16 v[16:19], v[168:171], a[184:187], v[16:19]
    ds_read_b128 v[148:151], v31 offset:38912
    ds_read_b128 v[84:87], v28 offset:13312
    ds_read_b128 v[88:91], v28 offset:14336
    v_mfma_f32_16x16x32_bf16 v[20:23], v[172:175], a[184:187], v[20:23]
    ds_read_b128 v[152:155], v31 offset:39936
    buffer_load_dwordx4 a[248:251], v31, s[16:19], s21 offen offset:2048 sc1
    s_waitcnt lgkmcnt(15)
    v_mfma_f32_16x16x32_bf16 v[92:95], v[176:179], a[188:191], v[92:95]
    ds_read_b128 v[156:159], v31 offset:40960
    buffer_load_dwordx4 a[252:255], v31, s[16:19], s21 offen offset:3072 sc1
    v_mfma_f32_16x16x32_bf16 v[4:7], v[180:183], a[188:191], v[4:7]
    ds_read_b128 v[160:163], v31 offset:41984
    v_sub_u32 v3, v28, v31
    v_add_u32 v3, v3, v14
    v_mfma_f32_16x16x32_bf16 v[8:11], v[184:187], a[188:191], v[8:11]
    ds_read_b128 v[164:167], v31 offset:43008
    s_waitcnt lgkmcnt(4)
    v_mfma_f32_16x16x32_bf16 v[16:19], v[188:191], a[188:191], v[16:19]
    ds_read_b128 v[168:171], v31 offset:44032
    v_pk_add_f32 v[236:237], v[236:237], v[32:33]
    v_pk_add_f32 v[238:239], v[238:239], v[34:35]
    v_pk_add_f32 v[240:241], v[240:241], v[36:37]
    v_pk_add_f32 v[242:243], v[242:243], v[38:39]
    v_pk_add_f32 v[244:245], v[244:245], v[40:41]
    v_pk_add_f32 v[246:247], v[246:247], v[42:43]
    v_pk_add_f32 v[248:249], v[248:249], v[44:45]
    v_pk_add_f32 v[250:251], v[250:251], v[46:47]
    v_pk_add_f32 v[252:253], v[252:253], v[48:49]
    v_pk_add_f32 v[254:255], v[254:255], v[50:51]
    v_pk_add_f32 v[52:53], v[52:53], v[72:73]
    v_pk_add_f32 v[54:55], v[54:55], v[74:75]
    v_pk_add_f32 v[56:57], v[56:57], v[76:77]
    v_pk_add_f32 v[58:59], v[58:59], v[78:79]
    v_pk_add_f32 v[60:61], v[60:61], v[80:81]
    v_pk_add_f32 v[62:63], v[62:63], v[82:83]
    v_pk_add_f32 v[64:65], v[64:65], v[84:85]
    v_pk_add_f32 v[66:67], v[66:67], v[86:87]
    v_pk_add_f32 v[68:69], v[68:69], v[88:89]
    v_pk_add_f32 v[70:71], v[70:71], v[90:91]
    v_pk_add_f32 v[236:237], v[236:237], v[52:53]
    v_pk_add_f32 v[238:239], v[238:239], v[54:55]
    v_pk_add_f32 v[240:241], v[240:241], v[56:57]
    v_pk_add_f32 v[242:243], v[242:243], v[58:59]
    v_pk_add_f32 v[244:245], v[244:245], v[60:61]
    v_pk_add_f32 v[246:247], v[246:247], v[62:63]
    v_pk_add_f32 v[248:249], v[248:249], v[64:65]
    v_pk_add_f32 v[250:251], v[250:251], v[66:67]
    v_pk_add_f32 v[252:253], v[252:253], v[68:69]
    v_pk_add_f32 v[254:255], v[254:255], v[70:71]
    v_pk_mul_f32 v[32:33], v[236:237], s[92:93] op_sel_hi:[1,0]
    v_pk_mul_f32 v[34:35], v[238:239], s[92:93] op_sel_hi:[1,0]
    v_pk_mul_f32 v[36:37], v[240:241], s[92:93] op_sel_hi:[1,0]
    v_pk_mul_f32 v[38:39], v[242:243], s[92:93] op_sel_hi:[1,0]
    v_pk_mul_f32 v[40:41], v[244:245], s[92:93] op_sel_hi:[1,0]
    v_pk_mul_f32 v[42:43], v[246:247], s[92:93] op_sel_hi:[1,0]
    v_pk_mul_f32 v[44:45], v[248:249], s[92:93] op_sel_hi:[1,0]
    v_pk_mul_f32 v[46:47], v[250:251], s[92:93] op_sel_hi:[1,0]
    v_pk_mul_f32 v[48:49], v[252:253], s[92:93] op_sel_hi:[1,0]
    v_pk_mul_f32 v[50:51], v[254:255], s[92:93] op_sel_hi:[1,0]
    v_mfma_f32_16x16x32_bf16 v[20:23], v[192:195], a[188:191], v[20:23]
    ds_read_b128 v[172:175], v31 offset:45056
    v_exp_f32 v32, v32
    v_exp_f32 v33, v33
    s_waitcnt vmcnt(12)
    v_mfma_f32_16x16x32_bf16 v[92:95], v[196:199], a[192:195], v[92:95]
    ds_read_b128 v[176:179], v31 offset:46080
    v_exp_f32 v34, v34
    v_mfma_f32_16x16x32_bf16 v[4:7], v[200:203], a[192:195], v[4:7]
    ds_read_b128 v[180:183], v31 offset:47104
    v_exp_f32 v35, v35
    v_mfma_f32_16x16x32_bf16 v[8:11], v[204:207], a[192:195], v[8:11]
    ds_read_b128 v[184:187], v31 offset:48128
    v_exp_f32 v36, v36
    v_mfma_f32_16x16x32_bf16 v[16:19], v[208:211], a[192:195], v[16:19]
    ds_read_b128 v[188:191], v31 offset:49152
    v_exp_f32 v37, v37
    v_exp_f32 v38, v38
    v_mfma_f32_16x16x32_bf16 v[20:23], v[212:215], a[192:195], v[20:23]
    ds_read_b128 v[192:195], v31 offset:50176
    v_exp_f32 v39, v39
    v_mfma_f32_16x16x32_bf16 v[92:95], v[96:99], a[196:199], v[92:95]
    ds_read_b128 v[196:199], v31 offset:51200
    v_exp_f32 v40, v40
    v_mfma_f32_16x16x32_bf16 v[4:7], v[100:103], a[196:199], v[4:7]
    ds_read_b128 v[200:203], v31 offset:52224
    v_exp_f32 v41, v41
    v_exp_f32 v42, v42
    v_mfma_f32_16x16x32_bf16 v[8:11], v[104:107], a[196:199], v[8:11]
    ds_read_b128 v[204:207], v31 offset:53248
    v_exp_f32 v43, v43
    v_mfma_f32_16x16x32_bf16 v[16:19], v[108:111], a[196:199], v[16:19]
    ds_read_b128 v[208:211], v31 offset:54272
    v_exp_f32 v44, v44
    v_mfma_f32_16x16x32_bf16 v[20:23], v[112:115], a[196:199], v[20:23]
    ds_read_b128 v[212:215], v31 offset:55296
    v_exp_f32 v45, v45
    v_exp_f32 v46, v46
    s_waitcnt lgkmcnt(10)
    v_mfma_f32_16x16x32_bf16 v[92:95], v[116:119], a[200:203], v[92:95]
    ds_read_b128 v[96:99], v31 offset:56320
    v_exp_f32 v47, v47
    v_mfma_f32_16x16x32_bf16 v[4:7], v[120:123], a[200:203], v[4:7]
    ds_read_b128 v[100:103], v31 offset:57344
    v_exp_f32 v48, v48
    v_mfma_f32_16x16x32_bf16 v[8:11], v[124:127], a[200:203], v[8:11]
    ds_read_b128 v[104:107], v31 offset:58368
    v_exp_f32 v49, v49
    v_mfma_f32_16x16x32_bf16 v[16:19], v[128:131], a[200:203], v[16:19]
    ds_read_b128 v[108:111], v31 offset:59392
    v_exp_f32 v50, v50
    v_exp_f32 v51, v51
    v_mfma_f32_16x16x32_bf16 v[20:23], v[132:135], a[200:203], v[20:23]
    ds_read_b128 v[112:115], v31 offset:60416
    v_add_f32 v32, 1.0, v32
    v_mfma_f32_16x16x32_bf16 v[92:95], v[136:139], a[204:207], v[92:95]
    ds_read_b128 v[116:119], v15 offset:0
    v_add_f32 v33, 1.0, v33
    v_mfma_f32_16x16x32_bf16 v[4:7], v[140:143], a[204:207], v[4:7]
    ds_read_b128 v[120:123], v15 offset:1024
    v_add_f32 v34, 1.0, v34
    v_add_f32 v35, 1.0, v35
    v_mfma_f32_16x16x32_bf16 v[8:11], v[144:147], a[204:207], v[8:11]
    ds_read_b128 v[124:127], v15 offset:2048
    v_add_f32 v36, 1.0, v36
    v_mfma_f32_16x16x32_bf16 v[16:19], v[148:151], a[204:207], v[16:19]
    ds_read_b128 v[128:131], v15 offset:3072
    v_add_f32 v37, 1.0, v37
    v_mfma_f32_16x16x32_bf16 v[20:23], v[152:155], a[204:207], v[20:23]
    ds_read_b128 v[132:135], v15 offset:4096
    v_add_f32 v38, 1.0, v38
    v_add_f32 v39, 1.0, v39
    s_waitcnt vmcnt(8)
    v_mfma_f32_16x16x32_bf16 v[92:95], v[156:159], a[208:211], v[92:95]
    ds_read_b128 v[136:139], v15 offset:5120
    v_add_f32 v40, 1.0, v40
    v_mfma_f32_16x16x32_bf16 v[4:7], v[160:163], a[208:211], v[4:7]
    ds_read_b128 v[140:143], v15 offset:6144
    v_add_f32 v41, 1.0, v41
    v_mfma_f32_16x16x32_bf16 v[8:11], v[164:167], a[208:211], v[8:11]
    ds_read_b128 v[144:147], v15 offset:7168
    v_add_f32 v42, 1.0, v42
    v_mfma_f32_16x16x32_bf16 v[16:19], v[168:171], a[208:211], v[16:19]
    ds_read_b128 v[148:151], v15 offset:8192
    v_add_f32 v43, 1.0, v43
    v_add_f32 v44, 1.0, v44
    v_mfma_f32_16x16x32_bf16 v[20:23], v[172:175], a[208:211], v[20:23]
    ds_read_b128 v[152:155], v15 offset:9216
    v_add_f32 v45, 1.0, v45
    s_waitcnt lgkmcnt(10)
    v_mfma_f32_16x16x32_bf16 v[92:95], v[176:179], a[212:215], v[92:95]
    ds_read_b128 v[156:159], v15 offset:10240
    v_add_f32 v46, 1.0, v46
    v_mfma_f32_16x16x32_bf16 v[4:7], v[180:183], a[212:215], v[4:7]
    ds_read_b128 v[160:163], v15 offset:11264
    v_add_f32 v47, 1.0, v47
    v_add_f32 v48, 1.0, v48
    v_mfma_f32_16x16x32_bf16 v[8:11], v[184:187], a[212:215], v[8:11]
    ds_read_b128 v[164:167], v15 offset:12288
    v_add_f32 v49, 1.0, v49
    v_mfma_f32_16x16x32_bf16 v[16:19], v[188:191], a[212:215], v[16:19]
    ds_read_b128 v[168:171], v15 offset:13312
    v_add_f32 v50, 1.0, v50
    v_mfma_f32_16x16x32_bf16 v[20:23], v[192:195], a[212:215], v[20:23]
    ds_read_b128 v[172:175], v15 offset:14336
    v_add_f32 v51, 1.0, v51
    v_rcp_f32 v32, v32
    v_mfma_f32_16x16x32_bf16 v[92:95], v[196:199], a[216:219], v[92:95]
    ds_read_b128 v[176:179], v15 offset:15360
    v_rcp_f32 v33, v33
    v_mfma_f32_16x16x32_bf16 v[4:7], v[200:203], a[216:219], v[4:7]
    ds_read_b128 v[180:183], v15 offset:16384
    v_rcp_f32 v34, v34
    v_mfma_f32_16x16x32_bf16 v[8:11], v[204:207], a[216:219], v[8:11]
    ds_read_b128 v[184:187], v15 offset:17408
    v_rcp_f32 v35, v35
    v_mfma_f32_16x16x32_bf16 v[16:19], v[208:211], a[216:219], v[16:19]
    ds_read_b128 v[188:191], v15 offset:18432
    v_rcp_f32 v36, v36
    v_rcp_f32 v37, v37
    v_mfma_f32_16x16x32_bf16 v[20:23], v[212:215], a[216:219], v[20:23]
    ds_read_b128 v[192:195], v15 offset:19456
    v_rcp_f32 v38, v38
    v_mfma_f32_16x16x32_bf16 v[92:95], v[96:99], a[220:223], v[92:95]
    ds_read_b128 v[196:199], v15 offset:20480
    v_rcp_f32 v39, v39
    v_mfma_f32_16x16x32_bf16 v[4:7], v[100:103], a[220:223], v[4:7]
    ds_read_b128 v[200:203], v15 offset:21504
    v_rcp_f32 v40, v40
    v_rcp_f32 v41, v41
    v_mfma_f32_16x16x32_bf16 v[8:11], v[104:107], a[220:223], v[8:11]
    ds_read_b128 v[204:207], v15 offset:22528
    v_rcp_f32 v42, v42
    v_mfma_f32_16x16x32_bf16 v[16:19], v[108:111], a[220:223], v[16:19]
    ds_read_b128 v[208:211], v15 offset:23552
    v_rcp_f32 v43, v43
    v_mfma_f32_16x16x32_bf16 v[20:23], v[112:115], a[220:223], v[20:23]
    ds_read_b128 v[212:215], v15 offset:24576
    v_rcp_f32 v44, v44
    v_rcp_f32 v45, v45
    s_waitcnt vmcnt(4)
    s_waitcnt lgkmcnt(10)
    v_mfma_f32_16x16x32_bf16 v[92:95], v[116:119], a[224:227], v[92:95]
    ds_read_b128 v[96:99], v15 offset:25600
    v_rcp_f32 v46, v46
    v_mfma_f32_16x16x32_bf16 v[4:7], v[120:123], a[224:227], v[4:7]
    ds_read_b128 v[100:103], v15 offset:26624
    v_rcp_f32 v47, v47
    v_mfma_f32_16x16x32_bf16 v[8:11], v[124:127], a[224:227], v[8:11]
    ds_read_b128 v[104:107], v15 offset:27648
    v_rcp_f32 v48, v48
    v_mfma_f32_16x16x32_bf16 v[16:19], v[128:131], a[224:227], v[16:19]
    ds_read_b128 v[108:111], v15 offset:28672
    v_rcp_f32 v49, v49
    v_rcp_f32 v50, v50
    v_mfma_f32_16x16x32_bf16 v[20:23], v[132:135], a[224:227], v[20:23]
    ds_read_b128 v[112:115], v15 offset:29696
    v_rcp_f32 v51, v51
    v_mfma_f32_16x16x32_bf16 v[92:95], v[136:139], a[228:231], v[92:95]
    ds_read_b128 v[116:119], v15 offset:30720
    v_mul_f32 v236, v236, v32
    v_mfma_f32_16x16x32_bf16 v[4:7], v[140:143], a[228:231], v[4:7]
    ds_read_b128 v[120:123], v15 offset:31744
    v_mul_f32 v237, v237, v33
    v_mul_f32 v238, v238, v34
    v_mfma_f32_16x16x32_bf16 v[8:11], v[144:147], a[228:231], v[8:11]
    ds_read_b128 v[124:127], v15 offset:32768
    v_mul_f32 v239, v239, v35
    v_mfma_f32_16x16x32_bf16 v[16:19], v[148:151], a[228:231], v[16:19]
    ds_read_b128 v[128:131], v15 offset:33792
    v_mul_f32 v240, v240, v36
    v_mfma_f32_16x16x32_bf16 v[20:23], v[152:155], a[228:231], v[20:23]
    ds_read_b128 v[132:135], v15 offset:34816
    v_mul_f32 v241, v241, v37
    v_mul_f32 v242, v242, v38
    v_mfma_f32_16x16x32_bf16 v[92:95], v[156:159], a[232:235], v[92:95]
    ds_read_b128 v[136:139], v15 offset:35840
    v_mul_f32 v243, v243, v39
    v_mfma_f32_16x16x32_bf16 v[4:7], v[160:163], a[232:235], v[4:7]
    ds_read_b128 v[140:143], v15 offset:36864
    v_mul_f32 v244, v244, v40
    v_mfma_f32_16x16x32_bf16 v[8:11], v[164:167], a[232:235], v[8:11]
    ds_read_b128 v[144:147], v15 offset:37888
    v_mul_f32 v245, v245, v41
    v_mfma_f32_16x16x32_bf16 v[16:19], v[168:171], a[232:235], v[16:19]
    ds_read_b128 v[148:151], v15 offset:38912
    v_mul_f32 v246, v246, v42
    v_mul_f32 v247, v247, v43
    v_mfma_f32_16x16x32_bf16 v[20:23], v[172:175], a[232:235], v[20:23]
    ds_read_b128 v[152:155], v15 offset:39936
    v_mul_f32 v248, v248, v44
    s_waitcnt lgkmcnt(10)
    v_mfma_f32_16x16x32_bf16 v[92:95], v[176:179], a[236:239], v[92:95]
    v_mul_f32 v249, v249, v45
    v_mfma_f32_16x16x32_bf16 v[4:7], v[180:183], a[236:239], v[4:7]
    v_mul_f32 v250, v250, v46
    v_mul_f32 v251, v251, v47
    v_mfma_f32_16x16x32_bf16 v[8:11], v[184:187], a[236:239], v[8:11]
    v_mul_f32 v252, v252, v48
    v_mfma_f32_16x16x32_bf16 v[16:19], v[188:191], a[236:239], v[16:19]
    v_mul_f32 v253, v253, v49
    v_mfma_f32_16x16x32_bf16 v[20:23], v[192:195], a[236:239], v[20:23]
    v_mul_f32 v254, v254, v50
    v_mul_f32 v255, v255, v51
    s_waitcnt vmcnt(0)
    s_waitcnt lgkmcnt(0)
    v_mfma_f32_16x16x32_bf16 v[92:95], v[196:199], a[240:243], v[92:95]
    v_mfma_f32_16x16x32_bf16 v[92:95], v[96:99], a[244:247], v[92:95]
    v_mfma_f32_16x16x32_bf16 v[92:95], v[116:119], a[248:251], v[92:95]
    v_mfma_f32_16x16x32_bf16 v[92:95], v[136:139], a[252:255], v[92:95]
    v_mfma_f32_16x16x32_bf16 v[4:7], v[200:203], a[240:243], v[4:7]
    v_mfma_f32_16x16x32_bf16 v[4:7], v[100:103], a[244:247], v[4:7]
    v_mfma_f32_16x16x32_bf16 v[4:7], v[120:123], a[248:251], v[4:7]
    v_mfma_f32_16x16x32_bf16 v[4:7], v[140:143], a[252:255], v[4:7]
    s_nop 2
    v_mfma_f32_16x16x32_bf16 v[8:11], v[204:207], a[240:243], v[8:11]
    v_fma_f32 v236, v236, v92, v216
    v_fma_f32 v237, v237, v93, v217
    v_mfma_f32_16x16x32_bf16 v[8:11], v[104:107], a[244:247], v[8:11]
    v_fma_f32 v238, v238, v94, v218
    v_fma_f32 v239, v239, v95, v219
    v_mfma_f32_16x16x32_bf16 v[8:11], v[124:127], a[248:251], v[8:11]
    v_cvt_pk_bf16_f32 v64, v236, v237
    v_cvt_pk_bf16_f32 v65, v238, v239
    v_mfma_f32_16x16x32_bf16 v[8:11], v[144:147], a[252:255], v[8:11]
    ds_write_b64 v3, v[64:65] offset:0
    v_mfma_f32_16x16x32_bf16 v[16:19], v[208:211], a[240:243], v[16:19]
    v_fma_f32 v240, v240, v4, v220
    v_fma_f32 v241, v241, v5, v221
    v_mfma_f32_16x16x32_bf16 v[16:19], v[108:111], a[244:247], v[16:19]
    v_fma_f32 v242, v242, v6, v222
    v_fma_f32 v243, v243, v7, v223
    v_mfma_f32_16x16x32_bf16 v[16:19], v[128:131], a[248:251], v[16:19]
    v_cvt_pk_bf16_f32 v66, v240, v241
    v_cvt_pk_bf16_f32 v67, v242, v243
    v_mfma_f32_16x16x32_bf16 v[16:19], v[148:151], a[252:255], v[16:19]
    ds_write_b64 v3, v[66:67] offset:32
    v_mfma_f32_16x16x32_bf16 v[20:23], v[212:215], a[240:243], v[20:23]
    v_fma_f32 v244, v244, v8, v224
    v_fma_f32 v245, v245, v9, v225
    v_mfma_f32_16x16x32_bf16 v[20:23], v[112:115], a[244:247], v[20:23]
    v_fma_f32 v246, v246, v10, v226
    v_fma_f32 v247, v247, v11, v227
    v_mfma_f32_16x16x32_bf16 v[20:23], v[132:135], a[248:251], v[20:23]
    v_cvt_pk_bf16_f32 v68, v244, v245
    v_cvt_pk_bf16_f32 v69, v246, v247
    v_mfma_f32_16x16x32_bf16 v[20:23], v[152:155], a[252:255], v[20:23]
    ds_write_b64 v3, v[68:69] offset:64
    v_fma_f32 v248, v248, v16, v228
    v_fma_f32 v249, v249, v17, v229
    v_fma_f32 v250, v250, v18, v230
    v_fma_f32 v251, v251, v19, v231
    v_cvt_pk_bf16_f32 v70, v248, v249
    v_cvt_pk_bf16_f32 v71, v250, v251
    ds_write_b64 v3, v[70:71] offset:96
    s_nop 0
    v_fma_f32 v252, v252, v20, v232
    v_fma_f32 v253, v253, v21, v233
    v_fma_f32 v254, v254, v22, v234
    v_fma_f32 v255, v255, v23, v235
    v_cvt_pk_bf16_f32 v72, v252, v253
    v_cvt_pk_bf16_f32 v73, v254, v255
    ds_write_b64 v3, v[72:73] offset:128
    s_waitcnt lgkmcnt(0)
    ds_read_b128 v[76:79], v28 offset:0
    ds_read_b128 v[80:83], v28 offset:1024
    ds_read_b128 v[84:87], v28 offset:2048
    s_waitcnt lgkmcnt(2)
    global_store_dwordx4 v1, v[76:79], s[6:7]
    s_waitcnt lgkmcnt(1)
    global_store_dwordx4 v2, v[80:83], s[6:7]
    s_waitcnt lgkmcnt(0)
    s_mov_b32 exec_hi, 0
    global_store_dwordx4 v29, v[84:87], s[6:7]
    s_mov_b32 exec_hi, -1
    s_endpgm
recurrent_scan__sliding_local_dilated__swiglu_ffn__prompt_kernel_two:
    s_waitcnt vmcnt(0)
    s_waitcnt lgkmcnt(0)
    s_barrier
    s_nop 4
    v_accvgpr_read_b32 v32, a64
    v_accvgpr_read_b32 v33, a65
    v_accvgpr_read_b32 v34, a66
    v_accvgpr_read_b32 v35, a67
    v_accvgpr_read_b32 v36, a68
    v_accvgpr_read_b32 v37, a69
    v_accvgpr_read_b32 v38, a70
    v_accvgpr_read_b32 v39, a71
    v_pk_mul_f32 v[48:49], v[22:23], v[32:33] op_sel:[0,0] op_sel_hi:[0,1]
    v_pk_mul_f32 v[50:51], v[22:23], v[34:35] op_sel:[0,0] op_sel_hi:[0,1]
    v_pk_mul_f32 v[52:53], v[22:23], v[36:37] op_sel:[0,0] op_sel_hi:[0,1]
    v_pk_mul_f32 v[54:55], v[22:23], v[38:39] op_sel:[0,0] op_sel_hi:[0,1]
    v_exp_f32 v48, v48
    v_accvgpr_read_b32 v40, a72
    v_exp_f32 v49, v49
    v_accvgpr_read_b32 v41, a73
    s_add_u32 s21, s68, 10240
    buffer_load_dwordx4 a[216:219], v31, s[16:19], s21 offen offset:0 sc1
    v_exp_f32 v50, v50
    v_accvgpr_read_b32 v42, a74
    v_exp_f32 v51, v51
    v_accvgpr_read_b32 v43, a75
    v_exp_f32 v52, v52
    v_accvgpr_read_b32 v44, a76
    v_exp_f32 v53, v53
    v_accvgpr_read_b32 v45, a77
    v_exp_f32 v54, v54
    v_accvgpr_read_b32 v46, a78
    v_exp_f32 v55, v55
    v_accvgpr_read_b32 v47, a79
    v_pk_fma_f32 v[48:49], v[48:49], v[20:21], v[20:21] op_sel:[0,0,0] op_sel_hi:[1,0,0]
    v_pk_fma_f32 v[50:51], v[50:51], v[20:21], v[20:21] op_sel:[0,0,0] op_sel_hi:[1,0,0]
    v_pk_fma_f32 v[52:53], v[52:53], v[20:21], v[20:21] op_sel:[0,0,0] op_sel_hi:[1,0,0]
    buffer_load_dwordx4 a[220:223], v31, s[16:19], s21 offen offset:1024 sc1
    v_pk_fma_f32 v[54:55], v[54:55], v[20:21], v[20:21] op_sel:[0,0,0] op_sel_hi:[1,0,0]
    v_rcp_f32 v48, v48
    v_rcp_f32 v49, v49
    v_rcp_f32 v50, v50
    v_rcp_f32 v51, v51
    v_rcp_f32 v52, v52
    v_rcp_f32 v53, v53
    v_rcp_f32 v54, v54
    v_rcp_f32 v55, v55
    v_pk_mul_f32 v[32:33], v[32:33], v[40:41]
    v_pk_mul_f32 v[34:35], v[34:35], v[42:43]
    v_pk_mul_f32 v[36:37], v[36:37], v[44:45]
    v_pk_mul_f32 v[38:39], v[38:39], v[46:47]
    v_pk_mul_f32 v[32:33], v[32:33], v[48:49]
    v_pk_mul_f32 v[34:35], v[34:35], v[50:51]
    buffer_load_dwordx4 a[224:227], v31, s[16:19], s21 offen offset:2048 sc1
    v_pk_mul_f32 v[36:37], v[36:37], v[52:53]
    v_pk_mul_f32 v[38:39], v[38:39], v[54:55]
    v_cvt_pk_bf16_f32 v56, v32, v33
    v_cvt_pk_bf16_f32 v57, v34, v35
    v_cvt_pk_bf16_f32 v58, v36, v37
    v_cvt_pk_bf16_f32 v59, v38, v39
    buffer_store_dwordx4 v[56:59], v31, s[16:19], s39 offen offset:0 sc1
    v_accvgpr_read_b32 v64, a80
    v_accvgpr_read_b32 v65, a81
    v_accvgpr_read_b32 v66, a82
    v_accvgpr_read_b32 v67, a83
    v_accvgpr_read_b32 v68, a84
    v_accvgpr_read_b32 v69, a85
    v_accvgpr_read_b32 v70, a86
    v_accvgpr_read_b32 v71, a87
    buffer_load_dwordx4 a[228:231], v31, s[16:19], s21 offen offset:3072 sc1
    v_pk_mul_f32 v[80:81], v[22:23], v[64:65] op_sel:[1,0] op_sel_hi:[1,1]
    v_pk_mul_f32 v[82:83], v[22:23], v[66:67] op_sel:[1,0] op_sel_hi:[1,1]
    v_pk_mul_f32 v[84:85], v[22:23], v[68:69] op_sel:[1,0] op_sel_hi:[1,1]
    v_pk_mul_f32 v[86:87], v[22:23], v[70:71] op_sel:[1,0] op_sel_hi:[1,1]
    v_exp_f32 v80, v80
    v_accvgpr_read_b32 v72, a88
    v_exp_f32 v81, v81
    v_accvgpr_read_b32 v73, a89
    v_exp_f32 v82, v82
    v_accvgpr_read_b32 v74, a90
    v_exp_f32 v83, v83
    v_accvgpr_read_b32 v75, a91
    v_exp_f32 v84, v84
    v_accvgpr_read_b32 v76, a92
    v_exp_f32 v85, v85
    v_accvgpr_read_b32 v77, a93
    s_add_u32 s21, s21, 4096
    buffer_load_dwordx4 a[232:235], v31, s[16:19], s21 offen offset:0 sc1
    v_exp_f32 v86, v86
    v_accvgpr_read_b32 v78, a94
    v_exp_f32 v87, v87
    v_accvgpr_read_b32 v79, a95
    v_pk_fma_f32 v[80:81], v[80:81], v[20:21], v[20:21] op_sel:[0,1,1] op_sel_hi:[1,1,1]
    v_pk_fma_f32 v[82:83], v[82:83], v[20:21], v[20:21] op_sel:[0,1,1] op_sel_hi:[1,1,1]
    v_pk_fma_f32 v[84:85], v[84:85], v[20:21], v[20:21] op_sel:[0,1,1] op_sel_hi:[1,1,1]
    v_pk_fma_f32 v[86:87], v[86:87], v[20:21], v[20:21] op_sel:[0,1,1] op_sel_hi:[1,1,1]
    v_rcp_f32 v80, v80
    v_rcp_f32 v81, v81
    v_rcp_f32 v82, v82
    v_rcp_f32 v83, v83
    v_rcp_f32 v84, v84
    v_rcp_f32 v85, v85
    v_rcp_f32 v86, v86
    s_add_u32 s21, s68, 15360
    buffer_load_dwordx4 a[236:239], v31, s[16:19], s21 offen offset:0 sc1
    v_rcp_f32 v87, v87
    v_pk_mul_f32 v[64:65], v[64:65], v[72:73]
    v_pk_mul_f32 v[66:67], v[66:67], v[74:75]
    v_pk_mul_f32 v[68:69], v[68:69], v[76:77]
    v_pk_mul_f32 v[70:71], v[70:71], v[78:79]
    v_pk_mul_f32 v[64:65], v[64:65], v[80:81]
    v_pk_mul_f32 v[66:67], v[66:67], v[82:83]
    v_pk_mul_f32 v[68:69], v[68:69], v[84:85]
    v_pk_mul_f32 v[70:71], v[70:71], v[86:87]
    v_cvt_pk_bf16_f32 v88, v64, v65
    v_cvt_pk_bf16_f32 v89, v66, v67
    v_cvt_pk_bf16_f32 v90, v68, v69
    v_cvt_pk_bf16_f32 v91, v70, v71
    buffer_store_dwordx4 v[88:91], v31, s[16:19], s39 offen offset:1024 sc1
    v_accvgpr_read_b32 v32, a96
    buffer_load_dwordx4 a[240:243], v31, s[16:19], s21 offen offset:1024 sc1
    v_accvgpr_read_b32 v33, a97
    v_accvgpr_read_b32 v34, a98
    v_accvgpr_read_b32 v35, a99
    v_accvgpr_read_b32 v36, a100
    v_accvgpr_read_b32 v37, a101
    v_accvgpr_read_b32 v38, a102
    v_accvgpr_read_b32 v39, a103
    v_pk_mul_f32 v[48:49], v[22:23], v[32:33] op_sel:[0,0] op_sel_hi:[0,1]
    v_pk_mul_f32 v[50:51], v[22:23], v[34:35] op_sel:[0,0] op_sel_hi:[0,1]
    v_pk_mul_f32 v[52:53], v[22:23], v[36:37] op_sel:[0,0] op_sel_hi:[0,1]
    v_pk_mul_f32 v[54:55], v[22:23], v[38:39] op_sel:[0,0] op_sel_hi:[0,1]
    v_exp_f32 v48, v48
    v_accvgpr_read_b32 v40, a104
    v_exp_f32 v49, v49
    v_accvgpr_read_b32 v41, a105
    buffer_load_dwordx4 a[244:247], v31, s[16:19], s21 offen offset:2048 sc1
    v_exp_f32 v50, v50
    v_accvgpr_read_b32 v42, a106
    v_exp_f32 v51, v51
    v_accvgpr_read_b32 v43, a107
    v_exp_f32 v52, v52
    v_accvgpr_read_b32 v44, a108
    v_exp_f32 v53, v53
    v_accvgpr_read_b32 v45, a109
    v_exp_f32 v54, v54
    v_accvgpr_read_b32 v46, a110
    v_exp_f32 v55, v55
    v_accvgpr_read_b32 v47, a111
    v_pk_fma_f32 v[48:49], v[48:49], v[20:21], v[20:21] op_sel:[0,0,0] op_sel_hi:[1,0,0]
    v_pk_fma_f32 v[50:51], v[50:51], v[20:21], v[20:21] op_sel:[0,0,0] op_sel_hi:[1,0,0]
    v_pk_fma_f32 v[52:53], v[52:53], v[20:21], v[20:21] op_sel:[0,0,0] op_sel_hi:[1,0,0]
    buffer_load_dwordx4 a[248:251], v31, s[16:19], s21 offen offset:3072 sc1
    v_pk_fma_f32 v[54:55], v[54:55], v[20:21], v[20:21] op_sel:[0,0,0] op_sel_hi:[1,0,0]
    v_rcp_f32 v48, v48
    v_rcp_f32 v49, v49
    v_rcp_f32 v50, v50
    v_rcp_f32 v51, v51
    v_rcp_f32 v52, v52
    v_rcp_f32 v53, v53
    v_rcp_f32 v54, v54
    v_rcp_f32 v55, v55
    v_pk_mul_f32 v[32:33], v[32:33], v[40:41]
    v_pk_mul_f32 v[34:35], v[34:35], v[42:43]
    v_pk_mul_f32 v[36:37], v[36:37], v[44:45]
    v_pk_mul_f32 v[38:39], v[38:39], v[46:47]
    v_pk_mul_f32 v[32:33], v[32:33], v[48:49]
    v_pk_mul_f32 v[34:35], v[34:35], v[50:51]
    v_pk_mul_f32 v[36:37], v[36:37], v[52:53]
    s_add_u32 s21, s21, 4096
    buffer_load_dwordx4 a[252:255], v31, s[16:19], s21 offen offset:0 sc1
    v_pk_mul_f32 v[38:39], v[38:39], v[54:55]
    v_cvt_pk_bf16_f32 v56, v32, v33
    v_cvt_pk_bf16_f32 v57, v34, v35
    v_cvt_pk_bf16_f32 v58, v36, v37
    v_cvt_pk_bf16_f32 v59, v38, v39
    s_add_u32 s39, s39, 4096
    buffer_store_dwordx4 v[56:59], v31, s[16:19], s39 offen offset:0 sc1
    v_accvgpr_read_b32 v64, a112
    v_accvgpr_read_b32 v65, a113
    v_accvgpr_read_b32 v66, a114
    v_accvgpr_read_b32 v67, a115
    v_accvgpr_read_b32 v68, a116
    v_accvgpr_read_b32 v69, a117
    v_accvgpr_read_b32 v70, a118
    v_accvgpr_read_b32 v71, a119
    s_add_u32 s21, s68, 20480
    buffer_load_dwordx4 v[116:119], v31, s[16:19], s21 offen offset:0 sc1
    v_pk_mul_f32 v[80:81], v[22:23], v[64:65] op_sel:[1,0] op_sel_hi:[1,1]
    v_pk_mul_f32 v[82:83], v[22:23], v[66:67] op_sel:[1,0] op_sel_hi:[1,1]
    v_pk_mul_f32 v[84:85], v[22:23], v[68:69] op_sel:[1,0] op_sel_hi:[1,1]
    v_pk_mul_f32 v[86:87], v[22:23], v[70:71] op_sel:[1,0] op_sel_hi:[1,1]
    v_exp_f32 v80, v80
    v_accvgpr_read_b32 v72, a120
    v_exp_f32 v81, v81
    v_accvgpr_read_b32 v73, a121
    v_exp_f32 v82, v82
    v_accvgpr_read_b32 v74, a122
    v_exp_f32 v83, v83
    v_accvgpr_read_b32 v75, a123
    v_exp_f32 v84, v84
    v_accvgpr_read_b32 v76, a124
    v_exp_f32 v85, v85
    buffer_load_dwordx4 v[120:123], v31, s[16:19], s21 offen offset:1024 sc1
    v_accvgpr_read_b32 v77, a125
    v_exp_f32 v86, v86
    v_accvgpr_read_b32 v78, a126
    v_exp_f32 v87, v87
    v_accvgpr_read_b32 v79, a127
    v_pk_fma_f32 v[80:81], v[80:81], v[20:21], v[20:21] op_sel:[0,1,1] op_sel_hi:[1,1,1]
    v_pk_fma_f32 v[82:83], v[82:83], v[20:21], v[20:21] op_sel:[0,1,1] op_sel_hi:[1,1,1]
    v_pk_fma_f32 v[84:85], v[84:85], v[20:21], v[20:21] op_sel:[0,1,1] op_sel_hi:[1,1,1]
    v_pk_fma_f32 v[86:87], v[86:87], v[20:21], v[20:21] op_sel:[0,1,1] op_sel_hi:[1,1,1]
    v_rcp_f32 v80, v80
    v_rcp_f32 v81, v81
    v_rcp_f32 v82, v82
    v_rcp_f32 v83, v83
    v_rcp_f32 v84, v84
    v_rcp_f32 v85, v85
    buffer_load_dwordx4 v[124:127], v31, s[16:19], s21 offen offset:2048 sc1
    v_rcp_f32 v86, v86
    v_rcp_f32 v87, v87
    v_pk_mul_f32 v[64:65], v[64:65], v[72:73]
    v_pk_mul_f32 v[66:67], v[66:67], v[74:75]
    v_pk_mul_f32 v[68:69], v[68:69], v[76:77]
    v_pk_mul_f32 v[70:71], v[70:71], v[78:79]
    v_pk_mul_f32 v[64:65], v[64:65], v[80:81]
    v_pk_mul_f32 v[66:67], v[66:67], v[82:83]
    v_pk_mul_f32 v[68:69], v[68:69], v[84:85]
    v_pk_mul_f32 v[70:71], v[70:71], v[86:87]
    v_cvt_pk_bf16_f32 v88, v64, v65
    v_cvt_pk_bf16_f32 v89, v66, v67
    v_cvt_pk_bf16_f32 v90, v68, v69
    v_cvt_pk_bf16_f32 v91, v70, v71
    buffer_store_dwordx4 v[88:91], v31, s[16:19], s39 offen offset:1024 sc1
    buffer_load_dwordx4 v[128:131], v31, s[16:19], s21 offen offset:3072 sc1
    s_add_u32 s21, s21, 4096
    buffer_load_dwordx4 v[132:135], v31, s[16:19], s21 offen offset:0 sc1
    s_add_u32 s21, s68, 25600
    buffer_load_dwordx4 v[136:139], v31, s[16:19], s21 offen offset:0 sc1
    buffer_load_dwordx4 v[140:143], v31, s[16:19], s21 offen offset:1024 sc1
    buffer_load_dwordx4 v[144:147], v31, s[16:19], s21 offen offset:2048 sc1
    buffer_load_dwordx4 v[148:151], v31, s[16:19], s21 offen offset:3072 sc1
    s_add_u32 s21, s21, 4096
    buffer_load_dwordx4 v[152:155], v31, s[16:19], s21 offen offset:0 sc1
    s_add_u32 s100, s63, 16384
    buffer_load_dwordx2 v[96:97], v18, s[16:19], s100 offen offset:0
    s_add_u32 s100, s64, 16384
    buffer_load_dwordx2 v[98:99], v18, s[16:19], s100 offen offset:0
    s_add_u32 s21, s68, 30720
    buffer_load_dwordx4 v[156:159], v31, s[16:19], s21 offen offset:0 sc1
    buffer_load_dwordx4 v[160:163], v31, s[16:19], s21 offen offset:1024 sc1
    buffer_load_dwordx4 v[164:167], v31, s[16:19], s21 offen offset:2048 sc1
    buffer_load_dwordx4 v[168:171], v31, s[16:19], s21 offen offset:3072 sc1
    s_waitcnt vmcnt(13)
    v_mov_b64 v[62:63], s[60:61]
    s_add_u32 s100, s62, 24576
    s_mov_b64 exec, 1
    buffer_store_dwordx2 v[62:63], off, s[16:19], s100 sc1
    s_mov_b64 exec, -1
    s_nop 1
    v_mov_b64 v[62:63], s[60:61]
    s_add_u32 s100, s62, 32768
    s_mov_b64 exec, 1
    buffer_store_dwordx2 v[62:63], off, s[16:19], s100 sc1
    s_mov_b64 exec, -1
    s_add_u32 s21, s21, 4096
    buffer_load_dwordx4 v[172:175], v31, s[16:19], s21 offen offset:0 sc1
    s_add_u32 s21, s68, 35840
    buffer_load_dwordx4 v[176:179], v31, s[16:19], s21 offen offset:0 sc1
    buffer_load_dwordx4 v[180:183], v31, s[16:19], s21 offen offset:1024 sc1
    buffer_load_dwordx4 v[184:187], v31, s[16:19], s21 offen offset:2048 sc1
    buffer_load_dwordx4 v[188:191], v31, s[16:19], s21 offen offset:3072 sc1
    s_add_u32 s21, s21, 4096
    buffer_load_dwordx4 v[192:195], v31, s[16:19], s21 offen offset:0 sc1
    s_waitcnt vmcnt(13)
    v_cmp_ne_u64 vcc, s[60:61], v[96:97]
    s_nop 0
    s_cmp_lg_u64 vcc, 0
    s_cbranch_scc1 fc_12_slow
fc_12_ok:
    s_waitcnt vmcnt(12)
    v_cmp_ne_u64 vcc, s[60:61], v[98:99]
    s_nop 0
    s_cmp_lg_u64 vcc, 0
    s_cbranch_scc1 fc_13_slow
fc_13_ok:
    s_add_u32 m0, s11, 114688
    s_add_u32 s98, s74, 40960
    s_mov_b32 exec_hi, 0xff
    buffer_load_dwordx4 v29, s[16:19], s98 offen offset:0 sc1 lds
    s_mov_b32 exec_hi, -1
    s_add_u32 m0, s11, 115072
    s_mov_b32 exec_hi, 0xff
    buffer_load_dwordx4 v29, s[16:19], s98 offen offset:256 sc1 lds
    s_mov_b32 exec_hi, -1
    s_add_u32 m0, s11, 115456
    s_mov_b32 exec_hi, 0xff
    buffer_load_dwordx4 v29, s[16:19], s98 offen offset:512 sc1 lds
    s_mov_b32 exec_hi, -1
    s_add_u32 m0, s11, 115840
    s_mov_b32 exec_hi, 0xff
    buffer_load_dwordx4 v29, s[16:19], s98 offen offset:768 sc1 lds
    s_mov_b32 exec_hi, -1
    s_add_u32 m0, s11, 116224
    s_mov_b32 exec_hi, 0xff
    buffer_load_dwordx4 v29, s[16:19], s98 offen offset:1024 sc1 lds
    s_mov_b32 exec_hi, -1
    s_add_u32 m0, s11, 131072
    s_add_u32 s98, s74, 81920
    s_mov_b32 exec_hi, 0xff
    buffer_load_dwordx4 v29, s[16:19], s98 offen offset:0 sc1 lds
    s_mov_b32 exec_hi, -1
    s_add_u32 m0, s11, 131456
    s_mov_b32 exec_hi, 0xff
    buffer_load_dwordx4 v29, s[16:19], s98 offen offset:256 sc1 lds
    s_mov_b32 exec_hi, -1
    s_add_u32 m0, s11, 131840
    s_mov_b32 exec_hi, 0xff
    buffer_load_dwordx4 v29, s[16:19], s98 offen offset:512 sc1 lds
    s_mov_b32 exec_hi, -1
    s_add_u32 m0, s11, 132224
    s_mov_b32 exec_hi, 0xff
    buffer_load_dwordx4 v29, s[16:19], s98 offen offset:768 sc1 lds
    s_mov_b32 exec_hi, -1
    s_add_u32 m0, s11, 132608
    s_mov_b32 exec_hi, 0xff
    buffer_load_dwordx4 v29, s[16:19], s98 offen offset:1024 sc1 lds
    s_mov_b32 exec_hi, -1
    buffer_load_dwordx2 v[96:97], v28, s[16:19], s74 offen offset:0 sc1
    buffer_load_dwordx2 v[98:99], v28, s[16:19], s74 offen offset:256 sc1
    buffer_load_dwordx2 v[100:101], v28, s[16:19], s74 offen offset:512 sc1
    buffer_load_dwordx2 v[102:103], v28, s[16:19], s74 offen offset:768 sc1
    buffer_load_dwordx2 v[104:105], v28, s[16:19], s74 offen offset:1024 sc1
    s_add_u32 s21, s68, 40960
    buffer_load_dwordx4 a[64:67], v31, s[16:19], s21 offen offset:0 sc1
    buffer_load_dwordx4 a[68:71], v31, s[16:19], s21 offen offset:1024 sc1
    buffer_load_dwordx4 a[72:75], v31, s[16:19], s21 offen offset:2048 sc1
    buffer_load_dwordx4 a[76:79], v31, s[16:19], s21 offen offset:3072 sc1
    s_add_u32 s21, s21, 4096
    buffer_load_dwordx4 a[80:83], v31, s[16:19], s21 offen offset:0 sc1
    s_add_u32 s21, s68, 46080
    buffer_load_dwordx4 a[84:87], v31, s[16:19], s21 offen offset:0 sc1
    buffer_load_dwordx4 a[88:91], v31, s[16:19], s21 offen offset:1024 sc1
    buffer_load_dwordx4 a[92:95], v31, s[16:19], s21 offen offset:2048 sc1
    buffer_load_dwordx4 a[96:99], v31, s[16:19], s21 offen offset:3072 sc1
    s_add_u32 s21, s21, 4096
    buffer_load_dwordx4 a[100:103], v31, s[16:19], s21 offen offset:0 sc1
    s_add_u32 s21, s68, 51200
    buffer_load_dwordx4 a[104:107], v31, s[16:19], s21 offen offset:0 sc1
    buffer_load_dwordx4 a[108:111], v31, s[16:19], s21 offen offset:1024 sc1
    buffer_load_dwordx4 a[112:115], v31, s[16:19], s21 offen offset:2048 sc1
    buffer_load_dwordx4 a[116:119], v31, s[16:19], s21 offen offset:3072 sc1
    s_add_u32 s21, s21, 4096
    buffer_load_dwordx4 a[120:123], v31, s[16:19], s21 offen offset:0 sc1
    s_add_u32 s21, s68, 56320
    buffer_load_dwordx4 a[128:131], v31, s[16:19], s21 offen offset:0 sc1
    buffer_load_dwordx4 a[132:135], v31, s[16:19], s21 offen offset:1024 sc1
    buffer_load_dwordx4 a[136:139], v31, s[16:19], s21 offen offset:2048 sc1
    buffer_load_dwordx4 a[140:143], v31, s[16:19], s21 offen offset:3072 sc1
    s_add_u32 s21, s21, 4096
    buffer_load_dwordx4 a[144:147], v31, s[16:19], s21 offen offset:0 sc1
    s_add_u32 s21, s69, 61440
    buffer_load_dwordx4 a[148:151], v31, s[16:19], s21 offen offset:0 sc1
    buffer_load_dwordx4 a[152:155], v31, s[16:19], s21 offen offset:1024 sc1
    buffer_load_dwordx4 a[156:159], v31, s[16:19], s21 offen offset:2048 sc1
    buffer_load_dwordx4 a[160:163], v31, s[16:19], s21 offen offset:3072 sc1
    s_add_u32 s21, s21, 4096
    buffer_load_dwordx4 a[164:167], v31, s[16:19], s21 offen offset:0 sc1
    s_add_u32 m0, s11, 0
    s_add_u32 s99, s71, 0
    buffer_load_dwordx4 v31, s[16:19], s99 offen offset:0 sc1 lds
    buffer_load_dwordx4 v31, s[16:19], s99 offen offset:1024 sc1 lds
    buffer_load_dwordx4 v31, s[16:19], s99 offen offset:2048 sc1 lds
    buffer_load_dwordx4 v31, s[16:19], s99 offen offset:3072 sc1 lds
    s_add_u32 m0, s11, 65536
    s_add_u32 s99, s71, 65536
    buffer_load_dwordx4 v31, s[16:19], s99 offen offset:0 sc1 lds
    buffer_load_dwordx4 v31, s[16:19], s99 offen offset:1024 sc1 lds
    buffer_load_dwordx4 v31, s[16:19], s99 offen offset:2048 sc1 lds
    buffer_load_dwordx4 v31, s[16:19], s99 offen offset:3072 sc1 lds
    s_add_u32 m0, s11, 81920
    s_add_u32 s99, s71, 81920
    buffer_load_dwordx4 v31, s[16:19], s99 offen offset:0 sc1 lds
    buffer_load_dwordx4 v31, s[16:19], s99 offen offset:1024 sc1 lds
    buffer_load_dwordx4 v31, s[16:19], s99 offen offset:2048 sc1 lds
    buffer_load_dwordx4 v31, s[16:19], s99 offen offset:3072 sc1 lds
    s_lshr_b32 s99, s11, 2
    s_add_u32 m0, s99, 98304
    s_sub_u32 s99, s71, s11
    s_add_u32 s99, s99, m0
    buffer_load_dwordx4 v31, s[16:19], s99 offen offset:0 sc1 lds
    s_waitcnt vmcnt(0)
    s_branch recurrent_scan__sliding_local_dilated__swiglu_ffn__prompt_kernel_join
    fc_1_slow:
    s_mov_b32 s101, 0
    fc_1_spin:
    s_add_u32 s100, s65, 8192
    buffer_load_dwordx2 v[88:89], v18, s[16:19], s100 offen offset:0 sc1
    s_add_u32 s101, s101, 1
    s_cmp_gt_u32 s101, 200000
    s_waitcnt vmcnt(0)
    s_cbranch_scc1 fc_1_ok
    v_cmp_ne_u64 vcc, s[60:61], v[88:89]
    s_nop 0
    s_cmp_lg_u64 vcc, 0
    s_cbranch_scc0 fc_1_ok
    s_sleep 4
    s_branch fc_1_spin
    fc_2_slow:
    s_mov_b32 s101, 0
    fc_2_spin:
    s_add_u32 s100, s65, 8192
    buffer_load_dwordx2 v[90:91], v18, s[16:19], s100 offen offset:512 sc1
    s_add_u32 s101, s101, 1
    s_cmp_gt_u32 s101, 200000
    s_waitcnt vmcnt(0)
    s_cbranch_scc1 fc_2_ok
    v_cmp_ne_u64 vcc, s[60:61], v[90:91]
    s_nop 0
    s_cmp_lg_u64 vcc, 0
    s_cbranch_scc0 fc_2_ok
    s_sleep 4
    s_branch fc_2_spin
    fc_3_slow:
    s_mov_b32 s101, 0
    fc_3_spin:
    s_add_u32 s100, s65, 8192
    buffer_load_dwordx2 v[92:93], v18, s[16:19], s100 offen offset:1024 sc1
    s_add_u32 s101, s101, 1
    s_cmp_gt_u32 s101, 200000
    s_waitcnt vmcnt(0)
    s_cbranch_scc1 fc_3_ok
    v_cmp_ne_u64 vcc, s[60:61], v[92:93]
    s_nop 0
    s_cmp_lg_u64 vcc, 0
    s_cbranch_scc0 fc_3_ok
    s_sleep 4
    s_branch fc_3_spin
    fc_4_slow:
    s_mov_b32 s101, 0
    fc_4_spin:
    s_add_u32 s100, s65, 8192
    buffer_load_dwordx2 v[94:95], v18, s[16:19], s100 offen offset:1536 sc1
    s_add_u32 s101, s101, 1
    s_cmp_gt_u32 s101, 200000
    s_waitcnt vmcnt(0)
    s_cbranch_scc1 fc_4_ok
    v_cmp_ne_u64 vcc, s[60:61], v[94:95]
    s_nop 0
    s_cmp_lg_u64 vcc, 0
    s_cbranch_scc0 fc_4_ok
    s_sleep 4
    s_branch fc_4_spin
    fc_6_slow:
    s_mov_b32 s101, 0
    fc_6_spin:
    s_add_u32 s100, s63, 16384
    buffer_load_dwordx2 v[96:97], v18, s[16:19], s100 offen offset:0 sc1
    s_add_u32 s101, s101, 1
    s_cmp_gt_u32 s101, 200000
    s_waitcnt vmcnt(0)
    s_cbranch_scc1 fc_6_ok
    v_cmp_ne_u64 vcc, s[60:61], v[96:97]
    s_nop 0
    s_cmp_lg_u64 vcc, 0
    s_cbranch_scc0 fc_6_ok
    s_sleep 4
    s_branch fc_6_spin
    fc_7_slow:
    s_mov_b32 s101, 0
    fc_7_spin:
    s_add_u32 s100, s64, 16384
    buffer_load_dwordx2 v[98:99], v18, s[16:19], s100 offen offset:0 sc1
    s_add_u32 s101, s101, 1
    s_cmp_gt_u32 s101, 200000
    s_waitcnt vmcnt(0)
    s_cbranch_scc1 fc_7_ok
    v_cmp_ne_u64 vcc, s[60:61], v[98:99]
    s_nop 0
    s_cmp_lg_u64 vcc, 0
    s_cbranch_scc0 fc_7_ok
    s_sleep 4
    s_branch fc_7_spin
    fc_9_slow:
    s_mov_b32 s101, 0
    fc_9_spin:
    s_add_u32 s100, s63, 24576
    buffer_load_dwordx2 v[22:23], v18, s[16:19], s100 offen offset:0 sc1
    s_add_u32 s101, s101, 1
    s_cmp_gt_u32 s101, 200000
    s_waitcnt vmcnt(0)
    s_cbranch_scc1 fc_9_ok
    v_cmp_ne_u64 vcc, s[60:61], v[22:23]
    s_nop 0
    s_cmp_lg_u64 vcc, 0
    s_cbranch_scc0 fc_9_ok
    s_sleep 4
    s_branch fc_9_spin
    fc_10_slow:
    s_mov_b32 s101, 0
    fc_10_spin:
    s_add_u32 s100, s63, 32768
    buffer_load_dwordx2 v[22:23], v18, s[16:19], s100 offen offset:0 sc1
    s_add_u32 s101, s101, 1
    s_cmp_gt_u32 s101, 200000
    s_waitcnt vmcnt(0)
    s_cbranch_scc1 fc_10_ok
    v_cmp_ne_u64 vcc, s[60:61], v[22:23]
    s_nop 0
    s_cmp_lg_u64 vcc, 0
    s_cbranch_scc0 fc_10_ok
    s_sleep 4
    s_branch fc_10_spin
    fc_11_slow:
    s_mov_b32 s101, 0
    fc_11_spin:
    s_add_u32 s100, s63, 40960
    buffer_load_dwordx2 v[22:23], v18, s[16:19], s100 offen offset:0 sc1
    s_add_u32 s101, s101, 1
    s_cmp_gt_u32 s101, 200000
    s_waitcnt vmcnt(0)
    s_cbranch_scc1 fc_11_ok
    v_cmp_ne_u64 vcc, s[60:61], v[22:23]
    s_nop 0
    s_or_b32 s100, vcc_lo, vcc_hi
    s_and_b32 s100, s100, s10
    s_cbranch_scc0 fc_11_ok
    s_sleep 4
    s_branch fc_11_spin
    fc_12_slow:
    s_mov_b32 s101, 0
    fc_12_spin:
    s_add_u32 s100, s63, 16384
    buffer_load_dwordx2 v[96:97], v18, s[16:19], s100 offen offset:0 sc1
    s_add_u32 s101, s101, 1
    s_cmp_gt_u32 s101, 200000
    s_waitcnt vmcnt(0)
    s_cbranch_scc1 fc_12_ok
    v_cmp_ne_u64 vcc, s[60:61], v[96:97]
    s_nop 0
    s_cmp_lg_u64 vcc, 0
    s_cbranch_scc0 fc_12_ok
    s_sleep 4
    s_branch fc_12_spin
    fc_13_slow:
    s_mov_b32 s101, 0
    fc_13_spin:
    s_add_u32 s100, s64, 16384
    buffer_load_dwordx2 v[98:99], v18, s[16:19], s100 offen offset:0 sc1
    s_add_u32 s101, s101, 1
    s_cmp_gt_u32 s101, 200000
    s_waitcnt vmcnt(0)
    s_cbranch_scc1 fc_13_ok
    v_cmp_ne_u64 vcc, s[60:61], v[98:99]
    s_nop 0
    s_cmp_lg_u64 vcc, 0
    s_cbranch_scc0 fc_13_ok
    s_sleep 4
    s_branch fc_13_spin
recurrent_scan__sliding_local_dilated__swiglu_ffn__prompt_kernel_end:
    s_endpgm
.section .rodata,"a"
.p2align 6
.amdhsa_kernel recurrent_scan__sliding_local_dilated__swiglu_ffn__prompt_kernel
  .amdhsa_next_free_vgpr 512
  .amdhsa_next_free_sgpr 102
  .amdhsa_accum_offset 256
  .amdhsa_group_segment_fixed_size 0
  .amdhsa_kernarg_size 80
  .amdhsa_user_sgpr_count 2
  .amdhsa_user_sgpr_kernarg_segment_ptr 1
  .amdhsa_system_sgpr_workgroup_id_x 1
  .amdhsa_float_denorm_mode_32 3
  .amdhsa_float_denorm_mode_16_64 3
.end_amdhsa_kernel
```
